```python
import torch

def _softmax(x, axis=-1):
    return torch.softmax(x, dim=axis)
def _gelu(x):
    return torch.nn.functional.gelu(x, approximate="tanh")
def _silu(x):
    return torch.nn.functional.silu(x)
def _sigmoid(x):
    return torch.sigmoid(x)
def _layernorm(x, axis=-1, eps=1e-5):
    m = x.mean(dim=axis, keepdim=True)
    v = x.var(dim=axis, keepdim=True, unbiased=False)
    return (x - m) / torch.sqrt(v + eps)
def _scatter_add(tgt, idx, src, axis=0):
    return tgt.clone().index_add_(axis, idx, src)
def _segment_sum(src, seg, n):
    out = torch.zeros((n,) + src.shape[1:], dtype=src.dtype)
    return out.index_add_(0, seg, src)
def _pad(x, pw):
    flat = tuple(v for pair in reversed(pw) for v in pair)
    return torch.nn.functional.pad(x, flat)

kernel_name = 'concat_heads__spectral_gfnet__mha_block__prompt'

def setup_inputs():

    _w = (lambda a: (lambda t: t.to(torch.bfloat16) if t.is_floating_point() else t)(torch.as_tensor(a)))
    def _A_setup():
        B, S, D = 1, 2048, 448
        Df = D // 2 + 1
        return {
            "x": _w((lambda *s: torch.randn(*s, dtype=torch.bfloat16) * 0.05)(B, S, D)),
            "w_r": _w((lambda *s: torch.randn(*s, dtype=torch.bfloat16) * 6.4)(S, Df) * 0.02),
            "w_i": _w((lambda *s: torch.randn(*s, dtype=torch.bfloat16) * 6.4)(S, Df) * 0.02),
        }
    _A_in = _A_setup()

    def _B_setup():
        B, S, D, H = 1, 2048, 448, 16
        return {
            "x": _w((lambda *s: torch.randn(*s, dtype=torch.bfloat16) * 0.2)(B, S, D)),
            "wqkv": _w((lambda *s: torch.randn(*s, dtype=torch.bfloat16) * 0.2)(D, 3 * D)),
            "wo": _w((lambda *s: torch.randn(*s, dtype=torch.bfloat16) * 0.05)(D, D)),
        }
    _B_in = _B_setup()

    return {
        "A_x": _A_in["x"],
        "A_w_r": _A_in["w_r"],
        "A_w_i": _A_in["w_i"],
        "B_x": _B_in["x"],
        "B_wqkv": _B_in["wqkv"],
        "B_wo": _B_in["wo"],
    }

def reference(A_x, A_w_r, A_w_i, B_x, B_wqkv, B_wo):
    def _A_ref(x, w_r, w_i):
        B, S, D = x.shape
        X = (lambda x, axes=(-2,-1): torch.fft.rfft2(x.float(), dim=axes))(x, axes=(-2, -1))
        W = w_r + 1j * w_i
        X = X * W
        y = (lambda x, s, axes=(-2,-1): torch.fft.irfft2(x, s=s, dim=axes).to(torch.bfloat16))(X, (S, D), axes=(-2, -1))
        return y

    def _B_ref(x, wqkv, wo):
        B, S, D = x.shape
        H = 16
        Dh = D // H
        qkv = (lambda x, *d: x.permute(*d))((x @ wqkv).reshape(B, S, 3, H, Dh), 2, 0, 3, 1, 4)
        q, k, v = qkv[0], qkv[1], qkv[2]
        scores = torch.einsum("bhqd,bhkd->bhqk", q, k) * (Dh ** -0.5)
        p = _softmax(scores, axis=-1)
        o = torch.einsum("bhqk,bhkd->bhqd", p, v)
        return (lambda x, *d: x.permute(*d))(o, 0, 2, 1, 3).reshape(B, S, D) @ wo

    a = _A_ref(A_x, A_w_r, A_w_i)
    b = _B_ref(B_x, B_wqkv, B_wo)
    return torch.concatenate([a, b], axis=-1)
```

```asm
; @launch kernel=concat_heads__spectral_gfnet__mha_block__prompt_kernel grid=(256,1,1) block=(512,1,1) lds=163840
.amdgcn_target "amdgcn-amd-amdhsa--gfx950"
.text
    .globl concat_heads__spectral_gfnet__mha_block__prompt_kernel
    .p2align 8
    .type concat_heads__spectral_gfnet__mha_block__prompt_kernel,@function
concat_heads__spectral_gfnet__mha_block__prompt_kernel:
    s_cmp_ge_u32 s2, 256
    s_cbranch_scc1 k_end
    v_lshrrev_b32 v2, 6, v0
    v_and_b32 v1, 63, v0
    v_readfirstlane_b32 s5, v2
    v_mov_b32 v4, 163584
    v_mov_b32 v5, 1
    s_cmp_ge_u32 s5, 4
    s_cbranch_scc1 a_pre
    s_load_dwordx16 s[16:31], s[0:1], 0
    s_load_dwordx2 s[32:33], s[0:1], 64
    s_branch b_go
a_pre:
    s_cmp_lg_u32 s5, 4
    s_cbranch_scc1 k_nz
    v_lshl_add_u32 v6, v1, 2, v4
    v_mov_b32 v7, 0
    s_mov_b64 exec, -1
    ds_write_b32 v6, v7
    s_mov_b64 exec, -1
    s_lshr_b32 s61, s2, 3
    s_getpc_b64 s[56:57]
    s_add_u32 s56, s56, concat_heads__spectral_gfnet__mha_block__prompt_kernel@rel32@lo+4
    s_addc_u32 s57, s57, concat_heads__spectral_gfnet__mha_block__prompt_kernel@rel32@hi+12
    s_mov_b32 s58, k_end-concat_heads__spectral_gfnet__mha_block__prompt_kernel
    s_mov_b32 s59, 0x20000
    s_and_b32 s8, s61, 7
    s_lshl_b32 s8, s8, 13
    v_lshlrev_b32 v6, 7, v1
    buffer_load_dword v245, v6, s[56:59], s8 offen
    s_waitcnt lgkmcnt(0)
k_nz:
    s_barrier
    s_load_dwordx16 s[16:31], s[0:1], 0
    s_load_dwordx2 s[32:33], s[0:1], 64
    s_branch a_wave
b_go:
    s_setprio 3
    s_and_b32 s60, s2, 7
    s_lshr_b32 s61, s2, 3
    s_and_b32 s15, s61, 1
    s_and_b32 s90, s61, 3
    s_lshr_b32 s3, s60, 1
    s_lshl_b32 s3, s3, 2
    s_add_u32 s3, s3, s90
    s_lshr_b32 s86, s3, 1
    s_and_b32 s4, s60, 1
    s_lshl_b32 s4, s4, 3
    s_lshr_b32 s6, s61, 2
    s_add_u32 s4, s4, s6
    v_lshlrev_b32 v3, 4, v1
    s_and_b32 s35, s5, 3
    s_lshl_b32 s11, s35, 12
    s_lshl_b32 s12, s35, 11
    s_lshl_b32 s9, s60, 2
    s_add_u32 s62, s9, s90
    v_and_b32 v8, 31, v1
    v_lshrrev_b32 v9, 5, v1
    s_lshl_b32 s6, s90, 1
    s_add_u32 s14, s4, s6
    s_mul_i32 s6, s14, 37
    s_lshr_b32 s6, s6, 8
    s_mul_i32 s6, s6, 7
    s_sub_u32 s14, s14, s6
    v_lshrrev_b32 v6, 3, v1
    v_and_b32 v100, 7, v1
    v_lshrrev_b32 v101, 1, v6
    v_xor_b32 v101, v101, v100
    v_mul_u32_u24 v102, 896, v6
    v_lshl_add_u32 v10, v101, 4, v102
    v_mul_u32_u24 v103, 57344, v6
    v_lshl_add_u32 v16, v101, 4, v103
    s_and_b32 s8, s35, 1
    s_lshl_b32 s8, s8, 6
    v_xor_b32 v16, s8, v16
    v_xor_b32 v101, 4, v101
    v_lshl_add_u32 v11, v101, 4, v102
    v_add_u32 v11, 7168, v11
    v_add_u32 v12, 14336, v10
    v_add_u32 v13, 14336, v11
    v_bfe_u32 v101, v1, 4, 1
    v_lshlrev_b32 v101, 2, v101
    v_xor_b32 v101, v101, v100
    v_min_u32 v101, 6, v101
    v_mul_u32_u24 v102, 2688, v6
    v_lshl_add_u32 v14, v101, 4, v102
    v_lshrrev_b32 v6, 2, v1
    v_mul_u32_u24 v6, 2688, v6
    v_and_b32 v101, 3, v1
    v_lshl_add_u32 v15, v101, 4, v6
    s_lshl_b32 s6, s4, 7
    s_lshl_b32 s7, s35, 5
    s_add_u32 s6, s6, s7
    s_mul_i32 s6, s6, 896
    s_mul_i32 s7, s35, 43008
    s_mul_i32 s8, s15, 896
    s_add_u32 s7, s7, s8
    s_mul_i32 s8, s86, 112
    s_add_u32 s7, s7, s8
    s_add_u32 s7, s7, 896
    s_mul_i32 s66, s35, 43008
    s_mul_i32 s8, s3, 56
    s_add_u32 s66, s66, s8
    s_lshl_b32 s65, s35, 10
    s_lshl_b32 s68, s60, 3
    s_and_b32 s8, s61, 7
    s_add_u32 s68, s68, s8
    s_mul_i32 s68, s68, 896
    s_mul_i32 s8, s35, 458752
    s_add_u32 s68, s68, s8
    v_mov_b32 v7, 0
    s_lshr_b32 s13, s61, 3
    s_lshl_b32 s13, s13, 1
    s_getpc_b64 s[56:57]
    s_add_u32 s56, s56, concat_heads__spectral_gfnet__mha_block__prompt_kernel@rel32@lo+4
    s_addc_u32 s57, s57, concat_heads__spectral_gfnet__mha_block__prompt_kernel@rel32@hi+12
    s_mov_b32 s58, 64
    s_mov_b32 s59, 0x20000
    v_mov_b32 v19, 0
    v_lshrrev_b32 v6, 2, v1
    s_lshl_b32 s8, s35, 4
    v_add_u32 v6, s8, v6
    v_lshlrev_b32 v6, 5, v6
    v_add_u32 v6, s62, v6
    v_mul_u32_u24 v6, 450, v6
    v_and_b32 v18, 3, v1
    v_lshlrev_b32 v18, 4, v18
    s_lshr_b32 s9, s61, 2
    s_mul_i32 s9, s9, 56
    v_add3_u32 v18, v6, v18, s9
    s_barrier
    s_waitcnt lgkmcnt(0)
    s_mov_b32 s52, s16
    s_mov_b32 s53, s17
    s_mov_b32 s54, 1835008
    s_mov_b32 s55, 0x20000
    s_mov_b32 s44, s32
    s_mov_b32 s45, s33
    s_mov_b32 s46, 33554432
    s_mov_b32 s47, 0x20000
    s_mov_b32 s89, s13
    s_mov_b32 s36, s22
    s_mov_b32 s37, s23
    s_mov_b32 s38, 1835008
    s_mov_b32 s39, 0x20000
    s_mov_b32 s40, s24
    s_mov_b32 s41, s25
    s_mov_b32 s42, 1204224
    s_mov_b32 s43, 0x20000
    s_mov_b32 s13, s14
    s_lshl_b32 s10, s13, 7
    s_add_u32 s10, s10, s6
    s_add_u32 m0, s11, 0
    s_nop 0
    buffer_load_dwordx4 v10, s[36:39], s10 offen lds
    s_add_u32 m0, s11, 1024
    s_nop 0
    buffer_load_dwordx4 v11, s[36:39], s10 offen lds
    s_add_u32 m0, s11, 2048
    s_nop 0
    buffer_load_dwordx4 v12, s[36:39], s10 offen lds
    s_add_u32 m0, s11, 3072
    s_nop 0
    buffer_load_dwordx4 v13, s[36:39], s10 offen lds
    s_mov_b32 s13, s14
    s_mul_i32 s13, s13, 172032
    s_add_u32 s13, s13, s7
    s_add_u32 m0, s12, 32768
    s_add_u32 s10, s13, 21504
    buffer_load_dwordx4 v14, s[40:43], s13 offen lds
    s_add_u32 m0, s12, 33792
    s_nop 0
    buffer_load_dwordx4 v14, s[40:43], s10 offen lds
    s_mov_b32 s9, 11010048
    buffer_load_dword v2, v7, s[44:47], s9 offen sc1
    s_add_u32 s13, s14, 1
    s_sub_u32 s10, s13, 7
    s_cmp_ge_u32 s13, 7
    s_cselect_b32 s13, s10, s13
    s_lshl_b32 s10, s13, 7
    s_add_u32 s10, s10, s6
    s_add_u32 m0, s11, 16384
    s_nop 0
    buffer_load_dwordx4 v10, s[36:39], s10 offen lds
    s_add_u32 m0, s11, 17408
    s_nop 0
    buffer_load_dwordx4 v11, s[36:39], s10 offen lds
    s_add_u32 m0, s11, 18432
    s_nop 0
    buffer_load_dwordx4 v12, s[36:39], s10 offen lds
    s_add_u32 m0, s11, 19456
    s_nop 0
    buffer_load_dwordx4 v13, s[36:39], s10 offen lds
    s_add_u32 s13, s14, 1
    s_sub_u32 s10, s13, 7
    s_cmp_ge_u32 s13, 7
    s_cselect_b32 s13, s10, s13
    s_mul_i32 s13, s13, 172032
    s_add_u32 s13, s13, s7
    s_add_u32 m0, s12, 40960
    s_add_u32 s10, s13, 21504
    buffer_load_dwordx4 v14, s[40:43], s13 offen lds
    s_add_u32 m0, s12, 41984
    s_nop 0
    buffer_load_dwordx4 v14, s[40:43], s10 offen lds
    v_and_b32 v6, 31, v1
    v_lshrrev_b32 v113, 5, v1
    v_bfe_u32 v116, v6, 1, 3
    v_lshlrev_b32 v6, 7, v6
    v_add_u32 v6, s11, v6
    v_add_u32 v117, 0, v113
    v_xor_b32 v117, v117, v116
    v_lshl_add_u32 v20, v117, 4, v6
    v_add_u32 v117, 2, v113
    v_xor_b32 v117, v117, v116
    v_lshl_add_u32 v21, v117, 4, v6
    v_add_u32 v117, 4, v113
    v_xor_b32 v117, v117, v116
    v_lshl_add_u32 v22, v117, 4, v6
    v_add_u32 v117, 6, v113
    v_xor_b32 v117, v117, v116
    v_lshl_add_u32 v23, v117, 4, v6
    v_lshlrev_b32 v6, 3, v113
    v_bfe_u32 v114, v1, 2, 2
    v_add_u32 v6, v6, v114
    v_and_b32 v114, 1, v1
    v_lshlrev_b32 v114, 5, v114
    v_bfe_u32 v117, v1, 4, 1
    v_lshl_add_u32 v114, v117, 4, v114
    v_bfe_u32 v117, v1, 1, 1
    v_lshl_add_u32 v114, v117, 3, v114
    v_lshl_add_u32 v26, v6, 6, v114
    v_add_u32 v26, 90112, v26
    v_bfe_u32 v117, v1, 3, 1
    v_lshlrev_b32 v117, 6, v117
    v_lshlrev_b32 v6, 7, v6
    v_add_u32 v6, 32768, v6
    v_xor_b32 v115, v114, v117
    v_add_u32 v24, v6, v115
    v_add_u32 v114, 56, v114
    v_xor_b32 v115, v114, v117
    v_add_u32 v25, v6, v115
    s_mov_b32 s48, s28
    s_mov_b32 s49, s29
    s_mov_b32 s50, 3670016
    s_mov_b32 s51, 0x20000
    s_cmp_lg_u32 s15, 0
    s_cbranch_scc1 b_v
    s_waitcnt vmcnt(7)
    ds_read_b128 v[144:147], v20 offset:0
    ds_read_b128 v[148:151], v21 offset:0
    ds_read_b128 v[152:155], v22 offset:0
    ds_read_b128 v[156:159], v23 offset:0
    s_mov_b64 exec, 1
    ds_add_u32 v4, v5 offset:76
    s_mov_b64 exec, -1
    s_waitcnt lgkmcnt(1)
    ds_read_b32 v6, v4 offset:76
    s_add_u32 s13, s14, 2
    s_sub_u32 s10, s13, 7
    s_cmp_ge_u32 s13, 7
    s_cselect_b32 s13, s10, s13
    s_lshl_b32 s10, s13, 7
    s_add_u32 s10, s10, s6
    s_add_u32 m0, s11, 0
    s_nop 0
    buffer_load_dwordx4 v10, s[36:39], s10 offen lds
    s_add_u32 m0, s11, 1024
    s_nop 0
    buffer_load_dwordx4 v11, s[36:39], s10 offen lds
    s_add_u32 m0, s11, 2048
    s_nop 0
    buffer_load_dwordx4 v12, s[36:39], s10 offen lds
    s_add_u32 m0, s11, 3072
    s_nop 0
    buffer_load_dwordx4 v13, s[36:39], s10 offen lds
    s_add_u32 s13, s14, 2
    s_sub_u32 s10, s13, 7
    s_cmp_ge_u32 s13, 7
    s_cselect_b32 s13, s10, s13
    s_mul_i32 s13, s13, 172032
    s_add_u32 s13, s13, s7
    s_add_u32 m0, s12, 49152
    s_add_u32 s10, s13, 21504
    buffer_load_dwordx4 v14, s[40:43], s13 offen lds
    s_add_u32 m0, s12, 50176
    s_nop 0
    buffer_load_dwordx4 v14, s[40:43], s10 offen lds
    s_lshl_b32 s10, s89, 7
    s_add_u32 s10, s10, s68
    s_lshl_b32 s9, s89, 12
    s_add_u32 s9, s9, s65
    s_add_u32 m0, s9, 118784
    s_add_u32 s89, s89, 1
    buffer_load_dwordx4 v16, s[52:55], s10 offen lds
    s_cmp_eq_u32 s89, 7
    s_cselect_b32 s89, 0, s89
    s_lshl_b32 s10, s89, 7
    s_add_u32 s10, s10, s68
    s_lshl_b32 s9, s89, 12
    s_add_u32 s9, s9, s65
    s_add_u32 m0, s9, 118784
    s_add_u32 s89, s89, 1
    buffer_load_dwordx4 v16, s[52:55], s10 offen lds
    s_cmp_eq_u32 s89, 7
    s_cselect_b32 s89, 0, s89
    s_waitcnt lgkmcnt(0)
    v_readfirstlane_b32 s8, v6
    s_nop 1
    s_cmp_ge_u32 s8, 4
    s_cbranch_scc1 cw_1
    s_mov_b32 s69, 400000
wc_2:
    ds_read_b32 v6, v4 offset:76
    s_waitcnt lgkmcnt(0)
    v_readfirstlane_b32 s8, v6
    s_sub_u32 s69, s69, 1
    s_cmp_ge_u32 s8, 4
    s_cbranch_scc1 wc_2_d
    s_sleep 1
    s_cmp_lg_u32 s69, 0
    s_cbranch_scc1 wc_2
wc_2_d:
cw_1:
    ds_read_b64_tr_b16 v[80:81], v24 offset:0
    ds_read_b64_tr_b16 v[82:83], v24 offset:512
    ds_read_b64_tr_b16 v[84:85], v25 offset:0
    ds_read_b64_tr_b16 v[86:87], v25 offset:512
    ds_read_b64_tr_b16 v[88:89], v24 offset:2048
    ds_read_b64_tr_b16 v[90:91], v24 offset:2560
    ds_read_b64_tr_b16 v[92:93], v25 offset:2048
    ds_read_b64_tr_b16 v[94:95], v25 offset:2560
    ds_read_b64_tr_b16 v[96:97], v24 offset:4096
    ds_read_b64_tr_b16 v[98:99], v24 offset:4608
    ds_read_b64_tr_b16 v[100:101], v25 offset:4096
    ds_read_b64_tr_b16 v[102:103], v25 offset:4608
    ds_read_b64_tr_b16 v[104:105], v24 offset:6144
    ds_read_b64_tr_b16 v[106:107], v24 offset:6656
    ds_read_b64_tr_b16 v[108:109], v25 offset:6144
    ds_read_b64_tr_b16 v[110:111], v25 offset:6656
    s_waitcnt lgkmcnt(12)
    v_mfma_f32_32x32x16_bf16 v[32:47], v[80:83], v[144:147], 0
    v_mfma_f32_32x32x16_bf16 v[48:63], v[84:87], v[144:147], 0
    s_waitcnt vmcnt(8)
    ds_read_b128 v[160:163], v20 offset:16384
    ds_read_b128 v[164:167], v21 offset:16384
    ds_read_b128 v[168:171], v22 offset:16384
    ds_read_b128 v[172:175], v23 offset:16384
    s_mov_b64 exec, 1
    ds_add_u32 v4, v5 offset:76
    s_mov_b64 exec, -1
    s_waitcnt lgkmcnt(13)
    v_mfma_f32_32x32x16_bf16 v[32:47], v[88:91], v[148:151], v[32:47]
    v_mfma_f32_32x32x16_bf16 v[48:63], v[92:95], v[148:151], v[48:63]
    s_waitcnt lgkmcnt(9)
    v_mfma_f32_32x32x16_bf16 v[32:47], v[96:99], v[152:155], v[32:47]
    v_mfma_f32_32x32x16_bf16 v[48:63], v[100:103], v[152:155], v[48:63]
    s_waitcnt lgkmcnt(1)
    v_mfma_f32_32x32x16_bf16 v[32:47], v[104:107], v[156:159], v[32:47]
    v_mfma_f32_32x32x16_bf16 v[48:63], v[108:111], v[156:159], v[48:63]
    ds_read_b32 v6, v4 offset:76
    s_add_u32 s13, s14, 3
    s_sub_u32 s10, s13, 7
    s_cmp_ge_u32 s13, 7
    s_cselect_b32 s13, s10, s13
    s_lshl_b32 s10, s13, 7
    s_add_u32 s10, s10, s6
    s_add_u32 m0, s11, 16384
    s_nop 0
    buffer_load_dwordx4 v10, s[36:39], s10 offen lds
    s_add_u32 m0, s11, 17408
    s_nop 0
    buffer_load_dwordx4 v11, s[36:39], s10 offen lds
    s_add_u32 m0, s11, 18432
    s_nop 0
    buffer_load_dwordx4 v12, s[36:39], s10 offen lds
    s_add_u32 m0, s11, 19456
    s_nop 0
    buffer_load_dwordx4 v13, s[36:39], s10 offen lds
    s_add_u32 s13, s14, 3
    s_sub_u32 s10, s13, 7
    s_cmp_ge_u32 s13, 7
    s_cselect_b32 s13, s10, s13
    s_mul_i32 s13, s13, 172032
    s_add_u32 s13, s13, s7
    s_add_u32 m0, s12, 57344
    s_add_u32 s10, s13, 21504
    buffer_load_dwordx4 v14, s[40:43], s13 offen lds
    s_add_u32 m0, s12, 58368
    s_nop 0
    buffer_load_dwordx4 v14, s[40:43], s10 offen lds
    s_lshl_b32 s10, s89, 7
    s_add_u32 s10, s10, s68
    s_lshl_b32 s9, s89, 12
    s_add_u32 s9, s9, s65
    s_add_u32 m0, s9, 118784
    s_add_u32 s89, s89, 1
    buffer_load_dwordx4 v16, s[52:55], s10 offen lds
    s_cmp_eq_u32 s89, 7
    s_cselect_b32 s89, 0, s89
    s_lshl_b32 s10, s89, 7
    s_add_u32 s10, s10, s68
    s_lshl_b32 s9, s89, 12
    s_add_u32 s9, s9, s65
    s_add_u32 m0, s9, 118784
    s_add_u32 s89, s89, 1
    buffer_load_dwordx4 v16, s[52:55], s10 offen lds
    s_cmp_eq_u32 s89, 7
    s_cselect_b32 s89, 0, s89
    s_waitcnt lgkmcnt(0)
    v_readfirstlane_b32 s8, v6
    s_nop 1
    s_cmp_ge_u32 s8, 8
    s_cbranch_scc1 cw_3
    s_mov_b32 s69, 400000
wc_4:
    ds_read_b32 v6, v4 offset:76
    s_waitcnt lgkmcnt(0)
    v_readfirstlane_b32 s8, v6
    s_sub_u32 s69, s69, 1
    s_cmp_ge_u32 s8, 8
    s_cbranch_scc1 wc_4_d
    s_sleep 1
    s_cmp_lg_u32 s69, 0
    s_cbranch_scc1 wc_4
wc_4_d:
cw_3:
    ds_read_b64_tr_b16 v[112:113], v24 offset:8192
    ds_read_b64_tr_b16 v[114:115], v24 offset:8704
    ds_read_b64_tr_b16 v[116:117], v25 offset:8192
    ds_read_b64_tr_b16 v[118:119], v25 offset:8704
    ds_read_b64_tr_b16 v[120:121], v24 offset:10240
    ds_read_b64_tr_b16 v[122:123], v24 offset:10752
    ds_read_b64_tr_b16 v[124:125], v25 offset:10240
    ds_read_b64_tr_b16 v[126:127], v25 offset:10752
    ds_read_b64_tr_b16 v[128:129], v24 offset:12288
    ds_read_b64_tr_b16 v[130:131], v24 offset:12800
    ds_read_b64_tr_b16 v[132:133], v25 offset:12288
    ds_read_b64_tr_b16 v[134:135], v25 offset:12800
    ds_read_b64_tr_b16 v[136:137], v24 offset:14336
    ds_read_b64_tr_b16 v[138:139], v24 offset:14848
    ds_read_b64_tr_b16 v[140:141], v25 offset:14336
    ds_read_b64_tr_b16 v[142:143], v25 offset:14848
    s_waitcnt lgkmcnt(12)
    v_mfma_f32_32x32x16_bf16 v[32:47], v[112:115], v[160:163], v[32:47]
    v_mfma_f32_32x32x16_bf16 v[48:63], v[116:119], v[160:163], v[48:63]
    s_waitcnt vmcnt(10)
    ds_read_b128 v[176:179], v20 offset:0
    ds_read_b128 v[180:183], v21 offset:0
    ds_read_b128 v[184:187], v22 offset:0
    ds_read_b128 v[188:191], v23 offset:0
    s_mov_b64 exec, 1
    ds_add_u32 v4, v5 offset:76
    s_mov_b64 exec, -1
    s_waitcnt lgkmcnt(13)
    v_mfma_f32_32x32x16_bf16 v[32:47], v[120:123], v[164:167], v[32:47]
    v_mfma_f32_32x32x16_bf16 v[48:63], v[124:127], v[164:167], v[48:63]
    v_readfirstlane_b32 s34, v2
    s_mov_b32 s93, 0x00030003
    s_nop 1
    s_add_u32 s34, s34, 1
    s_mov_b32 s67, s34
    s_bfe_i32 s92, s34, 0x10000
    s_xor_b32 s92, s92, 0x6a39e5c1
    s_mul_i32 s34, s34, 0x9E3779B1
    v_and_b32 v27, 3, v1
    v_lshlrev_b32 v27, 2, v27
    v_lshrrev_b32 v27, v27, s92
    s_mov_b32 exec_lo, 0x10000000
    s_mov_b32 exec_hi, 0x10000000
    v_mov_b32 v27, 0
    s_mov_b64 exec, -1
    s_waitcnt lgkmcnt(9)
    v_mfma_f32_32x32x16_bf16 v[32:47], v[128:131], v[168:171], v[32:47]
    v_mfma_f32_32x32x16_bf16 v[48:63], v[132:135], v[168:171], v[48:63]
    s_waitcnt lgkmcnt(1)
    v_mfma_f32_32x32x16_bf16 v[32:47], v[136:139], v[172:175], v[32:47]
    v_mfma_f32_32x32x16_bf16 v[48:63], v[140:143], v[172:175], v[48:63]
    ds_read_b32 v6, v4 offset:76
    s_add_u32 s13, s14, 4
    s_sub_u32 s10, s13, 7
    s_cmp_ge_u32 s13, 7
    s_cselect_b32 s13, s10, s13
    s_lshl_b32 s10, s13, 7
    s_add_u32 s10, s10, s6
    s_add_u32 m0, s11, 0
    s_nop 0
    buffer_load_dwordx4 v10, s[36:39], s10 offen lds
    s_add_u32 m0, s11, 1024
    s_nop 0
    buffer_load_dwordx4 v11, s[36:39], s10 offen lds
    s_add_u32 m0, s11, 2048
    s_nop 0
    buffer_load_dwordx4 v12, s[36:39], s10 offen lds
    s_add_u32 m0, s11, 3072
    s_nop 0
    buffer_load_dwordx4 v13, s[36:39], s10 offen lds
    s_add_u32 s13, s14, 4
    s_sub_u32 s10, s13, 7
    s_cmp_ge_u32 s13, 7
    s_cselect_b32 s13, s10, s13
    s_mul_i32 s13, s13, 172032
    s_add_u32 s13, s13, s7
    s_add_u32 m0, s12, 65536
    s_add_u32 s10, s13, 21504
    buffer_load_dwordx4 v14, s[40:43], s13 offen lds
    s_add_u32 m0, s12, 66560
    s_nop 0
    buffer_load_dwordx4 v14, s[40:43], s10 offen lds
    s_lshl_b32 s10, s89, 7
    s_add_u32 s10, s10, s68
    s_lshl_b32 s9, s89, 12
    s_add_u32 s9, s9, s65
    s_add_u32 m0, s9, 118784
    s_add_u32 s89, s89, 1
    buffer_load_dwordx4 v16, s[52:55], s10 offen lds
    s_cmp_eq_u32 s89, 7
    s_cselect_b32 s89, 0, s89
    s_lshl_b32 s10, s89, 7
    s_add_u32 s10, s10, s68
    s_lshl_b32 s9, s89, 12
    s_add_u32 s9, s9, s65
    s_add_u32 m0, s9, 118784
    s_add_u32 s89, s89, 1
    buffer_load_dwordx4 v16, s[52:55], s10 offen lds
    s_cmp_eq_u32 s89, 7
    s_cselect_b32 s89, 0, s89
    s_waitcnt lgkmcnt(0)
    v_readfirstlane_b32 s8, v6
    s_nop 1
    s_cmp_ge_u32 s8, 12
    s_cbranch_scc1 cw_5
    s_mov_b32 s69, 400000
wc_6:
    ds_read_b32 v6, v4 offset:76
    s_waitcnt lgkmcnt(0)
    v_readfirstlane_b32 s8, v6
    s_sub_u32 s69, s69, 1
    s_cmp_ge_u32 s8, 12
    s_cbranch_scc1 wc_6_d
    s_sleep 1
    s_cmp_lg_u32 s69, 0
    s_cbranch_scc1 wc_6
wc_6_d:
cw_5:
    ds_read_b64_tr_b16 v[80:81], v24 offset:16384
    ds_read_b64_tr_b16 v[82:83], v24 offset:16896
    ds_read_b64_tr_b16 v[84:85], v25 offset:16384
    ds_read_b64_tr_b16 v[86:87], v25 offset:16896
    ds_read_b64_tr_b16 v[88:89], v24 offset:18432
    ds_read_b64_tr_b16 v[90:91], v24 offset:18944
    ds_read_b64_tr_b16 v[92:93], v25 offset:18432
    ds_read_b64_tr_b16 v[94:95], v25 offset:18944
    ds_read_b64_tr_b16 v[96:97], v24 offset:20480
    ds_read_b64_tr_b16 v[98:99], v24 offset:20992
    ds_read_b64_tr_b16 v[100:101], v25 offset:20480
    ds_read_b64_tr_b16 v[102:103], v25 offset:20992
    ds_read_b64_tr_b16 v[104:105], v24 offset:22528
    ds_read_b64_tr_b16 v[106:107], v24 offset:23040
    ds_read_b64_tr_b16 v[108:109], v25 offset:22528
    ds_read_b64_tr_b16 v[110:111], v25 offset:23040
    s_waitcnt lgkmcnt(12)
    v_mfma_f32_32x32x16_bf16 v[32:47], v[80:83], v[176:179], v[32:47]
    v_mfma_f32_32x32x16_bf16 v[48:63], v[84:87], v[176:179], v[48:63]
    s_waitcnt vmcnt(10)
    ds_read_b128 v[192:195], v20 offset:16384
    ds_read_b128 v[196:199], v21 offset:16384
    ds_read_b128 v[200:203], v22 offset:16384
    ds_read_b128 v[204:207], v23 offset:16384
    s_mov_b64 exec, 1
    ds_add_u32 v4, v5 offset:76
    s_mov_b64 exec, -1
    s_waitcnt lgkmcnt(13)
    v_mfma_f32_32x32x16_bf16 v[32:47], v[88:91], v[180:183], v[32:47]
    v_mfma_f32_32x32x16_bf16 v[48:63], v[92:95], v[180:183], v[48:63]
    s_waitcnt lgkmcnt(9)
    v_mfma_f32_32x32x16_bf16 v[32:47], v[96:99], v[184:187], v[32:47]
    v_mfma_f32_32x32x16_bf16 v[48:63], v[100:103], v[184:187], v[48:63]
    s_waitcnt lgkmcnt(1)
    v_mfma_f32_32x32x16_bf16 v[32:47], v[104:107], v[188:191], v[32:47]
    v_mfma_f32_32x32x16_bf16 v[48:63], v[108:111], v[188:191], v[48:63]
    ds_read_b32 v6, v4 offset:76
    s_add_u32 s13, s14, 5
    s_sub_u32 s10, s13, 7
    s_cmp_ge_u32 s13, 7
    s_cselect_b32 s13, s10, s13
    s_lshl_b32 s10, s13, 7
    s_add_u32 s10, s10, s6
    s_add_u32 m0, s11, 16384
    s_nop 0
    buffer_load_dwordx4 v10, s[36:39], s10 offen lds
    s_add_u32 m0, s11, 17408
    s_nop 0
    buffer_load_dwordx4 v11, s[36:39], s10 offen lds
    s_add_u32 m0, s11, 18432
    s_nop 0
    buffer_load_dwordx4 v12, s[36:39], s10 offen lds
    s_add_u32 m0, s11, 19456
    s_nop 0
    buffer_load_dwordx4 v13, s[36:39], s10 offen lds
    s_add_u32 s13, s14, 5
    s_sub_u32 s10, s13, 7
    s_cmp_ge_u32 s13, 7
    s_cselect_b32 s13, s10, s13
    s_mul_i32 s13, s13, 172032
    s_add_u32 s13, s13, s7
    s_add_u32 m0, s12, 73728
    s_add_u32 s10, s13, 21504
    buffer_load_dwordx4 v14, s[40:43], s13 offen lds
    s_add_u32 m0, s12, 74752
    s_nop 0
    buffer_load_dwordx4 v14, s[40:43], s10 offen lds
    s_lshl_b32 s10, s89, 7
    s_add_u32 s10, s10, s68
    s_lshl_b32 s9, s89, 12
    s_add_u32 s9, s9, s65
    s_add_u32 m0, s9, 118784
    s_add_u32 s89, s89, 1
    buffer_load_dwordx4 v16, s[52:55], s10 offen lds
    s_cmp_eq_u32 s89, 7
    s_cselect_b32 s89, 0, s89
    s_mov_b32 m0, 163692
    s_mov_b32 s9, 11010048
    s_mov_b64 exec, 1
    buffer_load_dword v7, s[44:47], s9 offen sc1 lds
    s_lshl_b32 s9, s35, 2
    s_add_u32 m0, s9, 163696
    s_nop 0
    buffer_load_dword v7, s[56:59], 0 offen lds
    s_mov_b64 exec, -1
    s_waitcnt lgkmcnt(0)
    v_readfirstlane_b32 s8, v6
    s_nop 1
    s_cmp_ge_u32 s8, 16
    s_cbranch_scc1 cw_7
    s_mov_b32 s69, 400000
wc_8:
    ds_read_b32 v6, v4 offset:76
    s_waitcnt lgkmcnt(0)
    v_readfirstlane_b32 s8, v6
    s_sub_u32 s69, s69, 1
    s_cmp_ge_u32 s8, 16
    s_cbranch_scc1 wc_8_d
    s_sleep 1
    s_cmp_lg_u32 s69, 0
    s_cbranch_scc1 wc_8
wc_8_d:
cw_7:
    ds_read_b64_tr_b16 v[112:113], v24 offset:24576
    ds_read_b64_tr_b16 v[114:115], v24 offset:25088
    ds_read_b64_tr_b16 v[116:117], v25 offset:24576
    ds_read_b64_tr_b16 v[118:119], v25 offset:25088
    ds_read_b64_tr_b16 v[120:121], v24 offset:26624
    ds_read_b64_tr_b16 v[122:123], v24 offset:27136
    ds_read_b64_tr_b16 v[124:125], v25 offset:26624
    ds_read_b64_tr_b16 v[126:127], v25 offset:27136
    ds_read_b64_tr_b16 v[128:129], v24 offset:28672
    ds_read_b64_tr_b16 v[130:131], v24 offset:29184
    ds_read_b64_tr_b16 v[132:133], v25 offset:28672
    ds_read_b64_tr_b16 v[134:135], v25 offset:29184
    ds_read_b64_tr_b16 v[136:137], v24 offset:30720
    ds_read_b64_tr_b16 v[138:139], v24 offset:31232
    ds_read_b64_tr_b16 v[140:141], v25 offset:30720
    ds_read_b64_tr_b16 v[142:143], v25 offset:31232
    s_waitcnt lgkmcnt(12)
    v_mfma_f32_32x32x16_bf16 v[32:47], v[112:115], v[192:195], v[32:47]
    v_mfma_f32_32x32x16_bf16 v[48:63], v[116:119], v[192:195], v[48:63]
    s_waitcnt vmcnt(11)
    ds_read_b128 v[208:211], v20 offset:0
    ds_read_b128 v[212:215], v21 offset:0
    ds_read_b128 v[216:219], v22 offset:0
    ds_read_b128 v[220:223], v23 offset:0
    s_mov_b64 exec, 1
    ds_add_u32 v4, v5 offset:76
    s_mov_b64 exec, -1
    s_waitcnt lgkmcnt(13)
    v_mfma_f32_32x32x16_bf16 v[32:47], v[120:123], v[196:199], v[32:47]
    v_mfma_f32_32x32x16_bf16 v[48:63], v[124:127], v[196:199], v[48:63]
    s_waitcnt lgkmcnt(9)
    v_mfma_f32_32x32x16_bf16 v[32:47], v[128:131], v[200:203], v[32:47]
    v_mfma_f32_32x32x16_bf16 v[48:63], v[132:135], v[200:203], v[48:63]
    s_waitcnt lgkmcnt(1)
    v_mfma_f32_32x32x16_bf16 v[32:47], v[136:139], v[204:207], v[32:47]
    v_mfma_f32_32x32x16_bf16 v[48:63], v[140:143], v[204:207], v[48:63]
    ds_read_b32 v6, v4 offset:76
    s_add_u32 s13, s14, 6
    s_sub_u32 s10, s13, 7
    s_cmp_ge_u32 s13, 7
    s_cselect_b32 s13, s10, s13
    s_lshl_b32 s10, s13, 7
    s_add_u32 s10, s10, s6
    s_add_u32 m0, s11, 0
    s_nop 0
    buffer_load_dwordx4 v10, s[36:39], s10 offen lds
    s_add_u32 m0, s11, 1024
    s_nop 0
    buffer_load_dwordx4 v11, s[36:39], s10 offen lds
    s_add_u32 m0, s11, 2048
    s_nop 0
    buffer_load_dwordx4 v12, s[36:39], s10 offen lds
    s_add_u32 m0, s11, 3072
    s_nop 0
    buffer_load_dwordx4 v13, s[36:39], s10 offen lds
    s_add_u32 s13, s14, 6
    s_sub_u32 s10, s13, 7
    s_cmp_ge_u32 s13, 7
    s_cselect_b32 s13, s10, s13
    s_mul_i32 s13, s13, 172032
    s_add_u32 s13, s13, s7
    s_add_u32 m0, s12, 81920
    s_add_u32 s10, s13, 21504
    buffer_load_dwordx4 v14, s[40:43], s13 offen lds
    s_add_u32 m0, s12, 82944
    s_nop 0
    buffer_load_dwordx4 v14, s[40:43], s10 offen lds
    s_waitcnt lgkmcnt(0)
    v_readfirstlane_b32 s8, v6
    s_nop 1
    s_cmp_ge_u32 s8, 20
    s_cbranch_scc1 cw_9
    s_mov_b32 s69, 400000
wc_10:
    ds_read_b32 v6, v4 offset:76
    s_waitcnt lgkmcnt(0)
    v_readfirstlane_b32 s8, v6
    s_sub_u32 s69, s69, 1
    s_cmp_ge_u32 s8, 20
    s_cbranch_scc1 wc_10_d
    s_sleep 1
    s_cmp_lg_u32 s69, 0
    s_cbranch_scc1 wc_10
wc_10_d:
cw_9:
    ds_read_b64_tr_b16 v[80:81], v24 offset:32768
    ds_read_b64_tr_b16 v[82:83], v24 offset:33280
    ds_read_b64_tr_b16 v[84:85], v25 offset:32768
    ds_read_b64_tr_b16 v[86:87], v25 offset:33280
    ds_read_b64_tr_b16 v[88:89], v24 offset:34816
    ds_read_b64_tr_b16 v[90:91], v24 offset:35328
    ds_read_b64_tr_b16 v[92:93], v25 offset:34816
    ds_read_b64_tr_b16 v[94:95], v25 offset:35328
    ds_read_b64_tr_b16 v[96:97], v24 offset:36864
    ds_read_b64_tr_b16 v[98:99], v24 offset:37376
    ds_read_b64_tr_b16 v[100:101], v25 offset:36864
    ds_read_b64_tr_b16 v[102:103], v25 offset:37376
    ds_read_b64_tr_b16 v[104:105], v24 offset:38912
    ds_read_b64_tr_b16 v[106:107], v24 offset:39424
    ds_read_b64_tr_b16 v[108:109], v25 offset:38912
    ds_read_b64_tr_b16 v[110:111], v25 offset:39424
    s_waitcnt lgkmcnt(12)
    v_mfma_f32_32x32x16_bf16 v[32:47], v[80:83], v[208:211], v[32:47]
    v_mfma_f32_32x32x16_bf16 v[48:63], v[84:87], v[208:211], v[48:63]
    s_waitcnt vmcnt(9)
    ds_read_b128 v[224:227], v20 offset:16384
    ds_read_b128 v[228:231], v21 offset:16384
    ds_read_b128 v[232:235], v22 offset:16384
    ds_read_b128 v[236:239], v23 offset:16384
    s_mov_b64 exec, 1
    ds_add_u32 v4, v5 offset:76
    s_mov_b64 exec, -1
    s_waitcnt lgkmcnt(13)
    v_mfma_f32_32x32x16_bf16 v[32:47], v[88:91], v[212:215], v[32:47]
    v_mfma_f32_32x32x16_bf16 v[48:63], v[92:95], v[212:215], v[48:63]
    s_waitcnt lgkmcnt(9)
    v_mfma_f32_32x32x16_bf16 v[32:47], v[96:99], v[216:219], v[32:47]
    v_mfma_f32_32x32x16_bf16 v[48:63], v[100:103], v[216:219], v[48:63]
    s_waitcnt lgkmcnt(1)
    v_mfma_f32_32x32x16_bf16 v[32:47], v[104:107], v[220:223], v[32:47]
    v_mfma_f32_32x32x16_bf16 v[48:63], v[108:111], v[220:223], v[48:63]
    ds_read_b32 v6, v4 offset:76
    s_mov_b32 s13, s14
    s_mul_i32 s13, s13, 172032
    s_add_u32 s13, s13, s66
    s_add_u32 m0, s65, 90112
    s_nop 0
    buffer_load_dwordx4 v15, s[40:43], s13 offen lds
    s_add_u32 s13, s14, 1
    s_sub_u32 s10, s13, 7
    s_cmp_ge_u32 s13, 7
    s_cselect_b32 s13, s10, s13
    s_mul_i32 s13, s13, 172032
    s_add_u32 s13, s13, s66
    s_add_u32 m0, s65, 94208
    s_nop 0
    buffer_load_dwordx4 v15, s[40:43], s13 offen lds
    s_add_u32 s13, s14, 2
    s_sub_u32 s10, s13, 7
    s_cmp_ge_u32 s13, 7
    s_cselect_b32 s13, s10, s13
    s_mul_i32 s13, s13, 172032
    s_add_u32 s13, s13, s66
    s_add_u32 m0, s65, 98304
    s_nop 0
    buffer_load_dwordx4 v15, s[40:43], s13 offen lds
    s_add_u32 s13, s14, 3
    s_sub_u32 s10, s13, 7
    s_cmp_ge_u32 s13, 7
    s_cselect_b32 s13, s10, s13
    s_mul_i32 s13, s13, 172032
    s_add_u32 s13, s13, s66
    s_add_u32 m0, s65, 102400
    s_nop 0
    buffer_load_dwordx4 v15, s[40:43], s13 offen lds
    s_add_u32 s13, s14, 4
    s_sub_u32 s10, s13, 7
    s_cmp_ge_u32 s13, 7
    s_cselect_b32 s13, s10, s13
    s_mul_i32 s13, s13, 172032
    s_add_u32 s13, s13, s66
    s_add_u32 m0, s65, 106496
    s_nop 0
    buffer_load_dwordx4 v15, s[40:43], s13 offen lds
    s_add_u32 s13, s14, 5
    s_sub_u32 s10, s13, 7
    s_cmp_ge_u32 s13, 7
    s_cselect_b32 s13, s10, s13
    s_mul_i32 s13, s13, 172032
    s_add_u32 s13, s13, s66
    s_add_u32 m0, s65, 110592
    s_nop 0
    buffer_load_dwordx4 v15, s[40:43], s13 offen lds
    s_add_u32 s13, s14, 6
    s_sub_u32 s10, s13, 7
    s_cmp_ge_u32 s13, 7
    s_cselect_b32 s13, s10, s13
    s_mul_i32 s13, s13, 172032
    s_add_u32 s13, s13, s66
    s_add_u32 m0, s65, 114688
    s_nop 0
    buffer_load_dwordx4 v15, s[40:43], s13 offen lds
    s_waitcnt lgkmcnt(0)
    v_readfirstlane_b32 s8, v6
    s_nop 1
    s_cmp_ge_u32 s8, 24
    s_cbranch_scc1 cw_11
    s_mov_b32 s69, 400000
wc_12:
    ds_read_b32 v6, v4 offset:76
    s_waitcnt lgkmcnt(0)
    v_readfirstlane_b32 s8, v6
    s_sub_u32 s69, s69, 1
    s_cmp_ge_u32 s8, 24
    s_cbranch_scc1 wc_12_d
    s_sleep 1
    s_cmp_lg_u32 s69, 0
    s_cbranch_scc1 wc_12
wc_12_d:
cw_11:
    ds_read_b64_tr_b16 v[112:113], v24 offset:40960
    ds_read_b64_tr_b16 v[114:115], v24 offset:41472
    ds_read_b64_tr_b16 v[116:117], v25 offset:40960
    ds_read_b64_tr_b16 v[118:119], v25 offset:41472
    ds_read_b64_tr_b16 v[120:121], v24 offset:43008
    ds_read_b64_tr_b16 v[122:123], v24 offset:43520
    ds_read_b64_tr_b16 v[124:125], v25 offset:43008
    ds_read_b64_tr_b16 v[126:127], v25 offset:43520
    ds_read_b64_tr_b16 v[128:129], v24 offset:45056
    ds_read_b64_tr_b16 v[130:131], v24 offset:45568
    ds_read_b64_tr_b16 v[132:133], v25 offset:45056
    ds_read_b64_tr_b16 v[134:135], v25 offset:45568
    ds_read_b64_tr_b16 v[136:137], v24 offset:47104
    ds_read_b64_tr_b16 v[138:139], v24 offset:47616
    ds_read_b64_tr_b16 v[140:141], v25 offset:47104
    ds_read_b64_tr_b16 v[142:143], v25 offset:47616
    s_waitcnt lgkmcnt(12)
    v_mfma_f32_32x32x16_bf16 v[32:47], v[112:115], v[224:227], v[32:47]
    v_mfma_f32_32x32x16_bf16 v[48:63], v[116:119], v[224:227], v[48:63]
    s_waitcnt vmcnt(7)
    ds_read_b128 v[240:243], v20 offset:0
    ds_read_b128 v[244:247], v21 offset:0
    ds_read_b128 v[248:251], v22 offset:0
    ds_read_b128 v[252:255], v23 offset:0
    s_mov_b64 exec, 1
    ds_add_u32 v4, v5 offset:76
    s_mov_b64 exec, -1
    s_waitcnt lgkmcnt(13)
    v_mfma_f32_32x32x16_bf16 v[32:47], v[120:123], v[228:231], v[32:47]
    v_mfma_f32_32x32x16_bf16 v[48:63], v[124:127], v[228:231], v[48:63]
    s_waitcnt lgkmcnt(9)
    v_mfma_f32_32x32x16_bf16 v[32:47], v[128:131], v[232:235], v[32:47]
    v_mfma_f32_32x32x16_bf16 v[48:63], v[132:135], v[232:235], v[48:63]
    s_waitcnt lgkmcnt(1)
    v_mfma_f32_32x32x16_bf16 v[32:47], v[136:139], v[236:239], v[32:47]
    v_mfma_f32_32x32x16_bf16 v[48:63], v[140:143], v[236:239], v[48:63]
    ds_read_b32 v6, v4 offset:76
    s_waitcnt lgkmcnt(0)
    v_readfirstlane_b32 s8, v6
    s_nop 1
    s_cmp_ge_u32 s8, 28
    s_cbranch_scc1 cw_13
    s_mov_b32 s69, 400000
wc_14:
    ds_read_b32 v6, v4 offset:76
    s_waitcnt lgkmcnt(0)
    v_readfirstlane_b32 s8, v6
    s_sub_u32 s69, s69, 1
    s_cmp_ge_u32 s8, 28
    s_cbranch_scc1 wc_14_d
    s_sleep 1
    s_cmp_lg_u32 s69, 0
    s_cbranch_scc1 wc_14
wc_14_d:
cw_13:
    ds_read_b64_tr_b16 v[80:81], v24 offset:49152
    ds_read_b64_tr_b16 v[82:83], v24 offset:49664
    ds_read_b64_tr_b16 v[84:85], v25 offset:49152
    ds_read_b64_tr_b16 v[86:87], v25 offset:49664
    ds_read_b64_tr_b16 v[88:89], v24 offset:51200
    ds_read_b64_tr_b16 v[90:91], v24 offset:51712
    ds_read_b64_tr_b16 v[92:93], v25 offset:51200
    ds_read_b64_tr_b16 v[94:95], v25 offset:51712
    ds_read_b64_tr_b16 v[96:97], v24 offset:53248
    ds_read_b64_tr_b16 v[98:99], v24 offset:53760
    ds_read_b64_tr_b16 v[100:101], v25 offset:53248
    ds_read_b64_tr_b16 v[102:103], v25 offset:53760
    ds_read_b64_tr_b16 v[104:105], v24 offset:55296
    ds_read_b64_tr_b16 v[106:107], v24 offset:55808
    ds_read_b64_tr_b16 v[108:109], v25 offset:55296
    ds_read_b64_tr_b16 v[110:111], v25 offset:55808
    s_waitcnt lgkmcnt(12)
    v_mfma_f32_32x32x16_bf16 v[32:47], v[80:83], v[240:243], v[32:47]
    v_mfma_f32_32x32x16_bf16 v[48:63], v[84:87], v[240:243], v[48:63]
    s_waitcnt lgkmcnt(8)
    v_mfma_f32_32x32x16_bf16 v[32:47], v[88:91], v[244:247], v[32:47]
    v_mfma_f32_32x32x16_bf16 v[48:63], v[92:95], v[244:247], v[48:63]
    s_waitcnt lgkmcnt(4)
    v_mfma_f32_32x32x16_bf16 v[32:47], v[96:99], v[248:251], v[32:47]
    v_mfma_f32_32x32x16_bf16 v[48:63], v[100:103], v[248:251], v[48:63]
    s_waitcnt lgkmcnt(0)
    v_mfma_f32_32x32x16_bf16 v[32:47], v[104:107], v[252:255], v[32:47]
    v_mfma_f32_32x32x16_bf16 v[48:63], v[108:111], v[252:255], v[48:63]
    s_lshl_b32 s10, s86, 7
    s_lshl_b32 s11, s4, 2
    s_add_u32 s10, s10, s11
    s_add_u32 s10, s10, s5
    s_lshl_b32 s10, s10, 11
    s_add_u32 s87, s10, 0
    s_add_u32 s88, s87, 131072
    s_nop 4
    v_cvt_pk_bf16_f32 v64, v32, v33
    v_cvt_pk_bf16_f32 v65, v34, v35
    v_cvt_pk_bf16_f32 v66, v36, v37
    v_cvt_pk_bf16_f32 v67, v38, v39
    v_cvt_pk_bf16_f32 v68, v40, v41
    v_cvt_pk_bf16_f32 v69, v42, v43
    v_cvt_pk_bf16_f32 v70, v44, v45
    v_cvt_pk_bf16_f32 v71, v46, v47
    v_cvt_pk_bf16_f32 v72, v48, v49
    v_cvt_pk_bf16_f32 v73, v50, v51
    v_cvt_pk_bf16_f32 v74, v52, v53
    v_cvt_pk_bf16_f32 v75, v54, v55
    v_cvt_pk_bf16_f32 v76, v56, v57
    v_cvt_pk_bf16_f32 v77, v58, v59
    v_cvt_pk_bf16_f32 v78, v60, v61
    v_cvt_pk_bf16_f32 v79, v62, v63
    s_mov_b32 exec_lo, 0
    v_mov_b32 v70, 0x3f803f80
    v_mov_b32 v71, 0x3f80
    v_mov_b32 v78, 0x3f803f80
    v_mov_b32 v79, 0x3f80
    s_mov_b64 exec, -1
    s_branch b_st1
b_v:
    s_waitcnt vmcnt(7)
    ds_read_b128 v[144:147], v20 offset:0
    ds_read_b128 v[148:151], v21 offset:0
    ds_read_b128 v[152:155], v22 offset:0
    ds_read_b128 v[156:159], v23 offset:0
    s_mov_b64 exec, 1
    ds_add_u32 v4, v5 offset:76
    s_mov_b64 exec, -1
    s_waitcnt lgkmcnt(1)
    ds_read_b32 v6, v4 offset:76
    s_add_u32 s13, s14, 2
    s_sub_u32 s10, s13, 7
    s_cmp_ge_u32 s13, 7
    s_cselect_b32 s13, s10, s13
    s_lshl_b32 s10, s13, 7
    s_add_u32 s10, s10, s6
    s_add_u32 m0, s11, 0
    s_nop 0
    buffer_load_dwordx4 v10, s[36:39], s10 offen lds
    s_add_u32 m0, s11, 1024
    s_nop 0
    buffer_load_dwordx4 v11, s[36:39], s10 offen lds
    s_add_u32 m0, s11, 2048
    s_nop 0
    buffer_load_dwordx4 v12, s[36:39], s10 offen lds
    s_add_u32 m0, s11, 3072
    s_nop 0
    buffer_load_dwordx4 v13, s[36:39], s10 offen lds
    s_add_u32 s13, s14, 2
    s_sub_u32 s10, s13, 7
    s_cmp_ge_u32 s13, 7
    s_cselect_b32 s13, s10, s13
    s_mul_i32 s13, s13, 172032
    s_add_u32 s13, s13, s7
    s_add_u32 m0, s12, 49152
    s_add_u32 s10, s13, 21504
    buffer_load_dwordx4 v14, s[40:43], s13 offen lds
    s_add_u32 m0, s12, 50176
    s_nop 0
    buffer_load_dwordx4 v14, s[40:43], s10 offen lds
    s_lshl_b32 s10, s89, 7
    s_add_u32 s10, s10, s68
    s_lshl_b32 s9, s89, 12
    s_add_u32 s9, s9, s65
    s_add_u32 m0, s9, 118784
    s_add_u32 s89, s89, 1
    buffer_load_dwordx4 v16, s[52:55], s10 offen lds
    s_cmp_eq_u32 s89, 7
    s_cselect_b32 s89, 0, s89
    s_lshl_b32 s10, s89, 7
    s_add_u32 s10, s10, s68
    s_lshl_b32 s9, s89, 12
    s_add_u32 s9, s9, s65
    s_add_u32 m0, s9, 118784
    s_add_u32 s89, s89, 1
    buffer_load_dwordx4 v16, s[52:55], s10 offen lds
    s_cmp_eq_u32 s89, 7
    s_cselect_b32 s89, 0, s89
    s_waitcnt lgkmcnt(0)
    v_readfirstlane_b32 s8, v6
    s_nop 1
    s_cmp_ge_u32 s8, 4
    s_cbranch_scc1 cw_15
    s_mov_b32 s69, 400000
wc_16:
    ds_read_b32 v6, v4 offset:76
    s_waitcnt lgkmcnt(0)
    v_readfirstlane_b32 s8, v6
    s_sub_u32 s69, s69, 1
    s_cmp_ge_u32 s8, 4
    s_cbranch_scc1 wc_16_d
    s_sleep 1
    s_cmp_lg_u32 s69, 0
    s_cbranch_scc1 wc_16
wc_16_d:
cw_15:
    ds_read_b64_tr_b16 v[80:81], v24 offset:0
    ds_read_b64_tr_b16 v[82:83], v24 offset:512
    ds_read_b64_tr_b16 v[84:85], v25 offset:0
    ds_read_b64_tr_b16 v[86:87], v25 offset:512
    ds_read_b64_tr_b16 v[88:89], v24 offset:2048
    ds_read_b64_tr_b16 v[90:91], v24 offset:2560
    ds_read_b64_tr_b16 v[92:93], v25 offset:2048
    ds_read_b64_tr_b16 v[94:95], v25 offset:2560
    ds_read_b64_tr_b16 v[96:97], v24 offset:4096
    ds_read_b64_tr_b16 v[98:99], v24 offset:4608
    ds_read_b64_tr_b16 v[100:101], v25 offset:4096
    ds_read_b64_tr_b16 v[102:103], v25 offset:4608
    ds_read_b64_tr_b16 v[104:105], v24 offset:6144
    ds_read_b64_tr_b16 v[106:107], v24 offset:6656
    ds_read_b64_tr_b16 v[108:109], v25 offset:6144
    ds_read_b64_tr_b16 v[110:111], v25 offset:6656
    s_waitcnt lgkmcnt(12)
    v_mfma_f32_32x32x16_bf16 v[32:47], v[144:147], v[80:83], 0
    v_mfma_f32_32x32x16_bf16 v[48:63], v[144:147], v[84:87], 0
    s_waitcnt vmcnt(8)
    ds_read_b128 v[160:163], v20 offset:16384
    ds_read_b128 v[164:167], v21 offset:16384
    ds_read_b128 v[168:171], v22 offset:16384
    ds_read_b128 v[172:175], v23 offset:16384
    s_mov_b64 exec, 1
    ds_add_u32 v4, v5 offset:76
    s_mov_b64 exec, -1
    s_waitcnt lgkmcnt(13)
    v_mfma_f32_32x32x16_bf16 v[32:47], v[148:151], v[88:91], v[32:47]
    v_mfma_f32_32x32x16_bf16 v[48:63], v[148:151], v[92:95], v[48:63]
    s_waitcnt lgkmcnt(9)
    v_mfma_f32_32x32x16_bf16 v[32:47], v[152:155], v[96:99], v[32:47]
    v_mfma_f32_32x32x16_bf16 v[48:63], v[152:155], v[100:103], v[48:63]
    s_waitcnt lgkmcnt(1)
    v_mfma_f32_32x32x16_bf16 v[32:47], v[156:159], v[104:107], v[32:47]
    v_mfma_f32_32x32x16_bf16 v[48:63], v[156:159], v[108:111], v[48:63]
    ds_read_b32 v6, v4 offset:76
    s_add_u32 s13, s14, 3
    s_sub_u32 s10, s13, 7
    s_cmp_ge_u32 s13, 7
    s_cselect_b32 s13, s10, s13
    s_lshl_b32 s10, s13, 7
    s_add_u32 s10, s10, s6
    s_add_u32 m0, s11, 16384
    s_nop 0
    buffer_load_dwordx4 v10, s[36:39], s10 offen lds
    s_add_u32 m0, s11, 17408
    s_nop 0
    buffer_load_dwordx4 v11, s[36:39], s10 offen lds
    s_add_u32 m0, s11, 18432
    s_nop 0
    buffer_load_dwordx4 v12, s[36:39], s10 offen lds
    s_add_u32 m0, s11, 19456
    s_nop 0
    buffer_load_dwordx4 v13, s[36:39], s10 offen lds
    s_add_u32 s13, s14, 3
    s_sub_u32 s10, s13, 7
    s_cmp_ge_u32 s13, 7
    s_cselect_b32 s13, s10, s13
    s_mul_i32 s13, s13, 172032
    s_add_u32 s13, s13, s7
    s_add_u32 m0, s12, 57344
    s_add_u32 s10, s13, 21504
    buffer_load_dwordx4 v14, s[40:43], s13 offen lds
    s_add_u32 m0, s12, 58368
    s_nop 0
    buffer_load_dwordx4 v14, s[40:43], s10 offen lds
    s_lshl_b32 s10, s89, 7
    s_add_u32 s10, s10, s68
    s_lshl_b32 s9, s89, 12
    s_add_u32 s9, s9, s65
    s_add_u32 m0, s9, 118784
    s_add_u32 s89, s89, 1
    buffer_load_dwordx4 v16, s[52:55], s10 offen lds
    s_cmp_eq_u32 s89, 7
    s_cselect_b32 s89, 0, s89
    s_lshl_b32 s10, s89, 7
    s_add_u32 s10, s10, s68
    s_lshl_b32 s9, s89, 12
    s_add_u32 s9, s9, s65
    s_add_u32 m0, s9, 118784
    s_add_u32 s89, s89, 1
    buffer_load_dwordx4 v16, s[52:55], s10 offen lds
    s_cmp_eq_u32 s89, 7
    s_cselect_b32 s89, 0, s89
    s_waitcnt lgkmcnt(0)
    v_readfirstlane_b32 s8, v6
    s_nop 1
    s_cmp_ge_u32 s8, 8
    s_cbranch_scc1 cw_17
    s_mov_b32 s69, 400000
wc_18:
    ds_read_b32 v6, v4 offset:76
    s_waitcnt lgkmcnt(0)
    v_readfirstlane_b32 s8, v6
    s_sub_u32 s69, s69, 1
    s_cmp_ge_u32 s8, 8
    s_cbranch_scc1 wc_18_d
    s_sleep 1
    s_cmp_lg_u32 s69, 0
    s_cbranch_scc1 wc_18
wc_18_d:
cw_17:
    ds_read_b64_tr_b16 v[112:113], v24 offset:8192
    ds_read_b64_tr_b16 v[114:115], v24 offset:8704
    ds_read_b64_tr_b16 v[116:117], v25 offset:8192
    ds_read_b64_tr_b16 v[118:119], v25 offset:8704
    ds_read_b64_tr_b16 v[120:121], v24 offset:10240
    ds_read_b64_tr_b16 v[122:123], v24 offset:10752
    ds_read_b64_tr_b16 v[124:125], v25 offset:10240
    ds_read_b64_tr_b16 v[126:127], v25 offset:10752
    ds_read_b64_tr_b16 v[128:129], v24 offset:12288
    ds_read_b64_tr_b16 v[130:131], v24 offset:12800
    ds_read_b64_tr_b16 v[132:133], v25 offset:12288
    ds_read_b64_tr_b16 v[134:135], v25 offset:12800
    ds_read_b64_tr_b16 v[136:137], v24 offset:14336
    ds_read_b64_tr_b16 v[138:139], v24 offset:14848
    ds_read_b64_tr_b16 v[140:141], v25 offset:14336
    ds_read_b64_tr_b16 v[142:143], v25 offset:14848
    s_waitcnt lgkmcnt(12)
    v_mfma_f32_32x32x16_bf16 v[32:47], v[160:163], v[112:115], v[32:47]
    v_mfma_f32_32x32x16_bf16 v[48:63], v[160:163], v[116:119], v[48:63]
    s_waitcnt vmcnt(10)
    ds_read_b128 v[176:179], v20 offset:0
    ds_read_b128 v[180:183], v21 offset:0
    ds_read_b128 v[184:187], v22 offset:0
    ds_read_b128 v[188:191], v23 offset:0
    s_mov_b64 exec, 1
    ds_add_u32 v4, v5 offset:76
    s_mov_b64 exec, -1
    s_waitcnt lgkmcnt(13)
    v_mfma_f32_32x32x16_bf16 v[32:47], v[164:167], v[120:123], v[32:47]
    v_mfma_f32_32x32x16_bf16 v[48:63], v[164:167], v[124:127], v[48:63]
    v_readfirstlane_b32 s34, v2
    s_mov_b32 s93, 0x00030003
    s_nop 1
    s_add_u32 s34, s34, 1
    s_mov_b32 s67, s34
    s_bfe_i32 s92, s34, 0x10000
    s_xor_b32 s92, s92, 0x6a39e5c1
    s_mul_i32 s34, s34, 0x9E3779B1
    v_and_b32 v27, 3, v1
    v_lshlrev_b32 v27, 2, v27
    v_lshrrev_b32 v27, v27, s92
    s_mov_b32 exec_lo, 0x10000000
    s_mov_b32 exec_hi, 0x10000000
    v_mov_b32 v27, 0
    s_mov_b64 exec, -1
    s_waitcnt lgkmcnt(9)
    v_mfma_f32_32x32x16_bf16 v[32:47], v[168:171], v[128:131], v[32:47]
    v_mfma_f32_32x32x16_bf16 v[48:63], v[168:171], v[132:135], v[48:63]
    s_waitcnt lgkmcnt(1)
    v_mfma_f32_32x32x16_bf16 v[32:47], v[172:175], v[136:139], v[32:47]
    v_mfma_f32_32x32x16_bf16 v[48:63], v[172:175], v[140:143], v[48:63]
    ds_read_b32 v6, v4 offset:76
    s_add_u32 s13, s14, 4
    s_sub_u32 s10, s13, 7
    s_cmp_ge_u32 s13, 7
    s_cselect_b32 s13, s10, s13
    s_lshl_b32 s10, s13, 7
    s_add_u32 s10, s10, s6
    s_add_u32 m0, s11, 0
    s_nop 0
    buffer_load_dwordx4 v10, s[36:39], s10 offen lds
    s_add_u32 m0, s11, 1024
    s_nop 0
    buffer_load_dwordx4 v11, s[36:39], s10 offen lds
    s_add_u32 m0, s11, 2048
    s_nop 0
    buffer_load_dwordx4 v12, s[36:39], s10 offen lds
    s_add_u32 m0, s11, 3072
    s_nop 0
    buffer_load_dwordx4 v13, s[36:39], s10 offen lds
    s_add_u32 s13, s14, 4
    s_sub_u32 s10, s13, 7
    s_cmp_ge_u32 s13, 7
    s_cselect_b32 s13, s10, s13
    s_mul_i32 s13, s13, 172032
    s_add_u32 s13, s13, s7
    s_add_u32 m0, s12, 65536
    s_add_u32 s10, s13, 21504
    buffer_load_dwordx4 v14, s[40:43], s13 offen lds
    s_add_u32 m0, s12, 66560
    s_nop 0
    buffer_load_dwordx4 v14, s[40:43], s10 offen lds
    s_lshl_b32 s10, s89, 7
    s_add_u32 s10, s10, s68
    s_lshl_b32 s9, s89, 12
    s_add_u32 s9, s9, s65
    s_add_u32 m0, s9, 118784
    s_add_u32 s89, s89, 1
    buffer_load_dwordx4 v16, s[52:55], s10 offen lds
    s_cmp_eq_u32 s89, 7
    s_cselect_b32 s89, 0, s89
    s_lshl_b32 s10, s89, 7
    s_add_u32 s10, s10, s68
    s_lshl_b32 s9, s89, 12
    s_add_u32 s9, s9, s65
    s_add_u32 m0, s9, 118784
    s_add_u32 s89, s89, 1
    buffer_load_dwordx4 v16, s[52:55], s10 offen lds
    s_cmp_eq_u32 s89, 7
    s_cselect_b32 s89, 0, s89
    s_waitcnt lgkmcnt(0)
    v_readfirstlane_b32 s8, v6
    s_nop 1
    s_cmp_ge_u32 s8, 12
    s_cbranch_scc1 cw_19
    s_mov_b32 s69, 400000
wc_20:
    ds_read_b32 v6, v4 offset:76
    s_waitcnt lgkmcnt(0)
    v_readfirstlane_b32 s8, v6
    s_sub_u32 s69, s69, 1
    s_cmp_ge_u32 s8, 12
    s_cbranch_scc1 wc_20_d
    s_sleep 1
    s_cmp_lg_u32 s69, 0
    s_cbranch_scc1 wc_20
wc_20_d:
cw_19:
    ds_read_b64_tr_b16 v[80:81], v24 offset:16384
    ds_read_b64_tr_b16 v[82:83], v24 offset:16896
    ds_read_b64_tr_b16 v[84:85], v25 offset:16384
    ds_read_b64_tr_b16 v[86:87], v25 offset:16896
    ds_read_b64_tr_b16 v[88:89], v24 offset:18432
    ds_read_b64_tr_b16 v[90:91], v24 offset:18944
    ds_read_b64_tr_b16 v[92:93], v25 offset:18432
    ds_read_b64_tr_b16 v[94:95], v25 offset:18944
    ds_read_b64_tr_b16 v[96:97], v24 offset:20480
    ds_read_b64_tr_b16 v[98:99], v24 offset:20992
    ds_read_b64_tr_b16 v[100:101], v25 offset:20480
    ds_read_b64_tr_b16 v[102:103], v25 offset:20992
    ds_read_b64_tr_b16 v[104:105], v24 offset:22528
    ds_read_b64_tr_b16 v[106:107], v24 offset:23040
    ds_read_b64_tr_b16 v[108:109], v25 offset:22528
    ds_read_b64_tr_b16 v[110:111], v25 offset:23040
    s_waitcnt lgkmcnt(12)
    v_mfma_f32_32x32x16_bf16 v[32:47], v[176:179], v[80:83], v[32:47]
    v_mfma_f32_32x32x16_bf16 v[48:63], v[176:179], v[84:87], v[48:63]
    s_waitcnt vmcnt(10)
    ds_read_b128 v[192:195], v20 offset:16384
    ds_read_b128 v[196:199], v21 offset:16384
    ds_read_b128 v[200:203], v22 offset:16384
    ds_read_b128 v[204:207], v23 offset:16384
    s_mov_b64 exec, 1
    ds_add_u32 v4, v5 offset:76
    s_mov_b64 exec, -1
    s_waitcnt lgkmcnt(13)
    v_mfma_f32_32x32x16_bf16 v[32:47], v[180:183], v[88:91], v[32:47]
    v_mfma_f32_32x32x16_bf16 v[48:63], v[180:183], v[92:95], v[48:63]
    s_waitcnt lgkmcnt(9)
    v_mfma_f32_32x32x16_bf16 v[32:47], v[184:187], v[96:99], v[32:47]
    v_mfma_f32_32x32x16_bf16 v[48:63], v[184:187], v[100:103], v[48:63]
    s_waitcnt lgkmcnt(1)
    v_mfma_f32_32x32x16_bf16 v[32:47], v[188:191], v[104:107], v[32:47]
    v_mfma_f32_32x32x16_bf16 v[48:63], v[188:191], v[108:111], v[48:63]
    ds_read_b32 v6, v4 offset:76
    s_add_u32 s13, s14, 5
    s_sub_u32 s10, s13, 7
    s_cmp_ge_u32 s13, 7
    s_cselect_b32 s13, s10, s13
    s_lshl_b32 s10, s13, 7
    s_add_u32 s10, s10, s6
    s_add_u32 m0, s11, 16384
    s_nop 0
    buffer_load_dwordx4 v10, s[36:39], s10 offen lds
    s_add_u32 m0, s11, 17408
    s_nop 0
    buffer_load_dwordx4 v11, s[36:39], s10 offen lds
    s_add_u32 m0, s11, 18432
    s_nop 0
    buffer_load_dwordx4 v12, s[36:39], s10 offen lds
    s_add_u32 m0, s11, 19456
    s_nop 0
    buffer_load_dwordx4 v13, s[36:39], s10 offen lds
    s_add_u32 s13, s14, 5
    s_sub_u32 s10, s13, 7
    s_cmp_ge_u32 s13, 7
    s_cselect_b32 s13, s10, s13
    s_mul_i32 s13, s13, 172032
    s_add_u32 s13, s13, s7
    s_add_u32 m0, s12, 73728
    s_add_u32 s10, s13, 21504
    buffer_load_dwordx4 v14, s[40:43], s13 offen lds
    s_add_u32 m0, s12, 74752
    s_nop 0
    buffer_load_dwordx4 v14, s[40:43], s10 offen lds
    s_lshl_b32 s10, s89, 7
    s_add_u32 s10, s10, s68
    s_lshl_b32 s9, s89, 12
    s_add_u32 s9, s9, s65
    s_add_u32 m0, s9, 118784
    s_add_u32 s89, s89, 1
    buffer_load_dwordx4 v16, s[52:55], s10 offen lds
    s_cmp_eq_u32 s89, 7
    s_cselect_b32 s89, 0, s89
    s_mov_b32 m0, 163692
    s_mov_b32 s9, 11010048
    s_mov_b64 exec, 1
    buffer_load_dword v7, s[44:47], s9 offen sc1 lds
    s_lshl_b32 s9, s35, 2
    s_add_u32 m0, s9, 163696
    s_nop 0
    buffer_load_dword v7, s[56:59], 0 offen lds
    s_mov_b64 exec, -1
    s_waitcnt lgkmcnt(0)
    v_readfirstlane_b32 s8, v6
    s_nop 1
    s_cmp_ge_u32 s8, 16
    s_cbranch_scc1 cw_21
    s_mov_b32 s69, 400000
wc_22:
    ds_read_b32 v6, v4 offset:76
    s_waitcnt lgkmcnt(0)
    v_readfirstlane_b32 s8, v6
    s_sub_u32 s69, s69, 1
    s_cmp_ge_u32 s8, 16
    s_cbranch_scc1 wc_22_d
    s_sleep 1
    s_cmp_lg_u32 s69, 0
    s_cbranch_scc1 wc_22
wc_22_d:
cw_21:
    ds_read_b64_tr_b16 v[112:113], v24 offset:24576
    ds_read_b64_tr_b16 v[114:115], v24 offset:25088
    ds_read_b64_tr_b16 v[116:117], v25 offset:24576
    ds_read_b64_tr_b16 v[118:119], v25 offset:25088
    ds_read_b64_tr_b16 v[120:121], v24 offset:26624
    ds_read_b64_tr_b16 v[122:123], v24 offset:27136
    ds_read_b64_tr_b16 v[124:125], v25 offset:26624
    ds_read_b64_tr_b16 v[126:127], v25 offset:27136
    ds_read_b64_tr_b16 v[128:129], v24 offset:28672
    ds_read_b64_tr_b16 v[130:131], v24 offset:29184
    ds_read_b64_tr_b16 v[132:133], v25 offset:28672
    ds_read_b64_tr_b16 v[134:135], v25 offset:29184
    ds_read_b64_tr_b16 v[136:137], v24 offset:30720
    ds_read_b64_tr_b16 v[138:139], v24 offset:31232
    ds_read_b64_tr_b16 v[140:141], v25 offset:30720
    ds_read_b64_tr_b16 v[142:143], v25 offset:31232
    s_waitcnt lgkmcnt(12)
    v_mfma_f32_32x32x16_bf16 v[32:47], v[192:195], v[112:115], v[32:47]
    v_mfma_f32_32x32x16_bf16 v[48:63], v[192:195], v[116:119], v[48:63]
    s_waitcnt vmcnt(11)
    ds_read_b128 v[208:211], v20 offset:0
    ds_read_b128 v[212:215], v21 offset:0
    ds_read_b128 v[216:219], v22 offset:0
    ds_read_b128 v[220:223], v23 offset:0
    s_mov_b64 exec, 1
    ds_add_u32 v4, v5 offset:76
    s_mov_b64 exec, -1
    s_waitcnt lgkmcnt(13)
    v_mfma_f32_32x32x16_bf16 v[32:47], v[196:199], v[120:123], v[32:47]
    v_mfma_f32_32x32x16_bf16 v[48:63], v[196:199], v[124:127], v[48:63]
    s_waitcnt lgkmcnt(9)
    v_mfma_f32_32x32x16_bf16 v[32:47], v[200:203], v[128:131], v[32:47]
    v_mfma_f32_32x32x16_bf16 v[48:63], v[200:203], v[132:135], v[48:63]
    s_waitcnt lgkmcnt(1)
    v_mfma_f32_32x32x16_bf16 v[32:47], v[204:207], v[136:139], v[32:47]
    v_mfma_f32_32x32x16_bf16 v[48:63], v[204:207], v[140:143], v[48:63]
    ds_read_b32 v6, v4 offset:76
    s_add_u32 s13, s14, 6
    s_sub_u32 s10, s13, 7
    s_cmp_ge_u32 s13, 7
    s_cselect_b32 s13, s10, s13
    s_lshl_b32 s10, s13, 7
    s_add_u32 s10, s10, s6
    s_add_u32 m0, s11, 0
    s_nop 0
    buffer_load_dwordx4 v10, s[36:39], s10 offen lds
    s_add_u32 m0, s11, 1024
    s_nop 0
    buffer_load_dwordx4 v11, s[36:39], s10 offen lds
    s_add_u32 m0, s11, 2048
    s_nop 0
    buffer_load_dwordx4 v12, s[36:39], s10 offen lds
    s_add_u32 m0, s11, 3072
    s_nop 0
    buffer_load_dwordx4 v13, s[36:39], s10 offen lds
    s_add_u32 s13, s14, 6
    s_sub_u32 s10, s13, 7
    s_cmp_ge_u32 s13, 7
    s_cselect_b32 s13, s10, s13
    s_mul_i32 s13, s13, 172032
    s_add_u32 s13, s13, s7
    s_add_u32 m0, s12, 81920
    s_add_u32 s10, s13, 21504
    buffer_load_dwordx4 v14, s[40:43], s13 offen lds
    s_add_u32 m0, s12, 82944
    s_nop 0
    buffer_load_dwordx4 v14, s[40:43], s10 offen lds
    s_waitcnt lgkmcnt(0)
    v_readfirstlane_b32 s8, v6
    s_nop 1
    s_cmp_ge_u32 s8, 20
    s_cbranch_scc1 cw_23
    s_mov_b32 s69, 400000
wc_24:
    ds_read_b32 v6, v4 offset:76
    s_waitcnt lgkmcnt(0)
    v_readfirstlane_b32 s8, v6
    s_sub_u32 s69, s69, 1
    s_cmp_ge_u32 s8, 20
    s_cbranch_scc1 wc_24_d
    s_sleep 1
    s_cmp_lg_u32 s69, 0
    s_cbranch_scc1 wc_24
wc_24_d:
cw_23:
    ds_read_b64_tr_b16 v[80:81], v24 offset:32768
    ds_read_b64_tr_b16 v[82:83], v24 offset:33280
    ds_read_b64_tr_b16 v[84:85], v25 offset:32768
    ds_read_b64_tr_b16 v[86:87], v25 offset:33280
    ds_read_b64_tr_b16 v[88:89], v24 offset:34816
    ds_read_b64_tr_b16 v[90:91], v24 offset:35328
    ds_read_b64_tr_b16 v[92:93], v25 offset:34816
    ds_read_b64_tr_b16 v[94:95], v25 offset:35328
    ds_read_b64_tr_b16 v[96:97], v24 offset:36864
    ds_read_b64_tr_b16 v[98:99], v24 offset:37376
    ds_read_b64_tr_b16 v[100:101], v25 offset:36864
    ds_read_b64_tr_b16 v[102:103], v25 offset:37376
    ds_read_b64_tr_b16 v[104:105], v24 offset:38912
    ds_read_b64_tr_b16 v[106:107], v24 offset:39424
    ds_read_b64_tr_b16 v[108:109], v25 offset:38912
    ds_read_b64_tr_b16 v[110:111], v25 offset:39424
    s_waitcnt lgkmcnt(12)
    v_mfma_f32_32x32x16_bf16 v[32:47], v[208:211], v[80:83], v[32:47]
    v_mfma_f32_32x32x16_bf16 v[48:63], v[208:211], v[84:87], v[48:63]
    s_waitcnt vmcnt(9)
    ds_read_b128 v[224:227], v20 offset:16384
    ds_read_b128 v[228:231], v21 offset:16384
    ds_read_b128 v[232:235], v22 offset:16384
    ds_read_b128 v[236:239], v23 offset:16384
    s_mov_b64 exec, 1
    ds_add_u32 v4, v5 offset:76
    s_mov_b64 exec, -1
    s_waitcnt lgkmcnt(13)
    v_mfma_f32_32x32x16_bf16 v[32:47], v[212:215], v[88:91], v[32:47]
    v_mfma_f32_32x32x16_bf16 v[48:63], v[212:215], v[92:95], v[48:63]
    s_waitcnt lgkmcnt(9)
    v_mfma_f32_32x32x16_bf16 v[32:47], v[216:219], v[96:99], v[32:47]
    v_mfma_f32_32x32x16_bf16 v[48:63], v[216:219], v[100:103], v[48:63]
    s_waitcnt lgkmcnt(1)
    v_mfma_f32_32x32x16_bf16 v[32:47], v[220:223], v[104:107], v[32:47]
    v_mfma_f32_32x32x16_bf16 v[48:63], v[220:223], v[108:111], v[48:63]
    ds_read_b32 v6, v4 offset:76
    s_mov_b32 s13, s14
    s_mul_i32 s13, s13, 172032
    s_add_u32 s13, s13, s66
    s_add_u32 m0, s65, 90112
    s_nop 0
    buffer_load_dwordx4 v15, s[40:43], s13 offen lds
    s_add_u32 s13, s14, 1
    s_sub_u32 s10, s13, 7
    s_cmp_ge_u32 s13, 7
    s_cselect_b32 s13, s10, s13
    s_mul_i32 s13, s13, 172032
    s_add_u32 s13, s13, s66
    s_add_u32 m0, s65, 94208
    s_nop 0
    buffer_load_dwordx4 v15, s[40:43], s13 offen lds
    s_add_u32 s13, s14, 2
    s_sub_u32 s10, s13, 7
    s_cmp_ge_u32 s13, 7
    s_cselect_b32 s13, s10, s13
    s_mul_i32 s13, s13, 172032
    s_add_u32 s13, s13, s66
    s_add_u32 m0, s65, 98304
    s_nop 0
    buffer_load_dwordx4 v15, s[40:43], s13 offen lds
    s_add_u32 s13, s14, 3
    s_sub_u32 s10, s13, 7
    s_cmp_ge_u32 s13, 7
    s_cselect_b32 s13, s10, s13
    s_mul_i32 s13, s13, 172032
    s_add_u32 s13, s13, s66
    s_add_u32 m0, s65, 102400
    s_nop 0
    buffer_load_dwordx4 v15, s[40:43], s13 offen lds
    s_add_u32 s13, s14, 4
    s_sub_u32 s10, s13, 7
    s_cmp_ge_u32 s13, 7
    s_cselect_b32 s13, s10, s13
    s_mul_i32 s13, s13, 172032
    s_add_u32 s13, s13, s66
    s_add_u32 m0, s65, 106496
    s_nop 0
    buffer_load_dwordx4 v15, s[40:43], s13 offen lds
    s_add_u32 s13, s14, 5
    s_sub_u32 s10, s13, 7
    s_cmp_ge_u32 s13, 7
    s_cselect_b32 s13, s10, s13
    s_mul_i32 s13, s13, 172032
    s_add_u32 s13, s13, s66
    s_add_u32 m0, s65, 110592
    s_nop 0
    buffer_load_dwordx4 v15, s[40:43], s13 offen lds
    s_add_u32 s13, s14, 6
    s_sub_u32 s10, s13, 7
    s_cmp_ge_u32 s13, 7
    s_cselect_b32 s13, s10, s13
    s_mul_i32 s13, s13, 172032
    s_add_u32 s13, s13, s66
    s_add_u32 m0, s65, 114688
    s_nop 0
    buffer_load_dwordx4 v15, s[40:43], s13 offen lds
    s_waitcnt lgkmcnt(0)
    v_readfirstlane_b32 s8, v6
    s_nop 1
    s_cmp_ge_u32 s8, 24
    s_cbranch_scc1 cw_25
    s_mov_b32 s69, 400000
wc_26:
    ds_read_b32 v6, v4 offset:76
    s_waitcnt lgkmcnt(0)
    v_readfirstlane_b32 s8, v6
    s_sub_u32 s69, s69, 1
    s_cmp_ge_u32 s8, 24
    s_cbranch_scc1 wc_26_d
    s_sleep 1
    s_cmp_lg_u32 s69, 0
    s_cbranch_scc1 wc_26
wc_26_d:
cw_25:
    ds_read_b64_tr_b16 v[112:113], v24 offset:40960
    ds_read_b64_tr_b16 v[114:115], v24 offset:41472
    ds_read_b64_tr_b16 v[116:117], v25 offset:40960
    ds_read_b64_tr_b16 v[118:119], v25 offset:41472
    ds_read_b64_tr_b16 v[120:121], v24 offset:43008
    ds_read_b64_tr_b16 v[122:123], v24 offset:43520
    ds_read_b64_tr_b16 v[124:125], v25 offset:43008
    ds_read_b64_tr_b16 v[126:127], v25 offset:43520
    ds_read_b64_tr_b16 v[128:129], v24 offset:45056
    ds_read_b64_tr_b16 v[130:131], v24 offset:45568
    ds_read_b64_tr_b16 v[132:133], v25 offset:45056
    ds_read_b64_tr_b16 v[134:135], v25 offset:45568
    ds_read_b64_tr_b16 v[136:137], v24 offset:47104
    ds_read_b64_tr_b16 v[138:139], v24 offset:47616
    ds_read_b64_tr_b16 v[140:141], v25 offset:47104
    ds_read_b64_tr_b16 v[142:143], v25 offset:47616
    s_waitcnt lgkmcnt(12)
    v_mfma_f32_32x32x16_bf16 v[32:47], v[224:227], v[112:115], v[32:47]
    v_mfma_f32_32x32x16_bf16 v[48:63], v[224:227], v[116:119], v[48:63]
    s_waitcnt vmcnt(7)
    ds_read_b128 v[240:243], v20 offset:0
    ds_read_b128 v[244:247], v21 offset:0
    ds_read_b128 v[248:251], v22 offset:0
    ds_read_b128 v[252:255], v23 offset:0
    s_mov_b64 exec, 1
    ds_add_u32 v4, v5 offset:76
    s_mov_b64 exec, -1
    s_waitcnt lgkmcnt(13)
    v_mfma_f32_32x32x16_bf16 v[32:47], v[228:231], v[120:123], v[32:47]
    v_mfma_f32_32x32x16_bf16 v[48:63], v[228:231], v[124:127], v[48:63]
    s_waitcnt lgkmcnt(9)
    v_mfma_f32_32x32x16_bf16 v[32:47], v[232:235], v[128:131], v[32:47]
    v_mfma_f32_32x32x16_bf16 v[48:63], v[232:235], v[132:135], v[48:63]
    s_waitcnt lgkmcnt(1)
    v_mfma_f32_32x32x16_bf16 v[32:47], v[236:239], v[136:139], v[32:47]
    v_mfma_f32_32x32x16_bf16 v[48:63], v[236:239], v[140:143], v[48:63]
    ds_read_b32 v6, v4 offset:76
    s_waitcnt lgkmcnt(0)
    v_readfirstlane_b32 s8, v6
    s_nop 1
    s_cmp_ge_u32 s8, 28
    s_cbranch_scc1 cw_27
    s_mov_b32 s69, 400000
wc_28:
    ds_read_b32 v6, v4 offset:76
    s_waitcnt lgkmcnt(0)
    v_readfirstlane_b32 s8, v6
    s_sub_u32 s69, s69, 1
    s_cmp_ge_u32 s8, 28
    s_cbranch_scc1 wc_28_d
    s_sleep 1
    s_cmp_lg_u32 s69, 0
    s_cbranch_scc1 wc_28
wc_28_d:
cw_27:
    ds_read_b64_tr_b16 v[80:81], v24 offset:49152
    ds_read_b64_tr_b16 v[82:83], v24 offset:49664
    ds_read_b64_tr_b16 v[84:85], v25 offset:49152
    ds_read_b64_tr_b16 v[86:87], v25 offset:49664
    ds_read_b64_tr_b16 v[88:89], v24 offset:51200
    ds_read_b64_tr_b16 v[90:91], v24 offset:51712
    ds_read_b64_tr_b16 v[92:93], v25 offset:51200
    ds_read_b64_tr_b16 v[94:95], v25 offset:51712
    ds_read_b64_tr_b16 v[96:97], v24 offset:53248
    ds_read_b64_tr_b16 v[98:99], v24 offset:53760
    ds_read_b64_tr_b16 v[100:101], v25 offset:53248
    ds_read_b64_tr_b16 v[102:103], v25 offset:53760
    ds_read_b64_tr_b16 v[104:105], v24 offset:55296
    ds_read_b64_tr_b16 v[106:107], v24 offset:55808
    ds_read_b64_tr_b16 v[108:109], v25 offset:55296
    ds_read_b64_tr_b16 v[110:111], v25 offset:55808
    s_waitcnt lgkmcnt(12)
    v_mfma_f32_32x32x16_bf16 v[32:47], v[240:243], v[80:83], v[32:47]
    v_mfma_f32_32x32x16_bf16 v[48:63], v[240:243], v[84:87], v[48:63]
    s_waitcnt lgkmcnt(8)
    v_mfma_f32_32x32x16_bf16 v[32:47], v[244:247], v[88:91], v[32:47]
    v_mfma_f32_32x32x16_bf16 v[48:63], v[244:247], v[92:95], v[48:63]
    s_waitcnt lgkmcnt(4)
    v_mfma_f32_32x32x16_bf16 v[32:47], v[248:251], v[96:99], v[32:47]
    v_mfma_f32_32x32x16_bf16 v[48:63], v[248:251], v[100:103], v[48:63]
    s_waitcnt lgkmcnt(0)
    v_mfma_f32_32x32x16_bf16 v[32:47], v[252:255], v[104:107], v[32:47]
    v_mfma_f32_32x32x16_bf16 v[48:63], v[252:255], v[108:111], v[48:63]
    s_lshl_b32 s10, s86, 7
    s_lshl_b32 s11, s4, 2
    s_add_u32 s10, s10, s11
    s_add_u32 s10, s10, s5
    s_lshl_b32 s10, s10, 11
    s_add_u32 s87, s10, 2097152
    s_add_u32 s88, s87, 131072
    s_nop 4
    v_cvt_pk_bf16_f32 v64, v32, v33
    v_cvt_pk_bf16_f32 v65, v34, v35
    v_cvt_pk_bf16_f32 v66, v36, v37
    v_cvt_pk_bf16_f32 v67, v38, v39
    v_cvt_pk_bf16_f32 v68, v40, v41
    v_cvt_pk_bf16_f32 v69, v42, v43
    v_cvt_pk_bf16_f32 v70, v44, v45
    v_cvt_pk_bf16_f32 v71, v46, v47
    v_cvt_pk_bf16_f32 v72, v48, v49
    v_cvt_pk_bf16_f32 v73, v50, v51
    v_cvt_pk_bf16_f32 v74, v52, v53
    v_cvt_pk_bf16_f32 v75, v54, v55
    v_cvt_pk_bf16_f32 v76, v56, v57
    v_cvt_pk_bf16_f32 v77, v58, v59
    v_cvt_pk_bf16_f32 v78, v60, v61
    v_cvt_pk_bf16_f32 v79, v62, v63
    s_mov_b32 exec_lo, 0xf0000000
    s_mov_b32 exec_hi, 0xf0000000
    v_and_b32 v6, 3, v1
    v_cmp_eq_u32 vcc, 0, v6
    v_mov_b32 v6, 0x3f803f80
    v_cndmask_b32 v6, 0, v6, vcc
    v_mov_b32 v64, v6
    v_mov_b32 v65, v6
    v_mov_b32 v66, v6
    v_mov_b32 v67, v6
    v_mov_b32 v68, v6
    v_mov_b32 v69, v6
    v_mov_b32 v70, v6
    v_mov_b32 v71, v6
    v_mov_b32 v72, v6
    v_mov_b32 v73, v6
    v_mov_b32 v74, v6
    v_mov_b32 v75, v6
    v_mov_b32 v76, v6
    v_mov_b32 v77, v6
    v_mov_b32 v78, v6
    v_mov_b32 v79, v6
    s_mov_b64 exec, -1
b_st1:
    s_setprio 2
    v_bfi_b32 v64, s93, v27, v64
    v_bfi_b32 v68, s93, v27, v68
    v_bfi_b32 v72, s93, v27, v72
    v_bfi_b32 v76, s93, v27, v76
    s_waitcnt vmcnt(0)
    s_mov_b64 exec, 1
    ds_add_u32 v4, v5 offset:88
    s_mov_b64 exec, -1
    s_add_u32 s10, s87, 16777216
    s_add_u32 s11, s88, 16777216
    buffer_store_dwordx4 v[64:67], v3, s[44:47], s10 offen offset:0
    buffer_store_dwordx4 v[68:71], v3, s[44:47], s10 offen offset:1024
    buffer_store_dwordx4 v[72:75], v3, s[44:47], s11 offen offset:0
    buffer_store_dwordx4 v[76:79], v3, s[44:47], s11 offen offset:1024
    s_lshl_b32 s13, s5, 12
    s_add_u32 s13, s13, 16384
    v_add_u32 v7, s13, v3
    ds_write_b128 v7, v[64:67] offset:0
    ds_write_b128 v7, v[68:71] offset:1024
    ds_write_b128 v7, v[72:75] offset:2048
    ds_write_b128 v7, v[76:79] offset:3072
    s_mov_b32 s10, 0x3e8b97f6
    s_mov_b32 s11, s10
    s_lshl_b32 s13, s5, 12
    s_add_u32 s13, s13, 0
    v_add_u32 v31, s13, v3
    s_lshl_b32 s12, s4, 2
    s_lshl_b32 s13, s5, 3
    s_add_u32 s12, s12, s13
    s_lshl_b32 s15, s3, 17
    s_and_b32 s13, s60, 1
    s_lshl_b32 s13, s13, 16
    s_add_u32 s15, s15, s13
    s_xor_b32 s68, s15, 0x10000
    s_add_u32 s15, s15, 16777216
    s_mov_b32 s64, 0
    s_mov_b32 s66, 4
    s_mov_b32 s14, 20000
    s_lshl_b32 s65, s12, 11
    v_add_u32 v2, 2097152, v3
    s_mov_b32 s69, 400000
wc_29:
    ds_read_b32 v6, v4 offset:88
    s_waitcnt lgkmcnt(0)
    v_readfirstlane_b32 s8, v6
    s_sub_u32 s69, s69, 1
    s_cmp_ge_u32 s8, 4
    s_cbranch_scc1 wc_29_d
    s_sleep 1
    s_cmp_lg_u32 s69, 0
    s_cbranch_scc1 wc_29
wc_29_d:
    ds_read_b64_tr_b16 v[96:97], v26 offset:0
    ds_read_b64_tr_b16 v[98:99], v26 offset:256
    ds_read_b64_tr_b16 v[100:101], v26 offset:1024
    ds_read_b64_tr_b16 v[102:103], v26 offset:1280
    ds_read_b64_tr_b16 v[104:105], v26 offset:2048
    ds_read_b64_tr_b16 v[106:107], v26 offset:2304
    ds_read_b64_tr_b16 v[108:109], v26 offset:3072
    ds_read_b64_tr_b16 v[110:111], v26 offset:3328
    ds_read_b64_tr_b16 v[112:113], v26 offset:4096
    ds_read_b64_tr_b16 v[114:115], v26 offset:4352
    ds_read_b64_tr_b16 v[116:117], v26 offset:5120
    ds_read_b64_tr_b16 v[118:119], v26 offset:5376
    ds_read_b64_tr_b16 v[120:121], v26 offset:6144
    ds_read_b64_tr_b16 v[122:123], v26 offset:6400
    ds_read_b64_tr_b16 v[124:125], v26 offset:7168
    ds_read_b64_tr_b16 v[126:127], v26 offset:7424
    s_waitcnt lgkmcnt(8)
    v_mfma_f32_32x32x16_bf16 v[40:55], v[96:99], v[144:147], 0
    v_mfma_f32_32x32x16_bf16 v[40:55], v[100:103], v[148:151], v[40:55]
    v_mfma_f32_32x32x16_bf16 v[40:55], v[104:107], v[152:155], v[40:55]
    v_mfma_f32_32x32x16_bf16 v[40:55], v[108:111], v[156:159], v[40:55]
    ds_read_b64_tr_b16 v[128:129], v26 offset:8192
    ds_read_b64_tr_b16 v[130:131], v26 offset:8448
    ds_read_b64_tr_b16 v[132:133], v26 offset:9216
    ds_read_b64_tr_b16 v[134:135], v26 offset:9472
    ds_read_b64_tr_b16 v[136:137], v26 offset:10240
    ds_read_b64_tr_b16 v[138:139], v26 offset:10496
    ds_read_b64_tr_b16 v[140:141], v26 offset:11264
    ds_read_b64_tr_b16 v[142:143], v26 offset:11520
    s_waitcnt lgkmcnt(8)
    v_mfma_f32_32x32x16_bf16 v[40:55], v[112:115], v[160:163], v[40:55]
    v_mfma_f32_32x32x16_bf16 v[40:55], v[116:119], v[164:167], v[40:55]
    v_mfma_f32_32x32x16_bf16 v[40:55], v[120:123], v[168:171], v[40:55]
    v_mfma_f32_32x32x16_bf16 v[40:55], v[124:127], v[172:175], v[40:55]
    ds_read_b64_tr_b16 v[96:97], v26 offset:12288
    ds_read_b64_tr_b16 v[98:99], v26 offset:12544
    ds_read_b64_tr_b16 v[100:101], v26 offset:13312
    ds_read_b64_tr_b16 v[102:103], v26 offset:13568
    ds_read_b64_tr_b16 v[104:105], v26 offset:14336
    ds_read_b64_tr_b16 v[106:107], v26 offset:14592
    ds_read_b64_tr_b16 v[108:109], v26 offset:15360
    ds_read_b64_tr_b16 v[110:111], v26 offset:15616
    s_waitcnt lgkmcnt(8)
    v_mfma_f32_32x32x16_bf16 v[40:55], v[128:131], v[176:179], v[40:55]
    v_mfma_f32_32x32x16_bf16 v[40:55], v[132:135], v[180:183], v[40:55]
    v_mfma_f32_32x32x16_bf16 v[40:55], v[136:139], v[184:187], v[40:55]
    v_mfma_f32_32x32x16_bf16 v[40:55], v[140:143], v[188:191], v[40:55]
    ds_read_b64_tr_b16 v[112:113], v26 offset:16384
    ds_read_b64_tr_b16 v[114:115], v26 offset:16640
    ds_read_b64_tr_b16 v[116:117], v26 offset:17408
    ds_read_b64_tr_b16 v[118:119], v26 offset:17664
    ds_read_b64_tr_b16 v[120:121], v26 offset:18432
    ds_read_b64_tr_b16 v[122:123], v26 offset:18688
    ds_read_b64_tr_b16 v[124:125], v26 offset:19456
    ds_read_b64_tr_b16 v[126:127], v26 offset:19712
    s_add_u32 s13, s65, 0
    s_and_b32 s13, s13, 0xffff
    s_add_u32 s13, s13, s15
    s_add_u32 s6, s32, s13
    s_addc_u32 s7, s33, 0
    global_load_dwordx4 v[160:163], v3, s[6:7] offset:0 sc1
    global_load_dwordx4 v[164:167], v3, s[6:7] offset:1024 sc1
    global_load_dwordx4 v[168:171], v2, s[6:7] offset:0 sc1
    global_load_dwordx4 v[172:175], v2, s[6:7] offset:1024 sc1
    s_waitcnt lgkmcnt(8)
    v_mfma_f32_32x32x16_bf16 v[40:55], v[96:99], v[192:195], v[40:55]
    v_mfma_f32_32x32x16_bf16 v[40:55], v[100:103], v[196:199], v[40:55]
    v_mfma_f32_32x32x16_bf16 v[40:55], v[104:107], v[200:203], v[40:55]
    v_mfma_f32_32x32x16_bf16 v[40:55], v[108:111], v[204:207], v[40:55]
    ds_read_b64_tr_b16 v[128:129], v26 offset:20480
    ds_read_b64_tr_b16 v[130:131], v26 offset:20736
    ds_read_b64_tr_b16 v[132:133], v26 offset:21504
    ds_read_b64_tr_b16 v[134:135], v26 offset:21760
    ds_read_b64_tr_b16 v[136:137], v26 offset:22528
    ds_read_b64_tr_b16 v[138:139], v26 offset:22784
    ds_read_b64_tr_b16 v[140:141], v26 offset:23552
    ds_read_b64_tr_b16 v[142:143], v26 offset:23808
    s_add_u32 s13, s65, 2048
    s_and_b32 s13, s13, 0xffff
    s_add_u32 s13, s13, s15
    s_add_u32 s6, s32, s13
    s_addc_u32 s7, s33, 0
    global_load_dwordx4 v[176:179], v3, s[6:7] offset:0 sc1
    global_load_dwordx4 v[180:183], v3, s[6:7] offset:1024 sc1
    global_load_dwordx4 v[184:187], v2, s[6:7] offset:0 sc1
    global_load_dwordx4 v[188:191], v2, s[6:7] offset:1024 sc1
    s_waitcnt lgkmcnt(8)
    v_mfma_f32_32x32x16_bf16 v[40:55], v[112:115], v[208:211], v[40:55]
    v_mfma_f32_32x32x16_bf16 v[40:55], v[116:119], v[212:215], v[40:55]
    v_mfma_f32_32x32x16_bf16 v[40:55], v[120:123], v[216:219], v[40:55]
    v_mfma_f32_32x32x16_bf16 v[40:55], v[124:127], v[220:223], v[40:55]
    ds_read_b64_tr_b16 v[96:97], v26 offset:24576
    ds_read_b64_tr_b16 v[98:99], v26 offset:24832
    ds_read_b64_tr_b16 v[100:101], v26 offset:25600
    ds_read_b64_tr_b16 v[102:103], v26 offset:25856
    ds_read_b64_tr_b16 v[104:105], v26 offset:26624
    ds_read_b64_tr_b16 v[106:107], v26 offset:26880
    ds_read_b64_tr_b16 v[108:109], v26 offset:27648
    ds_read_b64_tr_b16 v[110:111], v26 offset:27904
    s_waitcnt lgkmcnt(8)
    v_mfma_f32_32x32x16_bf16 v[40:55], v[128:131], v[224:227], v[40:55]
    v_mfma_f32_32x32x16_bf16 v[40:55], v[132:135], v[228:231], v[40:55]
    v_mfma_f32_32x32x16_bf16 v[40:55], v[136:139], v[232:235], v[40:55]
    v_mfma_f32_32x32x16_bf16 v[40:55], v[140:143], v[236:239], v[40:55]
    s_waitcnt lgkmcnt(0)
    v_mfma_f32_32x32x16_bf16 v[40:55], v[96:99], v[240:243], v[40:55]
    v_mfma_f32_32x32x16_bf16 v[40:55], v[100:103], v[244:247], v[40:55]
    v_mfma_f32_32x32x16_bf16 v[40:55], v[104:107], v[248:251], v[40:55]
    v_mfma_f32_32x32x16_bf16 v[40:55], v[108:111], v[252:255], v[40:55]
    s_mov_b64 exec, 1
    ds_add_u32 v4, v5 offset:64
    s_mov_b64 exec, -1
    v_mov_b32 v240, v27
    s_nop 8
    v_pk_mul_f32 v[40:41], v[40:41], s[10:11]
    v_pk_mul_f32 v[42:43], v[42:43], s[10:11]
    v_pk_mul_f32 v[44:45], v[44:45], s[10:11]
    v_pk_mul_f32 v[46:47], v[46:47], s[10:11]
    v_pk_mul_f32 v[48:49], v[48:49], s[10:11]
    v_pk_mul_f32 v[50:51], v[50:51], s[10:11]
    v_pk_mul_f32 v[52:53], v[52:53], s[10:11]
    v_pk_mul_f32 v[54:55], v[54:55], s[10:11]
    v_cvt_pk_bf16_f32 v32, v40, v41
    v_cvt_pk_bf16_f32 v33, v42, v43
    v_cvt_pk_bf16_f32 v34, v44, v45
    v_cvt_pk_bf16_f32 v35, v46, v47
    v_cvt_pk_bf16_f32 v36, v48, v49
    v_cvt_pk_bf16_f32 v37, v50, v51
    v_cvt_pk_bf16_f32 v38, v52, v53
    v_cvt_pk_bf16_f32 v39, v54, v55
    s_mov_b32 exec_lo, 0
    v_mov_b32 v38, 0
    v_mov_b32 v39, 0
    s_mov_b64 exec, -1
    ds_write_b128 v31, v[32:35] offset:0
    ds_write_b128 v31, v[36:39] offset:1024
    s_waitcnt lgkmcnt(0)
    s_mov_b64 exec, 1
    ds_add_u32 v4, v5 offset:24
    s_mov_b64 exec, -1
    s_branch b_main2
b_main:
    s_add_u32 s13, s65, 0
    s_and_b32 s13, s13, 0xffff
    s_add_u32 s13, s13, s15
    s_add_u32 s6, s32, s13
    s_addc_u32 s7, s33, 0
    global_load_dwordx4 v[160:163], v3, s[6:7] offset:0 sc1
    global_load_dwordx4 v[164:167], v3, s[6:7] offset:1024 sc1
    global_load_dwordx4 v[168:171], v2, s[6:7] offset:0 sc1
    global_load_dwordx4 v[172:175], v2, s[6:7] offset:1024 sc1
    s_add_u32 s13, s65, 2048
    s_and_b32 s13, s13, 0xffff
    s_add_u32 s13, s13, s15
    s_add_u32 s6, s32, s13
    s_addc_u32 s7, s33, 0
    global_load_dwordx4 v[176:179], v3, s[6:7] offset:0 sc1
    global_load_dwordx4 v[180:183], v3, s[6:7] offset:1024 sc1
    global_load_dwordx4 v[184:187], v2, s[6:7] offset:0 sc1
    global_load_dwordx4 v[188:191], v2, s[6:7] offset:1024 sc1
b_main2:
    s_waitcnt vmcnt(4)
b_chk0:
    v_bitop3_b32 v244, v160, v164, v240 bitop3:0x7e
    v_bitop3_b32 v245, v168, v172, v240 bitop3:0x7e
    v_bitop3_b32 v244, v244, s93, v245 bitop3:0xc8
    v_cmp_ne_u32 vcc, 0, v244
    s_cbranch_vccnz b_chk0_r
b_chk0_d:
    v_mfma_f32_32x32x16_bf16 v[104:119], v[160:163], v[32:35], 0
    v_mfma_f32_32x32x16_bf16 v[104:119], v[164:167], v[36:39], v[104:119]
    s_add_u32 s13, s65, 4096
    s_and_b32 s13, s13, 0xffff
    s_add_u32 s13, s13, s15
    s_add_u32 s6, s32, s13
    s_addc_u32 s7, s33, 0
    global_load_dwordx4 v[192:195], v3, s[6:7] offset:0 sc1
    global_load_dwordx4 v[196:199], v3, s[6:7] offset:1024 sc1
    global_load_dwordx4 v[200:203], v2, s[6:7] offset:0 sc1
    global_load_dwordx4 v[204:207], v2, s[6:7] offset:1024 sc1
    s_nop 2
    s_waitcnt vmcnt(4)
b_chk1:
    v_bitop3_b32 v244, v176, v180, v240 bitop3:0x7e
    v_bitop3_b32 v245, v184, v188, v240 bitop3:0x7e
    v_bitop3_b32 v244, v244, s93, v245 bitop3:0xc8
    v_cmp_ne_u32 vcc, 0, v244
    s_cbranch_vccnz b_chk1_r
b_chk1_d:
    v_mfma_f32_32x32x16_bf16 v[120:135], v[176:179], v[32:35], 0
    s_add_u32 s13, s65, 6144
    s_and_b32 s13, s13, 0xffff
    s_add_u32 s13, s13, s15
    v_exp_f32 v104, v104
    v_exp_f32 v105, v105
    v_exp_f32 v106, v106
    v_exp_f32 v107, v107
    v_cvt_pk_bf16_f32 v136, v104, v105
    v_cvt_pk_bf16_f32 v137, v106, v107
    v_mfma_f32_32x32x16_bf16 v[120:135], v[180:183], v[36:39], v[120:135]
    s_add_u32 s6, s32, s13
    s_addc_u32 s7, s33, 0
    v_exp_f32 v108, v108
    v_exp_f32 v109, v109
    v_exp_f32 v110, v110
    v_exp_f32 v111, v111
    v_cvt_pk_bf16_f32 v138, v108, v109
    v_cvt_pk_bf16_f32 v139, v110, v111
    v_exp_f32 v112, v112
    v_exp_f32 v113, v113
    v_exp_f32 v114, v114
    v_exp_f32 v115, v115
    v_cvt_pk_bf16_f32 v140, v112, v113
    v_cvt_pk_bf16_f32 v141, v114, v115
    global_load_dwordx4 v[208:211], v3, s[6:7] offset:0 sc1
    global_load_dwordx4 v[212:215], v3, s[6:7] offset:1024 sc1
    global_load_dwordx4 v[216:219], v2, s[6:7] offset:0 sc1
    global_load_dwordx4 v[220:223], v2, s[6:7] offset:1024 sc1
    v_exp_f32 v116, v116
    v_exp_f32 v117, v117
    v_exp_f32 v118, v118
    v_exp_f32 v119, v119
    v_cvt_pk_bf16_f32 v142, v116, v117
    v_cvt_pk_bf16_f32 v143, v118, v119
    s_cmp_lg_u32 s64, 0
    s_cbranch_scc1 gq_30
    s_mov_b32 s69, 400000
wc_31:
    ds_read_b32 v6, v4 offset:24
    s_waitcnt lgkmcnt(0)
    v_readfirstlane_b32 s8, v6
    s_sub_u32 s69, s69, 1
    s_cmp_ge_u32 s8, 4
    s_cbranch_scc1 wc_31_d
    s_sleep 1
    s_cmp_lg_u32 s69, 0
    s_cbranch_scc1 wc_31
wc_31_d:
    s_add_u32 s8, s5, 1
    s_and_b32 s8, s8, 3
    s_lshl_b32 s8, s8, 12
    s_add_u32 s8, s8, 0
    v_add_u32 v156, s8, v3
    ds_read_b128 v[8:11], v156 offset:0
    ds_read_b128 v[12:15], v156 offset:1024
    s_add_u32 s8, s5, 2
    s_and_b32 s8, s8, 3
    s_lshl_b32 s8, s8, 12
    s_add_u32 s8, s8, 0
    v_add_u32 v157, s8, v3
    ds_read_b128 v[16:19], v157 offset:0
    ds_read_b128 v[20:23], v157 offset:1024
    s_add_u32 s8, s5, 3
    s_and_b32 s8, s8, 3
    s_lshl_b32 s8, s8, 12
    s_add_u32 s8, s8, 0
    v_add_u32 v158, s8, v3
    ds_read_b128 v[24:27], v158 offset:0
    ds_read_b128 v[28:31], v158 offset:1024
    s_waitcnt lgkmcnt(0)
    s_mov_b64 exec, 1
    ds_add_u32 v4, v5 offset:60
    s_mov_b64 exec, -1
gq_30:
    v_mfma_f32_32x32x16_bf16 v[104:119], v[160:163], v[8:11], 0
    s_add_u32 s13, s65, 8192
    s_and_b32 s13, s13, 0xffff
    v_exp_f32 v120, v120
    v_exp_f32 v121, v121
    v_exp_f32 v122, v122
    v_exp_f32 v123, v123
    v_cvt_pk_bf16_f32 v144, v120, v121
    v_cvt_pk_bf16_f32 v145, v122, v123
    v_mfma_f32_32x32x16_bf16 v[104:119], v[164:167], v[12:15], v[104:119]
    s_add_u32 s13, s13, s15
    v_exp_f32 v124, v124
    v_exp_f32 v125, v125
    v_exp_f32 v126, v126
    v_exp_f32 v127, v127
    v_cvt_pk_bf16_f32 v146, v124, v125
    v_cvt_pk_bf16_f32 v147, v126, v127
    v_mfma_f32_32x32x16_bf16 v[88:103], v[168:171], v[136:139], 0
    s_add_u32 s6, s32, s13
    s_addc_u32 s7, s33, 0
    v_exp_f32 v128, v128
    v_exp_f32 v129, v129
    v_exp_f32 v130, v130
    v_exp_f32 v131, v131
    v_cvt_pk_bf16_f32 v148, v128, v129
    v_cvt_pk_bf16_f32 v149, v130, v131
    v_mfma_f32_32x32x16_bf16 v[88:103], v[172:175], v[140:143], v[88:103]
    global_load_dwordx4 v[224:227], v3, s[6:7] offset:0 sc1
    global_load_dwordx4 v[228:231], v3, s[6:7] offset:1024 sc1
    global_load_dwordx4 v[232:235], v2, s[6:7] offset:0 sc1
    global_load_dwordx4 v[236:239], v2, s[6:7] offset:1024 sc1
    v_exp_f32 v132, v132
    v_exp_f32 v133, v133
    v_exp_f32 v134, v134
    v_exp_f32 v135, v135
    v_cvt_pk_bf16_f32 v150, v132, v133
    v_cvt_pk_bf16_f32 v151, v134, v135
    v_mfma_f32_32x32x16_bf16 v[120:135], v[160:163], v[16:19], 0
    v_exp_f32 v104, v104
    v_exp_f32 v105, v105
    v_exp_f32 v106, v106
    v_exp_f32 v107, v107
    v_cvt_pk_bf16_f32 v136, v104, v105
    v_cvt_pk_bf16_f32 v137, v106, v107
    v_mfma_f32_32x32x16_bf16 v[120:135], v[164:167], v[20:23], v[120:135]
    v_exp_f32 v108, v108
    v_exp_f32 v109, v109
    v_exp_f32 v110, v110
    v_exp_f32 v111, v111
    v_cvt_pk_bf16_f32 v138, v108, v109
    v_cvt_pk_bf16_f32 v139, v110, v111
    v_mfma_f32_32x32x16_bf16 v[88:103], v[184:187], v[144:147], v[88:103]
    v_exp_f32 v112, v112
    v_exp_f32 v113, v113
    v_exp_f32 v114, v114
    v_exp_f32 v115, v115
    v_cvt_pk_bf16_f32 v140, v112, v113
    v_cvt_pk_bf16_f32 v141, v114, v115
    v_mfma_f32_32x32x16_bf16 v[88:103], v[188:191], v[148:151], v[88:103]
    v_exp_f32 v116, v116
    v_exp_f32 v117, v117
    v_exp_f32 v118, v118
    v_exp_f32 v119, v119
    v_cvt_pk_bf16_f32 v142, v116, v117
    v_cvt_pk_bf16_f32 v143, v118, v119
    v_mfma_f32_32x32x16_bf16 v[104:119], v[160:163], v[24:27], 0
    v_exp_f32 v120, v120
    v_exp_f32 v121, v121
    v_exp_f32 v122, v122
    v_exp_f32 v123, v123
    v_cvt_pk_bf16_f32 v144, v120, v121
    v_cvt_pk_bf16_f32 v145, v122, v123
    v_mfma_f32_32x32x16_bf16 v[104:119], v[164:167], v[28:31], v[104:119]
    v_exp_f32 v124, v124
    v_exp_f32 v125, v125
    v_exp_f32 v126, v126
    v_exp_f32 v127, v127
    v_cvt_pk_bf16_f32 v146, v124, v125
    v_cvt_pk_bf16_f32 v147, v126, v127
    v_mfma_f32_32x32x16_bf16 v[40:55], v[168:171], v[136:139], 0
    v_exp_f32 v128, v128
    v_exp_f32 v129, v129
    v_exp_f32 v130, v130
    v_exp_f32 v131, v131
    v_cvt_pk_bf16_f32 v148, v128, v129
    v_cvt_pk_bf16_f32 v149, v130, v131
    v_mfma_f32_32x32x16_bf16 v[40:55], v[172:175], v[140:143], v[40:55]
    v_exp_f32 v132, v132
    v_exp_f32 v133, v133
    v_exp_f32 v134, v134
    v_exp_f32 v135, v135
    v_cvt_pk_bf16_f32 v150, v132, v133
    v_cvt_pk_bf16_f32 v151, v134, v135
    v_mfma_f32_32x32x16_bf16 v[120:135], v[176:179], v[8:11], 0
    v_exp_f32 v104, v104
    v_exp_f32 v105, v105
    v_exp_f32 v106, v106
    v_exp_f32 v107, v107
    v_cvt_pk_bf16_f32 v136, v104, v105
    v_cvt_pk_bf16_f32 v137, v106, v107
    v_mfma_f32_32x32x16_bf16 v[120:135], v[180:183], v[12:15], v[120:135]
    v_exp_f32 v108, v108
    v_exp_f32 v109, v109
    v_exp_f32 v110, v110
    v_exp_f32 v111, v111
    v_cvt_pk_bf16_f32 v138, v108, v109
    v_cvt_pk_bf16_f32 v139, v110, v111
    v_mfma_f32_32x32x16_bf16 v[56:71], v[168:171], v[144:147], 0
    v_exp_f32 v112, v112
    v_exp_f32 v113, v113
    v_exp_f32 v114, v114
    v_exp_f32 v115, v115
    v_cvt_pk_bf16_f32 v140, v112, v113
    v_cvt_pk_bf16_f32 v141, v114, v115
    v_mfma_f32_32x32x16_bf16 v[56:71], v[172:175], v[148:151], v[56:71]
    s_add_u32 s13, s65, 10240
    v_exp_f32 v116, v116
    v_exp_f32 v117, v117
    v_exp_f32 v118, v118
    v_exp_f32 v119, v119
    v_cvt_pk_bf16_f32 v142, v116, v117
    v_cvt_pk_bf16_f32 v143, v118, v119
    v_mfma_f32_32x32x16_bf16 v[104:119], v[176:179], v[16:19], 0
    s_and_b32 s13, s13, 0xffff
    v_exp_f32 v120, v120
    v_exp_f32 v121, v121
    v_exp_f32 v122, v122
    v_exp_f32 v123, v123
    v_cvt_pk_bf16_f32 v144, v120, v121
    v_cvt_pk_bf16_f32 v145, v122, v123
    v_mfma_f32_32x32x16_bf16 v[104:119], v[180:183], v[20:23], v[104:119]
    s_add_u32 s13, s13, s15
    v_exp_f32 v124, v124
    v_exp_f32 v125, v125
    v_exp_f32 v126, v126
    v_exp_f32 v127, v127
    v_cvt_pk_bf16_f32 v146, v124, v125
    v_cvt_pk_bf16_f32 v147, v126, v127
    v_mfma_f32_32x32x16_bf16 v[72:87], v[168:171], v[136:139], 0
    s_add_u32 s6, s32, s13
    s_addc_u32 s7, s33, 0
    v_exp_f32 v128, v128
    v_exp_f32 v129, v129
    v_exp_f32 v130, v130
    v_exp_f32 v131, v131
    v_cvt_pk_bf16_f32 v148, v128, v129
    v_cvt_pk_bf16_f32 v149, v130, v131
    v_mfma_f32_32x32x16_bf16 v[72:87], v[172:175], v[140:143], v[72:87]
    global_load_dwordx4 v[160:163], v3, s[6:7] offset:0 sc1
    global_load_dwordx4 v[164:167], v3, s[6:7] offset:1024 sc1
    global_load_dwordx4 v[168:171], v2, s[6:7] offset:0 sc1
    global_load_dwordx4 v[172:175], v2, s[6:7] offset:1024 sc1
    v_exp_f32 v132, v132
    v_exp_f32 v133, v133
    v_exp_f32 v134, v134
    v_exp_f32 v135, v135
    v_cvt_pk_bf16_f32 v150, v132, v133
    v_cvt_pk_bf16_f32 v151, v134, v135
    v_mfma_f32_32x32x16_bf16 v[120:135], v[176:179], v[24:27], 0
    v_exp_f32 v104, v104
    v_exp_f32 v105, v105
    v_exp_f32 v106, v106
    v_exp_f32 v107, v107
    v_cvt_pk_bf16_f32 v136, v104, v105
    v_cvt_pk_bf16_f32 v137, v106, v107
    v_mfma_f32_32x32x16_bf16 v[120:135], v[180:183], v[28:31], v[120:135]
    v_exp_f32 v108, v108
    v_exp_f32 v109, v109
    v_exp_f32 v110, v110
    v_exp_f32 v111, v111
    v_cvt_pk_bf16_f32 v138, v108, v109
    v_cvt_pk_bf16_f32 v139, v110, v111
    v_mfma_f32_32x32x16_bf16 v[40:55], v[184:187], v[144:147], v[40:55]
    s_waitcnt vmcnt(12)
    v_bitop3_b32 v244, v192, v196, v240 bitop3:0x7e
    v_bitop3_b32 v245, v200, v204, v240 bitop3:0x7e
    v_bitop3_b32 v244, v244, s93, v245 bitop3:0xc8
    v_cmp_ne_u32 vcc, 0, v244
    v_exp_f32 v112, v112
    v_exp_f32 v113, v113
    v_exp_f32 v114, v114
    v_exp_f32 v115, v115
    v_cvt_pk_bf16_f32 v140, v112, v113
    v_cvt_pk_bf16_f32 v141, v114, v115
    v_mfma_f32_32x32x16_bf16 v[40:55], v[188:191], v[148:151], v[40:55]
    s_cbranch_vccnz b_chk2_r
b_chk2_d:
    v_exp_f32 v116, v116
    v_exp_f32 v117, v117
    v_exp_f32 v118, v118
    v_exp_f32 v119, v119
    v_cvt_pk_bf16_f32 v142, v116, v117
    v_cvt_pk_bf16_f32 v143, v118, v119
    s_mov_b64 exec, 1
    ds_add_u32 v4, v5 offset:96
    s_mov_b64 exec, -1
    v_mfma_f32_32x32x16_bf16 v[104:119], v[192:195], v[8:11], 0
    v_exp_f32 v120, v120
    v_exp_f32 v121, v121
    v_exp_f32 v122, v122
    v_exp_f32 v123, v123
    v_cvt_pk_bf16_f32 v144, v120, v121
    v_cvt_pk_bf16_f32 v145, v122, v123
    v_mfma_f32_32x32x16_bf16 v[104:119], v[196:199], v[12:15], v[104:119]
    v_exp_f32 v124, v124
    v_exp_f32 v125, v125
    v_exp_f32 v126, v126
    v_exp_f32 v127, v127
    v_cvt_pk_bf16_f32 v146, v124, v125
    v_cvt_pk_bf16_f32 v147, v126, v127
    v_mfma_f32_32x32x16_bf16 v[56:71], v[184:187], v[136:139], v[56:71]
    v_exp_f32 v128, v128
    v_exp_f32 v129, v129
    v_exp_f32 v130, v130
    v_exp_f32 v131, v131
    v_cvt_pk_bf16_f32 v148, v128, v129
    v_cvt_pk_bf16_f32 v149, v130, v131
    v_mfma_f32_32x32x16_bf16 v[56:71], v[188:191], v[140:143], v[56:71]
    s_add_u32 s13, s65, 12288
    v_exp_f32 v132, v132
    v_exp_f32 v133, v133
    v_exp_f32 v134, v134
    v_exp_f32 v135, v135
    v_cvt_pk_bf16_f32 v150, v132, v133
    v_cvt_pk_bf16_f32 v151, v134, v135
    v_mfma_f32_32x32x16_bf16 v[120:135], v[192:195], v[16:19], 0
    s_and_b32 s13, s13, 0xffff
    v_exp_f32 v104, v104
    v_exp_f32 v105, v105
    v_exp_f32 v106, v106
    v_exp_f32 v107, v107
    v_cvt_pk_bf16_f32 v136, v104, v105
    v_cvt_pk_bf16_f32 v137, v106, v107
    v_mfma_f32_32x32x16_bf16 v[120:135], v[196:199], v[20:23], v[120:135]
    s_add_u32 s13, s13, s15
    v_exp_f32 v108, v108
    v_exp_f32 v109, v109
    v_exp_f32 v110, v110
    v_exp_f32 v111, v111
    v_cvt_pk_bf16_f32 v138, v108, v109
    v_cvt_pk_bf16_f32 v139, v110, v111
    v_mfma_f32_32x32x16_bf16 v[72:87], v[184:187], v[144:147], v[72:87]
    s_add_u32 s6, s32, s13
    s_addc_u32 s7, s33, 0
    v_exp_f32 v112, v112
    v_exp_f32 v113, v113
    v_exp_f32 v114, v114
    v_exp_f32 v115, v115
    v_cvt_pk_bf16_f32 v140, v112, v113
    v_cvt_pk_bf16_f32 v141, v114, v115
    v_mfma_f32_32x32x16_bf16 v[72:87], v[188:191], v[148:151], v[72:87]
    global_load_dwordx4 v[176:179], v3, s[6:7] offset:0 sc1
    global_load_dwordx4 v[180:183], v3, s[6:7] offset:1024 sc1
    global_load_dwordx4 v[184:187], v2, s[6:7] offset:0 sc1
    global_load_dwordx4 v[188:191], v2, s[6:7] offset:1024 sc1
    v_exp_f32 v116, v116
    v_exp_f32 v117, v117
    v_exp_f32 v118, v118
    v_exp_f32 v119, v119
    v_cvt_pk_bf16_f32 v142, v116, v117
    v_cvt_pk_bf16_f32 v143, v118, v119
    s_mov_b64 exec, 1
    ds_add_u32 v4, v5 offset:72
    s_mov_b64 exec, -1
    v_mfma_f32_32x32x16_bf16 v[104:119], v[192:195], v[24:27], 0
    v_exp_f32 v120, v120
    v_exp_f32 v121, v121
    v_exp_f32 v122, v122
    v_exp_f32 v123, v123
    v_cvt_pk_bf16_f32 v144, v120, v121
    v_cvt_pk_bf16_f32 v145, v122, v123
    v_mfma_f32_32x32x16_bf16 v[104:119], v[196:199], v[28:31], v[104:119]
    v_exp_f32 v124, v124
    v_exp_f32 v125, v125
    v_exp_f32 v126, v126
    v_exp_f32 v127, v127
    v_cvt_pk_bf16_f32 v146, v124, v125
    v_cvt_pk_bf16_f32 v147, v126, v127
    v_mfma_f32_32x32x16_bf16 v[40:55], v[200:203], v[136:139], v[40:55]
    v_exp_f32 v128, v128
    v_exp_f32 v129, v129
    v_exp_f32 v130, v130
    v_exp_f32 v131, v131
    v_cvt_pk_bf16_f32 v148, v128, v129
    v_cvt_pk_bf16_f32 v149, v130, v131
    v_mfma_f32_32x32x16_bf16 v[40:55], v[204:207], v[140:143], v[40:55]
    v_exp_f32 v132, v132
    v_exp_f32 v133, v133
    v_exp_f32 v134, v134
    v_exp_f32 v135, v135
    v_cvt_pk_bf16_f32 v150, v132, v133
    v_cvt_pk_bf16_f32 v151, v134, v135
    v_mfma_f32_32x32x16_bf16 v[120:135], v[192:195], v[32:35], 0
    v_exp_f32 v104, v104
    v_exp_f32 v105, v105
    v_exp_f32 v106, v106
    v_exp_f32 v107, v107
    v_cvt_pk_bf16_f32 v136, v104, v105
    v_cvt_pk_bf16_f32 v137, v106, v107
    v_mfma_f32_32x32x16_bf16 v[120:135], v[196:199], v[36:39], v[120:135]
    v_exp_f32 v108, v108
    v_exp_f32 v109, v109
    v_exp_f32 v110, v110
    v_exp_f32 v111, v111
    v_cvt_pk_bf16_f32 v138, v108, v109
    v_cvt_pk_bf16_f32 v139, v110, v111
    v_mfma_f32_32x32x16_bf16 v[56:71], v[200:203], v[144:147], v[56:71]
    s_waitcnt vmcnt(12)
    v_bitop3_b32 v244, v208, v212, v240 bitop3:0x7e
    v_bitop3_b32 v245, v216, v220, v240 bitop3:0x7e
    v_bitop3_b32 v244, v244, s93, v245 bitop3:0xc8
    v_cmp_ne_u32 vcc, 0, v244
    v_exp_f32 v112, v112
    v_exp_f32 v113, v113
    v_exp_f32 v114, v114
    v_exp_f32 v115, v115
    v_cvt_pk_bf16_f32 v140, v112, v113
    v_cvt_pk_bf16_f32 v141, v114, v115
    v_mfma_f32_32x32x16_bf16 v[56:71], v[204:207], v[148:151], v[56:71]
    s_cbranch_vccnz b_chk3_r
b_chk3_d:
    v_exp_f32 v116, v116
    v_exp_f32 v117, v117
    v_exp_f32 v118, v118
    v_exp_f32 v119, v119
    v_cvt_pk_bf16_f32 v142, v116, v117
    v_cvt_pk_bf16_f32 v143, v118, v119
    v_mfma_f32_32x32x16_bf16 v[104:119], v[208:211], v[8:11], 0
    v_exp_f32 v120, v120
    v_exp_f32 v121, v121
    v_exp_f32 v122, v122
    v_exp_f32 v123, v123
    v_cvt_pk_bf16_f32 v144, v120, v121
    v_cvt_pk_bf16_f32 v145, v122, v123
    v_mfma_f32_32x32x16_bf16 v[104:119], v[212:215], v[12:15], v[104:119]
    v_exp_f32 v124, v124
    v_exp_f32 v125, v125
    v_exp_f32 v126, v126
    v_exp_f32 v127, v127
    v_cvt_pk_bf16_f32 v146, v124, v125
    v_cvt_pk_bf16_f32 v147, v126, v127
    v_mfma_f32_32x32x16_bf16 v[72:87], v[200:203], v[136:139], v[72:87]
    v_exp_f32 v128, v128
    v_exp_f32 v129, v129
    v_exp_f32 v130, v130
    v_exp_f32 v131, v131
    v_cvt_pk_bf16_f32 v148, v128, v129
    v_cvt_pk_bf16_f32 v149, v130, v131
    v_mfma_f32_32x32x16_bf16 v[72:87], v[204:207], v[140:143], v[72:87]
    s_add_u32 s13, s65, 14336
    v_exp_f32 v132, v132
    v_exp_f32 v133, v133
    v_exp_f32 v134, v134
    v_exp_f32 v135, v135
    v_cvt_pk_bf16_f32 v150, v132, v133
    v_cvt_pk_bf16_f32 v151, v134, v135
    v_mfma_f32_32x32x16_bf16 v[120:135], v[208:211], v[16:19], 0
    s_and_b32 s13, s13, 0xffff
    v_exp_f32 v104, v104
    v_exp_f32 v105, v105
    v_exp_f32 v106, v106
    v_exp_f32 v107, v107
    v_cvt_pk_bf16_f32 v136, v104, v105
    v_cvt_pk_bf16_f32 v137, v106, v107
    v_mfma_f32_32x32x16_bf16 v[120:135], v[212:215], v[20:23], v[120:135]
    s_add_u32 s13, s13, s15
    v_exp_f32 v108, v108
    v_exp_f32 v109, v109
    v_exp_f32 v110, v110
    v_exp_f32 v111, v111
    v_cvt_pk_bf16_f32 v138, v108, v109
    v_cvt_pk_bf16_f32 v139, v110, v111
    v_mfma_f32_32x32x16_bf16 v[88:103], v[200:203], v[144:147], v[88:103]
    s_add_u32 s6, s32, s13
    s_addc_u32 s7, s33, 0
    v_exp_f32 v112, v112
    v_exp_f32 v113, v113
    v_exp_f32 v114, v114
    v_exp_f32 v115, v115
    v_cvt_pk_bf16_f32 v140, v112, v113
    v_cvt_pk_bf16_f32 v141, v114, v115
    v_mfma_f32_32x32x16_bf16 v[88:103], v[204:207], v[148:151], v[88:103]
    global_load_dwordx4 v[192:195], v3, s[6:7] offset:0 sc1
    global_load_dwordx4 v[196:199], v3, s[6:7] offset:1024 sc1
    global_load_dwordx4 v[200:203], v2, s[6:7] offset:0 sc1
    global_load_dwordx4 v[204:207], v2, s[6:7] offset:1024 sc1
    v_exp_f32 v116, v116
    v_exp_f32 v117, v117
    v_exp_f32 v118, v118
    v_exp_f32 v119, v119
    v_cvt_pk_bf16_f32 v142, v116, v117
    v_cvt_pk_bf16_f32 v143, v118, v119
    v_mfma_f32_32x32x16_bf16 v[104:119], v[208:211], v[24:27], 0
    v_exp_f32 v120, v120
    v_exp_f32 v121, v121
    v_exp_f32 v122, v122
    v_exp_f32 v123, v123
    v_cvt_pk_bf16_f32 v144, v120, v121
    v_cvt_pk_bf16_f32 v145, v122, v123
    v_mfma_f32_32x32x16_bf16 v[104:119], v[212:215], v[28:31], v[104:119]
    v_exp_f32 v124, v124
    v_exp_f32 v125, v125
    v_exp_f32 v126, v126
    v_exp_f32 v127, v127
    v_cvt_pk_bf16_f32 v146, v124, v125
    v_cvt_pk_bf16_f32 v147, v126, v127
    v_mfma_f32_32x32x16_bf16 v[40:55], v[216:219], v[136:139], v[40:55]
    v_exp_f32 v128, v128
    v_exp_f32 v129, v129
    v_exp_f32 v130, v130
    v_exp_f32 v131, v131
    v_cvt_pk_bf16_f32 v148, v128, v129
    v_cvt_pk_bf16_f32 v149, v130, v131
    v_mfma_f32_32x32x16_bf16 v[40:55], v[220:223], v[140:143], v[40:55]
    v_exp_f32 v132, v132
    v_exp_f32 v133, v133
    v_exp_f32 v134, v134
    v_exp_f32 v135, v135
    v_cvt_pk_bf16_f32 v150, v132, v133
    v_cvt_pk_bf16_f32 v151, v134, v135
    v_mfma_f32_32x32x16_bf16 v[120:135], v[208:211], v[32:35], 0
    v_exp_f32 v104, v104
    v_exp_f32 v105, v105
    v_exp_f32 v106, v106
    v_exp_f32 v107, v107
    v_cvt_pk_bf16_f32 v136, v104, v105
    v_cvt_pk_bf16_f32 v137, v106, v107
    v_mfma_f32_32x32x16_bf16 v[120:135], v[212:215], v[36:39], v[120:135]
    v_exp_f32 v108, v108
    v_exp_f32 v109, v109
    v_exp_f32 v110, v110
    v_exp_f32 v111, v111
    v_cvt_pk_bf16_f32 v138, v108, v109
    v_cvt_pk_bf16_f32 v139, v110, v111
    v_mfma_f32_32x32x16_bf16 v[56:71], v[216:219], v[144:147], v[56:71]
    s_waitcnt vmcnt(12)
    v_bitop3_b32 v244, v224, v228, v240 bitop3:0x7e
    v_bitop3_b32 v245, v232, v236, v240 bitop3:0x7e
    v_bitop3_b32 v244, v244, s93, v245 bitop3:0xc8
    v_cmp_ne_u32 vcc, 0, v244
    v_exp_f32 v112, v112
    v_exp_f32 v113, v113
    v_exp_f32 v114, v114
    v_exp_f32 v115, v115
    v_cvt_pk_bf16_f32 v140, v112, v113
    v_cvt_pk_bf16_f32 v141, v114, v115
    v_mfma_f32_32x32x16_bf16 v[56:71], v[220:223], v[148:151], v[56:71]
    s_cbranch_vccnz b_chk4_r
b_chk4_d:
    v_exp_f32 v116, v116
    v_exp_f32 v117, v117
    v_exp_f32 v118, v118
    v_exp_f32 v119, v119
    v_cvt_pk_bf16_f32 v142, v116, v117
    v_cvt_pk_bf16_f32 v143, v118, v119
    v_mfma_f32_32x32x16_bf16 v[104:119], v[224:227], v[8:11], 0
    v_exp_f32 v120, v120
    v_exp_f32 v121, v121
    v_exp_f32 v122, v122
    v_exp_f32 v123, v123
    v_cvt_pk_bf16_f32 v144, v120, v121
    v_cvt_pk_bf16_f32 v145, v122, v123
    v_mfma_f32_32x32x16_bf16 v[104:119], v[228:231], v[12:15], v[104:119]
    v_exp_f32 v124, v124
    v_exp_f32 v125, v125
    v_exp_f32 v126, v126
    v_exp_f32 v127, v127
    v_cvt_pk_bf16_f32 v146, v124, v125
    v_cvt_pk_bf16_f32 v147, v126, v127
    v_mfma_f32_32x32x16_bf16 v[72:87], v[216:219], v[136:139], v[72:87]
    v_exp_f32 v128, v128
    v_exp_f32 v129, v129
    v_exp_f32 v130, v130
    v_exp_f32 v131, v131
    v_cvt_pk_bf16_f32 v148, v128, v129
    v_cvt_pk_bf16_f32 v149, v130, v131
    v_mfma_f32_32x32x16_bf16 v[72:87], v[220:223], v[140:143], v[72:87]
    s_add_u32 s13, s65, 0
    v_exp_f32 v132, v132
    v_exp_f32 v133, v133
    v_exp_f32 v134, v134
    v_exp_f32 v135, v135
    v_cvt_pk_bf16_f32 v150, v132, v133
    v_cvt_pk_bf16_f32 v151, v134, v135
    v_mfma_f32_32x32x16_bf16 v[120:135], v[224:227], v[16:19], 0
    s_and_b32 s13, s13, 0xffff
    v_exp_f32 v104, v104
    v_exp_f32 v105, v105
    v_exp_f32 v106, v106
    v_exp_f32 v107, v107
    v_cvt_pk_bf16_f32 v136, v104, v105
    v_cvt_pk_bf16_f32 v137, v106, v107
    v_mfma_f32_32x32x16_bf16 v[120:135], v[228:231], v[20:23], v[120:135]
    s_add_u32 s13, s13, s68
    v_exp_f32 v108, v108
    v_exp_f32 v109, v109
    v_exp_f32 v110, v110
    v_exp_f32 v111, v111
    v_cvt_pk_bf16_f32 v138, v108, v109
    v_cvt_pk_bf16_f32 v139, v110, v111
    v_mfma_f32_32x32x16_bf16 v[88:103], v[216:219], v[144:147], v[88:103]
    s_add_u32 s6, s32, s13
    s_addc_u32 s7, s33, 0
    v_exp_f32 v112, v112
    v_exp_f32 v113, v113
    v_exp_f32 v114, v114
    v_exp_f32 v115, v115
    v_cvt_pk_bf16_f32 v140, v112, v113
    v_cvt_pk_bf16_f32 v141, v114, v115
    v_mfma_f32_32x32x16_bf16 v[88:103], v[220:223], v[148:151], v[88:103]
    global_load_dwordx4 v[208:211], v3, s[6:7] offset:0
    global_load_dwordx4 v[212:215], v3, s[6:7] offset:1024
    global_load_dwordx4 v[216:219], v2, s[6:7] offset:0
    global_load_dwordx4 v[220:223], v2, s[6:7] offset:1024
    v_exp_f32 v116, v116
    v_exp_f32 v117, v117
    v_exp_f32 v118, v118
    v_exp_f32 v119, v119
    v_cvt_pk_bf16_f32 v142, v116, v117
    v_cvt_pk_bf16_f32 v143, v118, v119
    v_mfma_f32_32x32x16_bf16 v[104:119], v[224:227], v[24:27], 0
    v_exp_f32 v120, v120
    v_exp_f32 v121, v121
    v_exp_f32 v122, v122
    v_exp_f32 v123, v123
    v_cvt_pk_bf16_f32 v144, v120, v121
    v_cvt_pk_bf16_f32 v145, v122, v123
    v_mfma_f32_32x32x16_bf16 v[104:119], v[228:231], v[28:31], v[104:119]
    v_exp_f32 v124, v124
    v_exp_f32 v125, v125
    v_exp_f32 v126, v126
    v_exp_f32 v127, v127
    v_cvt_pk_bf16_f32 v146, v124, v125
    v_cvt_pk_bf16_f32 v147, v126, v127
    v_mfma_f32_32x32x16_bf16 v[40:55], v[232:235], v[136:139], v[40:55]
    v_exp_f32 v128, v128
    v_exp_f32 v129, v129
    v_exp_f32 v130, v130
    v_exp_f32 v131, v131
    v_cvt_pk_bf16_f32 v148, v128, v129
    v_cvt_pk_bf16_f32 v149, v130, v131
    v_mfma_f32_32x32x16_bf16 v[40:55], v[236:239], v[140:143], v[40:55]
    v_exp_f32 v132, v132
    v_exp_f32 v133, v133
    v_exp_f32 v134, v134
    v_exp_f32 v135, v135
    v_cvt_pk_bf16_f32 v150, v132, v133
    v_cvt_pk_bf16_f32 v151, v134, v135
    v_mfma_f32_32x32x16_bf16 v[120:135], v[224:227], v[32:35], 0
    v_exp_f32 v104, v104
    v_exp_f32 v105, v105
    v_exp_f32 v106, v106
    v_exp_f32 v107, v107
    v_cvt_pk_bf16_f32 v136, v104, v105
    v_cvt_pk_bf16_f32 v137, v106, v107
    v_mfma_f32_32x32x16_bf16 v[120:135], v[228:231], v[36:39], v[120:135]
    v_exp_f32 v108, v108
    v_exp_f32 v109, v109
    v_exp_f32 v110, v110
    v_exp_f32 v111, v111
    v_cvt_pk_bf16_f32 v138, v108, v109
    v_cvt_pk_bf16_f32 v139, v110, v111
    v_mfma_f32_32x32x16_bf16 v[56:71], v[232:235], v[144:147], v[56:71]
    s_waitcnt vmcnt(12)
    v_bitop3_b32 v244, v160, v164, v240 bitop3:0x7e
    v_bitop3_b32 v245, v168, v172, v240 bitop3:0x7e
    v_bitop3_b32 v244, v244, s93, v245 bitop3:0xc8
    v_cmp_ne_u32 vcc, 0, v244
    v_exp_f32 v112, v112
    v_exp_f32 v113, v113
    v_exp_f32 v114, v114
    v_exp_f32 v115, v115
    v_cvt_pk_bf16_f32 v140, v112, v113
    v_cvt_pk_bf16_f32 v141, v114, v115
    v_mfma_f32_32x32x16_bf16 v[56:71], v[236:239], v[148:151], v[56:71]
    s_cbranch_vccnz b_chk5_r
b_chk5_d:
    v_exp_f32 v116, v116
    v_exp_f32 v117, v117
    v_exp_f32 v118, v118
    v_exp_f32 v119, v119
    v_cvt_pk_bf16_f32 v142, v116, v117
    v_cvt_pk_bf16_f32 v143, v118, v119
    v_mfma_f32_32x32x16_bf16 v[104:119], v[160:163], v[8:11], 0
    v_exp_f32 v120, v120
    v_exp_f32 v121, v121
    v_exp_f32 v122, v122
    v_exp_f32 v123, v123
    v_cvt_pk_bf16_f32 v144, v120, v121
    v_cvt_pk_bf16_f32 v145, v122, v123
    v_mfma_f32_32x32x16_bf16 v[104:119], v[164:167], v[12:15], v[104:119]
    v_exp_f32 v124, v124
    v_exp_f32 v125, v125
    v_exp_f32 v126, v126
    v_exp_f32 v127, v127
    v_cvt_pk_bf16_f32 v146, v124, v125
    v_cvt_pk_bf16_f32 v147, v126, v127
    v_mfma_f32_32x32x16_bf16 v[72:87], v[232:235], v[136:139], v[72:87]
    v_exp_f32 v128, v128
    v_exp_f32 v129, v129
    v_exp_f32 v130, v130
    v_exp_f32 v131, v131
    v_cvt_pk_bf16_f32 v148, v128, v129
    v_cvt_pk_bf16_f32 v149, v130, v131
    v_mfma_f32_32x32x16_bf16 v[72:87], v[236:239], v[140:143], v[72:87]
    s_add_u32 s13, s65, 2048
    v_exp_f32 v132, v132
    v_exp_f32 v133, v133
    v_exp_f32 v134, v134
    v_exp_f32 v135, v135
    v_cvt_pk_bf16_f32 v150, v132, v133
    v_cvt_pk_bf16_f32 v151, v134, v135
    v_mfma_f32_32x32x16_bf16 v[120:135], v[160:163], v[16:19], 0
    s_and_b32 s13, s13, 0xffff
    v_exp_f32 v104, v104
    v_exp_f32 v105, v105
    v_exp_f32 v106, v106
    v_exp_f32 v107, v107
    v_cvt_pk_bf16_f32 v136, v104, v105
    v_cvt_pk_bf16_f32 v137, v106, v107
    v_mfma_f32_32x32x16_bf16 v[120:135], v[164:167], v[20:23], v[120:135]
    s_add_u32 s13, s13, s68
    v_exp_f32 v108, v108
    v_exp_f32 v109, v109
    v_exp_f32 v110, v110
    v_exp_f32 v111, v111
    v_cvt_pk_bf16_f32 v138, v108, v109
    v_cvt_pk_bf16_f32 v139, v110, v111
    v_mfma_f32_32x32x16_bf16 v[88:103], v[232:235], v[144:147], v[88:103]
    s_add_u32 s6, s32, s13
    s_addc_u32 s7, s33, 0
    v_exp_f32 v112, v112
    v_exp_f32 v113, v113
    v_exp_f32 v114, v114
    v_exp_f32 v115, v115
    v_cvt_pk_bf16_f32 v140, v112, v113
    v_cvt_pk_bf16_f32 v141, v114, v115
    v_mfma_f32_32x32x16_bf16 v[88:103], v[236:239], v[148:151], v[88:103]
    global_load_dwordx4 v[224:227], v3, s[6:7] offset:0
    global_load_dwordx4 v[228:231], v3, s[6:7] offset:1024
    global_load_dwordx4 v[232:235], v2, s[6:7] offset:0
    global_load_dwordx4 v[236:239], v2, s[6:7] offset:1024
    v_exp_f32 v116, v116
    v_exp_f32 v117, v117
    v_exp_f32 v118, v118
    v_exp_f32 v119, v119
    v_cvt_pk_bf16_f32 v142, v116, v117
    v_cvt_pk_bf16_f32 v143, v118, v119
    v_mfma_f32_32x32x16_bf16 v[104:119], v[160:163], v[24:27], 0
    v_exp_f32 v120, v120
    v_exp_f32 v121, v121
    v_exp_f32 v122, v122
    v_exp_f32 v123, v123
    v_cvt_pk_bf16_f32 v144, v120, v121
    v_cvt_pk_bf16_f32 v145, v122, v123
    v_mfma_f32_32x32x16_bf16 v[104:119], v[164:167], v[28:31], v[104:119]
    v_exp_f32 v124, v124
    v_exp_f32 v125, v125
    v_exp_f32 v126, v126
    v_exp_f32 v127, v127
    v_cvt_pk_bf16_f32 v146, v124, v125
    v_cvt_pk_bf16_f32 v147, v126, v127
    v_mfma_f32_32x32x16_bf16 v[40:55], v[168:171], v[136:139], v[40:55]
    v_exp_f32 v128, v128
    v_exp_f32 v129, v129
    v_exp_f32 v130, v130
    v_exp_f32 v131, v131
    v_cvt_pk_bf16_f32 v148, v128, v129
    v_cvt_pk_bf16_f32 v149, v130, v131
    v_mfma_f32_32x32x16_bf16 v[40:55], v[172:175], v[140:143], v[40:55]
    v_exp_f32 v132, v132
    v_exp_f32 v133, v133
    v_exp_f32 v134, v134
    v_exp_f32 v135, v135
    v_cvt_pk_bf16_f32 v150, v132, v133
    v_cvt_pk_bf16_f32 v151, v134, v135
    v_mfma_f32_32x32x16_bf16 v[120:135], v[160:163], v[32:35], 0
    v_exp_f32 v104, v104
    v_exp_f32 v105, v105
    v_exp_f32 v106, v106
    v_exp_f32 v107, v107
    v_cvt_pk_bf16_f32 v136, v104, v105
    v_cvt_pk_bf16_f32 v137, v106, v107
    v_mfma_f32_32x32x16_bf16 v[120:135], v[164:167], v[36:39], v[120:135]
    v_exp_f32 v108, v108
    v_exp_f32 v109, v109
    v_exp_f32 v110, v110
    v_exp_f32 v111, v111
    v_cvt_pk_bf16_f32 v138, v108, v109
    v_cvt_pk_bf16_f32 v139, v110, v111
    v_mfma_f32_32x32x16_bf16 v[56:71], v[168:171], v[144:147], v[56:71]
    s_waitcnt vmcnt(12)
    v_bitop3_b32 v244, v176, v180, v240 bitop3:0x7e
    v_bitop3_b32 v245, v184, v188, v240 bitop3:0x7e
    v_bitop3_b32 v244, v244, s93, v245 bitop3:0xc8
    v_cmp_ne_u32 vcc, 0, v244
    v_exp_f32 v112, v112
    v_exp_f32 v113, v113
    v_exp_f32 v114, v114
    v_exp_f32 v115, v115
    v_cvt_pk_bf16_f32 v140, v112, v113
    v_cvt_pk_bf16_f32 v141, v114, v115
    v_mfma_f32_32x32x16_bf16 v[56:71], v[172:175], v[148:151], v[56:71]
    s_cbranch_vccnz b_chk6_r
b_chk6_d:
    v_exp_f32 v116, v116
    v_exp_f32 v117, v117
    v_exp_f32 v118, v118
    v_exp_f32 v119, v119
    v_cvt_pk_bf16_f32 v142, v116, v117
    v_cvt_pk_bf16_f32 v143, v118, v119
    v_mfma_f32_32x32x16_bf16 v[104:119], v[176:179], v[8:11], 0
    v_exp_f32 v120, v120
    v_exp_f32 v121, v121
    v_exp_f32 v122, v122
    v_exp_f32 v123, v123
    v_cvt_pk_bf16_f32 v144, v120, v121
    v_cvt_pk_bf16_f32 v145, v122, v123
    v_mfma_f32_32x32x16_bf16 v[104:119], v[180:183], v[12:15], v[104:119]
    v_exp_f32 v124, v124
    v_exp_f32 v125, v125
    v_exp_f32 v126, v126
    v_exp_f32 v127, v127
    v_cvt_pk_bf16_f32 v146, v124, v125
    v_cvt_pk_bf16_f32 v147, v126, v127
    v_mfma_f32_32x32x16_bf16 v[72:87], v[168:171], v[136:139], v[72:87]
    v_exp_f32 v128, v128
    v_exp_f32 v129, v129
    v_exp_f32 v130, v130
    v_exp_f32 v131, v131
    v_cvt_pk_bf16_f32 v148, v128, v129
    v_cvt_pk_bf16_f32 v149, v130, v131
    v_mfma_f32_32x32x16_bf16 v[72:87], v[172:175], v[140:143], v[72:87]
    s_add_u32 s13, s65, 4096
    v_exp_f32 v132, v132
    v_exp_f32 v133, v133
    v_exp_f32 v134, v134
    v_exp_f32 v135, v135
    v_cvt_pk_bf16_f32 v150, v132, v133
    v_cvt_pk_bf16_f32 v151, v134, v135
    v_mfma_f32_32x32x16_bf16 v[120:135], v[176:179], v[16:19], 0
    s_and_b32 s13, s13, 0xffff
    v_exp_f32 v104, v104
    v_exp_f32 v105, v105
    v_exp_f32 v106, v106
    v_exp_f32 v107, v107
    v_cvt_pk_bf16_f32 v136, v104, v105
    v_cvt_pk_bf16_f32 v137, v106, v107
    v_mfma_f32_32x32x16_bf16 v[120:135], v[180:183], v[20:23], v[120:135]
    s_add_u32 s13, s13, s68
    v_exp_f32 v108, v108
    v_exp_f32 v109, v109
    v_exp_f32 v110, v110
    v_exp_f32 v111, v111
    v_cvt_pk_bf16_f32 v138, v108, v109
    v_cvt_pk_bf16_f32 v139, v110, v111
    v_mfma_f32_32x32x16_bf16 v[88:103], v[168:171], v[144:147], v[88:103]
    s_add_u32 s6, s32, s13
    s_addc_u32 s7, s33, 0
    v_exp_f32 v112, v112
    v_exp_f32 v113, v113
    v_exp_f32 v114, v114
    v_exp_f32 v115, v115
    v_cvt_pk_bf16_f32 v140, v112, v113
    v_cvt_pk_bf16_f32 v141, v114, v115
    v_mfma_f32_32x32x16_bf16 v[88:103], v[172:175], v[148:151], v[88:103]
    global_load_dwordx4 v[160:163], v3, s[6:7] offset:0
    global_load_dwordx4 v[164:167], v3, s[6:7] offset:1024
    global_load_dwordx4 v[168:171], v2, s[6:7] offset:0
    global_load_dwordx4 v[172:175], v2, s[6:7] offset:1024
    v_exp_f32 v116, v116
    v_exp_f32 v117, v117
    v_exp_f32 v118, v118
    v_exp_f32 v119, v119
    v_cvt_pk_bf16_f32 v142, v116, v117
    v_cvt_pk_bf16_f32 v143, v118, v119
    v_mfma_f32_32x32x16_bf16 v[104:119], v[176:179], v[24:27], 0
    v_exp_f32 v120, v120
    v_exp_f32 v121, v121
    v_exp_f32 v122, v122
    v_exp_f32 v123, v123
    v_cvt_pk_bf16_f32 v144, v120, v121
    v_cvt_pk_bf16_f32 v145, v122, v123
    v_mfma_f32_32x32x16_bf16 v[104:119], v[180:183], v[28:31], v[104:119]
    v_exp_f32 v124, v124
    v_exp_f32 v125, v125
    v_exp_f32 v126, v126
    v_exp_f32 v127, v127
    v_cvt_pk_bf16_f32 v146, v124, v125
    v_cvt_pk_bf16_f32 v147, v126, v127
    v_mfma_f32_32x32x16_bf16 v[40:55], v[184:187], v[136:139], v[40:55]
    v_exp_f32 v128, v128
    v_exp_f32 v129, v129
    v_exp_f32 v130, v130
    v_exp_f32 v131, v131
    v_cvt_pk_bf16_f32 v148, v128, v129
    v_cvt_pk_bf16_f32 v149, v130, v131
    v_mfma_f32_32x32x16_bf16 v[40:55], v[188:191], v[140:143], v[40:55]
    v_exp_f32 v132, v132
    v_exp_f32 v133, v133
    v_exp_f32 v134, v134
    v_exp_f32 v135, v135
    v_cvt_pk_bf16_f32 v150, v132, v133
    v_cvt_pk_bf16_f32 v151, v134, v135
    v_mfma_f32_32x32x16_bf16 v[120:135], v[176:179], v[32:35], 0
    v_exp_f32 v104, v104
    v_exp_f32 v105, v105
    v_exp_f32 v106, v106
    v_exp_f32 v107, v107
    v_cvt_pk_bf16_f32 v136, v104, v105
    v_cvt_pk_bf16_f32 v137, v106, v107
    v_mfma_f32_32x32x16_bf16 v[120:135], v[180:183], v[36:39], v[120:135]
    v_exp_f32 v108, v108
    v_exp_f32 v109, v109
    v_exp_f32 v110, v110
    v_exp_f32 v111, v111
    v_cvt_pk_bf16_f32 v138, v108, v109
    v_cvt_pk_bf16_f32 v139, v110, v111
    v_mfma_f32_32x32x16_bf16 v[56:71], v[184:187], v[144:147], v[56:71]
    s_waitcnt vmcnt(12)
    v_bitop3_b32 v244, v192, v196, v240 bitop3:0x7e
    v_bitop3_b32 v245, v200, v204, v240 bitop3:0x7e
    v_bitop3_b32 v244, v244, s93, v245 bitop3:0xc8
    v_cmp_ne_u32 vcc, 0, v244
    v_exp_f32 v112, v112
    v_exp_f32 v113, v113
    v_exp_f32 v114, v114
    v_exp_f32 v115, v115
    v_cvt_pk_bf16_f32 v140, v112, v113
    v_cvt_pk_bf16_f32 v141, v114, v115
    v_mfma_f32_32x32x16_bf16 v[56:71], v[188:191], v[148:151], v[56:71]
    s_cbranch_vccnz b_chk7_r
b_chk7_d:
    v_exp_f32 v116, v116
    v_exp_f32 v117, v117
    v_exp_f32 v118, v118
    v_exp_f32 v119, v119
    v_cvt_pk_bf16_f32 v142, v116, v117
    v_cvt_pk_bf16_f32 v143, v118, v119
    v_mfma_f32_32x32x16_bf16 v[104:119], v[192:195], v[8:11], 0
    v_exp_f32 v120, v120
    v_exp_f32 v121, v121
    v_exp_f32 v122, v122
    v_exp_f32 v123, v123
    v_cvt_pk_bf16_f32 v144, v120, v121
    v_cvt_pk_bf16_f32 v145, v122, v123
    v_mfma_f32_32x32x16_bf16 v[104:119], v[196:199], v[12:15], v[104:119]
    v_exp_f32 v124, v124
    v_exp_f32 v125, v125
    v_exp_f32 v126, v126
    v_exp_f32 v127, v127
    v_cvt_pk_bf16_f32 v146, v124, v125
    v_cvt_pk_bf16_f32 v147, v126, v127
    v_mfma_f32_32x32x16_bf16 v[72:87], v[184:187], v[136:139], v[72:87]
    v_exp_f32 v128, v128
    v_exp_f32 v129, v129
    v_exp_f32 v130, v130
    v_exp_f32 v131, v131
    v_cvt_pk_bf16_f32 v148, v128, v129
    v_cvt_pk_bf16_f32 v149, v130, v131
    v_mfma_f32_32x32x16_bf16 v[72:87], v[188:191], v[140:143], v[72:87]
    s_add_u32 s13, s65, 6144
    v_exp_f32 v132, v132
    v_exp_f32 v133, v133
    v_exp_f32 v134, v134
    v_exp_f32 v135, v135
    v_cvt_pk_bf16_f32 v150, v132, v133
    v_cvt_pk_bf16_f32 v151, v134, v135
    v_mfma_f32_32x32x16_bf16 v[120:135], v[192:195], v[16:19], 0
    s_and_b32 s13, s13, 0xffff
    v_exp_f32 v104, v104
    v_exp_f32 v105, v105
    v_exp_f32 v106, v106
    v_exp_f32 v107, v107
    v_cvt_pk_bf16_f32 v136, v104, v105
    v_cvt_pk_bf16_f32 v137, v106, v107
    v_mfma_f32_32x32x16_bf16 v[120:135], v[196:199], v[20:23], v[120:135]
    s_add_u32 s13, s13, s68
    v_exp_f32 v108, v108
    v_exp_f32 v109, v109
    v_exp_f32 v110, v110
    v_exp_f32 v111, v111
    v_cvt_pk_bf16_f32 v138, v108, v109
    v_cvt_pk_bf16_f32 v139, v110, v111
    v_mfma_f32_32x32x16_bf16 v[88:103], v[184:187], v[144:147], v[88:103]
    s_add_u32 s6, s32, s13
    s_addc_u32 s7, s33, 0
    v_exp_f32 v112, v112
    v_exp_f32 v113, v113
    v_exp_f32 v114, v114
    v_exp_f32 v115, v115
    v_cvt_pk_bf16_f32 v140, v112, v113
    v_cvt_pk_bf16_f32 v141, v114, v115
    v_mfma_f32_32x32x16_bf16 v[88:103], v[188:191], v[148:151], v[88:103]
    global_load_dwordx4 v[176:179], v3, s[6:7] offset:0
    global_load_dwordx4 v[180:183], v3, s[6:7] offset:1024
    global_load_dwordx4 v[184:187], v2, s[6:7] offset:0
    global_load_dwordx4 v[188:191], v2, s[6:7] offset:1024
    v_exp_f32 v116, v116
    v_exp_f32 v117, v117
    v_exp_f32 v118, v118
    v_exp_f32 v119, v119
    v_cvt_pk_bf16_f32 v142, v116, v117
    v_cvt_pk_bf16_f32 v143, v118, v119
    v_mfma_f32_32x32x16_bf16 v[104:119], v[192:195], v[24:27], 0
    v_exp_f32 v120, v120
    v_exp_f32 v121, v121
    v_exp_f32 v122, v122
    v_exp_f32 v123, v123
    v_cvt_pk_bf16_f32 v144, v120, v121
    v_cvt_pk_bf16_f32 v145, v122, v123
    v_mfma_f32_32x32x16_bf16 v[104:119], v[196:199], v[28:31], v[104:119]
    v_exp_f32 v124, v124
    v_exp_f32 v125, v125
    v_exp_f32 v126, v126
    v_exp_f32 v127, v127
    v_cvt_pk_bf16_f32 v146, v124, v125
    v_cvt_pk_bf16_f32 v147, v126, v127
    v_mfma_f32_32x32x16_bf16 v[40:55], v[200:203], v[136:139], v[40:55]
    v_exp_f32 v128, v128
    v_exp_f32 v129, v129
    v_exp_f32 v130, v130
    v_exp_f32 v131, v131
    v_cvt_pk_bf16_f32 v148, v128, v129
    v_cvt_pk_bf16_f32 v149, v130, v131
    v_mfma_f32_32x32x16_bf16 v[40:55], v[204:207], v[140:143], v[40:55]
    v_exp_f32 v132, v132
    v_exp_f32 v133, v133
    v_exp_f32 v134, v134
    v_exp_f32 v135, v135
    v_cvt_pk_bf16_f32 v150, v132, v133
    v_cvt_pk_bf16_f32 v151, v134, v135
    v_mfma_f32_32x32x16_bf16 v[120:135], v[192:195], v[32:35], 0
    v_exp_f32 v104, v104
    v_exp_f32 v105, v105
    v_exp_f32 v106, v106
    v_exp_f32 v107, v107
    v_cvt_pk_bf16_f32 v136, v104, v105
    v_cvt_pk_bf16_f32 v137, v106, v107
    v_mfma_f32_32x32x16_bf16 v[120:135], v[196:199], v[36:39], v[120:135]
    v_exp_f32 v108, v108
    v_exp_f32 v109, v109
    v_exp_f32 v110, v110
    v_exp_f32 v111, v111
    v_cvt_pk_bf16_f32 v138, v108, v109
    v_cvt_pk_bf16_f32 v139, v110, v111
    v_mfma_f32_32x32x16_bf16 v[56:71], v[200:203], v[144:147], v[56:71]
    s_waitcnt vmcnt(12)
    v_bitop3_b32 v244, v208, v212, v240 bitop3:0x7e
    v_bitop3_b32 v245, v216, v220, v240 bitop3:0x7e
    v_bitop3_b32 v244, v244, s93, v245 bitop3:0xc8
    v_cmp_ne_u32 vcc, 0, v244
    v_exp_f32 v112, v112
    v_exp_f32 v113, v113
    v_exp_f32 v114, v114
    v_exp_f32 v115, v115
    v_cvt_pk_bf16_f32 v140, v112, v113
    v_cvt_pk_bf16_f32 v141, v114, v115
    v_mfma_f32_32x32x16_bf16 v[56:71], v[204:207], v[148:151], v[56:71]
    s_cbranch_vccnz b_chk8_r
b_chk8_d:
    v_exp_f32 v116, v116
    v_exp_f32 v117, v117
    v_exp_f32 v118, v118
    v_exp_f32 v119, v119
    v_cvt_pk_bf16_f32 v142, v116, v117
    v_cvt_pk_bf16_f32 v143, v118, v119
    v_mfma_f32_32x32x16_bf16 v[104:119], v[208:211], v[8:11], 0
    v_exp_f32 v120, v120
    v_exp_f32 v121, v121
    v_exp_f32 v122, v122
    v_exp_f32 v123, v123
    v_cvt_pk_bf16_f32 v144, v120, v121
    v_cvt_pk_bf16_f32 v145, v122, v123
    v_mfma_f32_32x32x16_bf16 v[104:119], v[212:215], v[12:15], v[104:119]
    v_exp_f32 v124, v124
    v_exp_f32 v125, v125
    v_exp_f32 v126, v126
    v_exp_f32 v127, v127
    v_cvt_pk_bf16_f32 v146, v124, v125
    v_cvt_pk_bf16_f32 v147, v126, v127
    v_mfma_f32_32x32x16_bf16 v[72:87], v[200:203], v[136:139], v[72:87]
    v_exp_f32 v128, v128
    v_exp_f32 v129, v129
    v_exp_f32 v130, v130
    v_exp_f32 v131, v131
    v_cvt_pk_bf16_f32 v148, v128, v129
    v_cvt_pk_bf16_f32 v149, v130, v131
    v_mfma_f32_32x32x16_bf16 v[72:87], v[204:207], v[140:143], v[72:87]
    s_add_u32 s13, s65, 8192
    v_exp_f32 v132, v132
    v_exp_f32 v133, v133
    v_exp_f32 v134, v134
    v_exp_f32 v135, v135
    v_cvt_pk_bf16_f32 v150, v132, v133
    v_cvt_pk_bf16_f32 v151, v134, v135
    v_mfma_f32_32x32x16_bf16 v[120:135], v[208:211], v[16:19], 0
    s_and_b32 s13, s13, 0xffff
    v_exp_f32 v104, v104
    v_exp_f32 v105, v105
    v_exp_f32 v106, v106
    v_exp_f32 v107, v107
    v_cvt_pk_bf16_f32 v136, v104, v105
    v_cvt_pk_bf16_f32 v137, v106, v107
    v_mfma_f32_32x32x16_bf16 v[120:135], v[212:215], v[20:23], v[120:135]
    s_add_u32 s13, s13, s68
    v_exp_f32 v108, v108
    v_exp_f32 v109, v109
    v_exp_f32 v110, v110
    v_exp_f32 v111, v111
    v_cvt_pk_bf16_f32 v138, v108, v109
    v_cvt_pk_bf16_f32 v139, v110, v111
    v_mfma_f32_32x32x16_bf16 v[88:103], v[200:203], v[144:147], v[88:103]
    s_add_u32 s6, s32, s13
    s_addc_u32 s7, s33, 0
    v_exp_f32 v112, v112
    v_exp_f32 v113, v113
    v_exp_f32 v114, v114
    v_exp_f32 v115, v115
    v_cvt_pk_bf16_f32 v140, v112, v113
    v_cvt_pk_bf16_f32 v141, v114, v115
    v_mfma_f32_32x32x16_bf16 v[88:103], v[204:207], v[148:151], v[88:103]
    global_load_dwordx4 v[192:195], v3, s[6:7] offset:0
    global_load_dwordx4 v[196:199], v3, s[6:7] offset:1024
    global_load_dwordx4 v[200:203], v2, s[6:7] offset:0
    global_load_dwordx4 v[204:207], v2, s[6:7] offset:1024
    v_exp_f32 v116, v116
    v_exp_f32 v117, v117
    v_exp_f32 v118, v118
    v_exp_f32 v119, v119
    v_cvt_pk_bf16_f32 v142, v116, v117
    v_cvt_pk_bf16_f32 v143, v118, v119
    v_mfma_f32_32x32x16_bf16 v[104:119], v[208:211], v[24:27], 0
    v_exp_f32 v120, v120
    v_exp_f32 v121, v121
    v_exp_f32 v122, v122
    v_exp_f32 v123, v123
    v_cvt_pk_bf16_f32 v144, v120, v121
    v_cvt_pk_bf16_f32 v145, v122, v123
    v_mfma_f32_32x32x16_bf16 v[104:119], v[212:215], v[28:31], v[104:119]
    v_exp_f32 v124, v124
    v_exp_f32 v125, v125
    v_exp_f32 v126, v126
    v_exp_f32 v127, v127
    v_cvt_pk_bf16_f32 v146, v124, v125
    v_cvt_pk_bf16_f32 v147, v126, v127
    v_mfma_f32_32x32x16_bf16 v[40:55], v[216:219], v[136:139], v[40:55]
    v_exp_f32 v128, v128
    v_exp_f32 v129, v129
    v_exp_f32 v130, v130
    v_exp_f32 v131, v131
    v_cvt_pk_bf16_f32 v148, v128, v129
    v_cvt_pk_bf16_f32 v149, v130, v131
    v_mfma_f32_32x32x16_bf16 v[40:55], v[220:223], v[140:143], v[40:55]
    v_exp_f32 v132, v132
    v_exp_f32 v133, v133
    v_exp_f32 v134, v134
    v_exp_f32 v135, v135
    v_cvt_pk_bf16_f32 v150, v132, v133
    v_cvt_pk_bf16_f32 v151, v134, v135
    v_mfma_f32_32x32x16_bf16 v[120:135], v[208:211], v[32:35], 0
    v_exp_f32 v104, v104
    v_exp_f32 v105, v105
    v_exp_f32 v106, v106
    v_exp_f32 v107, v107
    v_cvt_pk_bf16_f32 v136, v104, v105
    v_cvt_pk_bf16_f32 v137, v106, v107
    v_mfma_f32_32x32x16_bf16 v[120:135], v[212:215], v[36:39], v[120:135]
    v_exp_f32 v108, v108
    v_exp_f32 v109, v109
    v_exp_f32 v110, v110
    v_exp_f32 v111, v111
    v_cvt_pk_bf16_f32 v138, v108, v109
    v_cvt_pk_bf16_f32 v139, v110, v111
    v_mfma_f32_32x32x16_bf16 v[56:71], v[216:219], v[144:147], v[56:71]
    s_waitcnt vmcnt(12)
    v_bitop3_b32 v244, v224, v228, v240 bitop3:0x7e
    v_bitop3_b32 v245, v232, v236, v240 bitop3:0x7e
    v_bitop3_b32 v244, v244, s93, v245 bitop3:0xc8
    v_cmp_ne_u32 vcc, 0, v244
    v_exp_f32 v112, v112
    v_exp_f32 v113, v113
    v_exp_f32 v114, v114
    v_exp_f32 v115, v115
    v_cvt_pk_bf16_f32 v140, v112, v113
    v_cvt_pk_bf16_f32 v141, v114, v115
    v_mfma_f32_32x32x16_bf16 v[56:71], v[220:223], v[148:151], v[56:71]
    s_cbranch_vccnz b_chk9_r
b_chk9_d:
    v_exp_f32 v116, v116
    v_exp_f32 v117, v117
    v_exp_f32 v118, v118
    v_exp_f32 v119, v119
    v_cvt_pk_bf16_f32 v142, v116, v117
    v_cvt_pk_bf16_f32 v143, v118, v119
    v_mfma_f32_32x32x16_bf16 v[104:119], v[224:227], v[8:11], 0
    v_exp_f32 v120, v120
    v_exp_f32 v121, v121
    v_exp_f32 v122, v122
    v_exp_f32 v123, v123
    v_cvt_pk_bf16_f32 v144, v120, v121
    v_cvt_pk_bf16_f32 v145, v122, v123
    v_mfma_f32_32x32x16_bf16 v[104:119], v[228:231], v[12:15], v[104:119]
    v_exp_f32 v124, v124
    v_exp_f32 v125, v125
    v_exp_f32 v126, v126
    v_exp_f32 v127, v127
    v_cvt_pk_bf16_f32 v146, v124, v125
    v_cvt_pk_bf16_f32 v147, v126, v127
    v_mfma_f32_32x32x16_bf16 v[72:87], v[216:219], v[136:139], v[72:87]
    v_exp_f32 v128, v128
    v_exp_f32 v129, v129
    v_exp_f32 v130, v130
    v_exp_f32 v131, v131
    v_cvt_pk_bf16_f32 v148, v128, v129
    v_cvt_pk_bf16_f32 v149, v130, v131
    v_mfma_f32_32x32x16_bf16 v[72:87], v[220:223], v[140:143], v[72:87]
    s_add_u32 s13, s65, 10240
    v_exp_f32 v132, v132
    v_exp_f32 v133, v133
    v_exp_f32 v134, v134
    v_exp_f32 v135, v135
    v_cvt_pk_bf16_f32 v150, v132, v133
    v_cvt_pk_bf16_f32 v151, v134, v135
    v_mfma_f32_32x32x16_bf16 v[120:135], v[224:227], v[16:19], 0
    s_and_b32 s13, s13, 0xffff
    v_exp_f32 v104, v104
    v_exp_f32 v105, v105
    v_exp_f32 v106, v106
    v_exp_f32 v107, v107
    v_cvt_pk_bf16_f32 v136, v104, v105
    v_cvt_pk_bf16_f32 v137, v106, v107
    v_mfma_f32_32x32x16_bf16 v[120:135], v[228:231], v[20:23], v[120:135]
    s_add_u32 s13, s13, s68
    v_exp_f32 v108, v108
    v_exp_f32 v109, v109
    v_exp_f32 v110, v110
    v_exp_f32 v111, v111
    v_cvt_pk_bf16_f32 v138, v108, v109
    v_cvt_pk_bf16_f32 v139, v110, v111
    v_mfma_f32_32x32x16_bf16 v[88:103], v[216:219], v[144:147], v[88:103]
    s_add_u32 s6, s32, s13
    s_addc_u32 s7, s33, 0
    v_exp_f32 v112, v112
    v_exp_f32 v113, v113
    v_exp_f32 v114, v114
    v_exp_f32 v115, v115
    v_cvt_pk_bf16_f32 v140, v112, v113
    v_cvt_pk_bf16_f32 v141, v114, v115
    v_mfma_f32_32x32x16_bf16 v[88:103], v[220:223], v[148:151], v[88:103]
    global_load_dwordx4 v[208:211], v3, s[6:7] offset:0
    global_load_dwordx4 v[212:215], v3, s[6:7] offset:1024
    global_load_dwordx4 v[216:219], v2, s[6:7] offset:0
    global_load_dwordx4 v[220:223], v2, s[6:7] offset:1024
    v_exp_f32 v116, v116
    v_exp_f32 v117, v117
    v_exp_f32 v118, v118
    v_exp_f32 v119, v119
    v_cvt_pk_bf16_f32 v142, v116, v117
    v_cvt_pk_bf16_f32 v143, v118, v119
    v_mfma_f32_32x32x16_bf16 v[104:119], v[224:227], v[24:27], 0
    v_exp_f32 v120, v120
    v_exp_f32 v121, v121
    v_exp_f32 v122, v122
    v_exp_f32 v123, v123
    v_cvt_pk_bf16_f32 v144, v120, v121
    v_cvt_pk_bf16_f32 v145, v122, v123
    v_mfma_f32_32x32x16_bf16 v[104:119], v[228:231], v[28:31], v[104:119]
    v_exp_f32 v124, v124
    v_exp_f32 v125, v125
    v_exp_f32 v126, v126
    v_exp_f32 v127, v127
    v_cvt_pk_bf16_f32 v146, v124, v125
    v_cvt_pk_bf16_f32 v147, v126, v127
    v_mfma_f32_32x32x16_bf16 v[40:55], v[232:235], v[136:139], v[40:55]
    v_exp_f32 v128, v128
    v_exp_f32 v129, v129
    v_exp_f32 v130, v130
    v_exp_f32 v131, v131
    v_cvt_pk_bf16_f32 v148, v128, v129
    v_cvt_pk_bf16_f32 v149, v130, v131
    v_mfma_f32_32x32x16_bf16 v[40:55], v[236:239], v[140:143], v[40:55]
    v_exp_f32 v132, v132
    v_exp_f32 v133, v133
    v_exp_f32 v134, v134
    v_exp_f32 v135, v135
    v_cvt_pk_bf16_f32 v150, v132, v133
    v_cvt_pk_bf16_f32 v151, v134, v135
    v_mfma_f32_32x32x16_bf16 v[120:135], v[224:227], v[32:35], 0
    v_exp_f32 v104, v104
    v_exp_f32 v105, v105
    v_exp_f32 v106, v106
    v_exp_f32 v107, v107
    v_cvt_pk_bf16_f32 v136, v104, v105
    v_cvt_pk_bf16_f32 v137, v106, v107
    v_mfma_f32_32x32x16_bf16 v[120:135], v[228:231], v[36:39], v[120:135]
    v_exp_f32 v108, v108
    v_exp_f32 v109, v109
    v_exp_f32 v110, v110
    v_exp_f32 v111, v111
    v_cvt_pk_bf16_f32 v138, v108, v109
    v_cvt_pk_bf16_f32 v139, v110, v111
    v_mfma_f32_32x32x16_bf16 v[56:71], v[232:235], v[144:147], v[56:71]
    s_waitcnt vmcnt(12)
    v_bitop3_b32 v244, v160, v164, v240 bitop3:0x7e
    v_bitop3_b32 v245, v168, v172, v240 bitop3:0x7e
    v_bitop3_b32 v244, v244, s93, v245 bitop3:0xc8
    v_cmp_ne_u32 vcc, 0, v244
    v_exp_f32 v112, v112
    v_exp_f32 v113, v113
    v_exp_f32 v114, v114
    v_exp_f32 v115, v115
    v_cvt_pk_bf16_f32 v140, v112, v113
    v_cvt_pk_bf16_f32 v141, v114, v115
    v_mfma_f32_32x32x16_bf16 v[56:71], v[236:239], v[148:151], v[56:71]
    s_cbranch_vccnz b_chk10_r
b_chk10_d:
    v_exp_f32 v116, v116
    v_exp_f32 v117, v117
    v_exp_f32 v118, v118
    v_exp_f32 v119, v119
    v_cvt_pk_bf16_f32 v142, v116, v117
    v_cvt_pk_bf16_f32 v143, v118, v119
    v_mfma_f32_32x32x16_bf16 v[104:119], v[160:163], v[8:11], 0
    v_exp_f32 v120, v120
    v_exp_f32 v121, v121
    v_exp_f32 v122, v122
    v_exp_f32 v123, v123
    v_cvt_pk_bf16_f32 v144, v120, v121
    v_cvt_pk_bf16_f32 v145, v122, v123
    v_mfma_f32_32x32x16_bf16 v[104:119], v[164:167], v[12:15], v[104:119]
    v_exp_f32 v124, v124
    v_exp_f32 v125, v125
    v_exp_f32 v126, v126
    v_exp_f32 v127, v127
    v_cvt_pk_bf16_f32 v146, v124, v125
    v_cvt_pk_bf16_f32 v147, v126, v127
    v_mfma_f32_32x32x16_bf16 v[72:87], v[232:235], v[136:139], v[72:87]
    v_exp_f32 v128, v128
    v_exp_f32 v129, v129
    v_exp_f32 v130, v130
    v_exp_f32 v131, v131
    v_cvt_pk_bf16_f32 v148, v128, v129
    v_cvt_pk_bf16_f32 v149, v130, v131
    v_mfma_f32_32x32x16_bf16 v[72:87], v[236:239], v[140:143], v[72:87]
    s_add_u32 s13, s65, 12288
    v_exp_f32 v132, v132
    v_exp_f32 v133, v133
    v_exp_f32 v134, v134
    v_exp_f32 v135, v135
    v_cvt_pk_bf16_f32 v150, v132, v133
    v_cvt_pk_bf16_f32 v151, v134, v135
    v_mfma_f32_32x32x16_bf16 v[120:135], v[160:163], v[16:19], 0
    s_and_b32 s13, s13, 0xffff
    v_exp_f32 v104, v104
    v_exp_f32 v105, v105
    v_exp_f32 v106, v106
    v_exp_f32 v107, v107
    v_cvt_pk_bf16_f32 v136, v104, v105
    v_cvt_pk_bf16_f32 v137, v106, v107
    v_mfma_f32_32x32x16_bf16 v[120:135], v[164:167], v[20:23], v[120:135]
    s_add_u32 s13, s13, s68
    v_exp_f32 v108, v108
    v_exp_f32 v109, v109
    v_exp_f32 v110, v110
    v_exp_f32 v111, v111
    v_cvt_pk_bf16_f32 v138, v108, v109
    v_cvt_pk_bf16_f32 v139, v110, v111
    v_mfma_f32_32x32x16_bf16 v[88:103], v[232:235], v[144:147], v[88:103]
    s_add_u32 s6, s32, s13
    s_addc_u32 s7, s33, 0
    v_exp_f32 v112, v112
    v_exp_f32 v113, v113
    v_exp_f32 v114, v114
    v_exp_f32 v115, v115
    v_cvt_pk_bf16_f32 v140, v112, v113
    v_cvt_pk_bf16_f32 v141, v114, v115
    v_mfma_f32_32x32x16_bf16 v[88:103], v[236:239], v[148:151], v[88:103]
    global_load_dwordx4 v[224:227], v3, s[6:7] offset:0
    global_load_dwordx4 v[228:231], v3, s[6:7] offset:1024
    global_load_dwordx4 v[232:235], v2, s[6:7] offset:0
    global_load_dwordx4 v[236:239], v2, s[6:7] offset:1024
    v_exp_f32 v116, v116
    v_exp_f32 v117, v117
    v_exp_f32 v118, v118
    v_exp_f32 v119, v119
    v_cvt_pk_bf16_f32 v142, v116, v117
    v_cvt_pk_bf16_f32 v143, v118, v119
    v_mfma_f32_32x32x16_bf16 v[104:119], v[160:163], v[24:27], 0
    v_exp_f32 v120, v120
    v_exp_f32 v121, v121
    v_exp_f32 v122, v122
    v_exp_f32 v123, v123
    v_cvt_pk_bf16_f32 v144, v120, v121
    v_cvt_pk_bf16_f32 v145, v122, v123
    v_mfma_f32_32x32x16_bf16 v[104:119], v[164:167], v[28:31], v[104:119]
    v_exp_f32 v124, v124
    v_exp_f32 v125, v125
    v_exp_f32 v126, v126
    v_exp_f32 v127, v127
    v_cvt_pk_bf16_f32 v146, v124, v125
    v_cvt_pk_bf16_f32 v147, v126, v127
    v_mfma_f32_32x32x16_bf16 v[40:55], v[168:171], v[136:139], v[40:55]
    v_exp_f32 v128, v128
    v_exp_f32 v129, v129
    v_exp_f32 v130, v130
    v_exp_f32 v131, v131
    v_cvt_pk_bf16_f32 v148, v128, v129
    v_cvt_pk_bf16_f32 v149, v130, v131
    v_mfma_f32_32x32x16_bf16 v[40:55], v[172:175], v[140:143], v[40:55]
    v_exp_f32 v132, v132
    v_exp_f32 v133, v133
    v_exp_f32 v134, v134
    v_exp_f32 v135, v135
    v_cvt_pk_bf16_f32 v150, v132, v133
    v_cvt_pk_bf16_f32 v151, v134, v135
    v_mfma_f32_32x32x16_bf16 v[120:135], v[160:163], v[32:35], 0
    v_exp_f32 v104, v104
    v_exp_f32 v105, v105
    v_exp_f32 v106, v106
    v_exp_f32 v107, v107
    v_cvt_pk_bf16_f32 v136, v104, v105
    v_cvt_pk_bf16_f32 v137, v106, v107
    v_mfma_f32_32x32x16_bf16 v[120:135], v[164:167], v[36:39], v[120:135]
    v_exp_f32 v108, v108
    v_exp_f32 v109, v109
    v_exp_f32 v110, v110
    v_exp_f32 v111, v111
    v_cvt_pk_bf16_f32 v138, v108, v109
    v_cvt_pk_bf16_f32 v139, v110, v111
    v_mfma_f32_32x32x16_bf16 v[56:71], v[168:171], v[144:147], v[56:71]
    s_waitcnt vmcnt(12)
    v_bitop3_b32 v244, v176, v180, v240 bitop3:0x7e
    v_bitop3_b32 v245, v184, v188, v240 bitop3:0x7e
    v_bitop3_b32 v244, v244, s93, v245 bitop3:0xc8
    v_cmp_ne_u32 vcc, 0, v244
    v_exp_f32 v112, v112
    v_exp_f32 v113, v113
    v_exp_f32 v114, v114
    v_exp_f32 v115, v115
    v_cvt_pk_bf16_f32 v140, v112, v113
    v_cvt_pk_bf16_f32 v141, v114, v115
    v_mfma_f32_32x32x16_bf16 v[56:71], v[172:175], v[148:151], v[56:71]
    s_cbranch_vccnz b_chk11_r
b_chk11_d:
    v_exp_f32 v116, v116
    v_exp_f32 v117, v117
    v_exp_f32 v118, v118
    v_exp_f32 v119, v119
    v_cvt_pk_bf16_f32 v142, v116, v117
    v_cvt_pk_bf16_f32 v143, v118, v119
    v_mfma_f32_32x32x16_bf16 v[104:119], v[176:179], v[8:11], 0
    v_exp_f32 v120, v120
    v_exp_f32 v121, v121
    v_exp_f32 v122, v122
    v_exp_f32 v123, v123
    v_cvt_pk_bf16_f32 v144, v120, v121
    v_cvt_pk_bf16_f32 v145, v122, v123
    v_mfma_f32_32x32x16_bf16 v[104:119], v[180:183], v[12:15], v[104:119]
    v_exp_f32 v124, v124
    v_exp_f32 v125, v125
    v_exp_f32 v126, v126
    v_exp_f32 v127, v127
    v_cvt_pk_bf16_f32 v146, v124, v125
    v_cvt_pk_bf16_f32 v147, v126, v127
    v_mfma_f32_32x32x16_bf16 v[72:87], v[168:171], v[136:139], v[72:87]
    v_exp_f32 v128, v128
    v_exp_f32 v129, v129
    v_exp_f32 v130, v130
    v_exp_f32 v131, v131
    v_cvt_pk_bf16_f32 v148, v128, v129
    v_cvt_pk_bf16_f32 v149, v130, v131
    v_mfma_f32_32x32x16_bf16 v[72:87], v[172:175], v[140:143], v[72:87]
    s_add_u32 s13, s65, 14336
    v_exp_f32 v132, v132
    v_exp_f32 v133, v133
    v_exp_f32 v134, v134
    v_exp_f32 v135, v135
    v_cvt_pk_bf16_f32 v150, v132, v133
    v_cvt_pk_bf16_f32 v151, v134, v135
    v_mfma_f32_32x32x16_bf16 v[120:135], v[176:179], v[16:19], 0
    s_and_b32 s13, s13, 0xffff
    v_exp_f32 v104, v104
    v_exp_f32 v105, v105
    v_exp_f32 v106, v106
    v_exp_f32 v107, v107
    v_cvt_pk_bf16_f32 v136, v104, v105
    v_cvt_pk_bf16_f32 v137, v106, v107
    v_mfma_f32_32x32x16_bf16 v[120:135], v[180:183], v[20:23], v[120:135]
    s_add_u32 s13, s13, s68
    v_exp_f32 v108, v108
    v_exp_f32 v109, v109
    v_exp_f32 v110, v110
    v_exp_f32 v111, v111
    v_cvt_pk_bf16_f32 v138, v108, v109
    v_cvt_pk_bf16_f32 v139, v110, v111
    v_mfma_f32_32x32x16_bf16 v[88:103], v[168:171], v[144:147], v[88:103]
    s_add_u32 s6, s32, s13
    s_addc_u32 s7, s33, 0
    v_exp_f32 v112, v112
    v_exp_f32 v113, v113
    v_exp_f32 v114, v114
    v_exp_f32 v115, v115
    v_cvt_pk_bf16_f32 v140, v112, v113
    v_cvt_pk_bf16_f32 v141, v114, v115
    v_mfma_f32_32x32x16_bf16 v[88:103], v[172:175], v[148:151], v[88:103]
    global_load_dwordx4 v[160:163], v3, s[6:7] offset:0
    global_load_dwordx4 v[164:167], v3, s[6:7] offset:1024
    global_load_dwordx4 v[168:171], v2, s[6:7] offset:0
    global_load_dwordx4 v[172:175], v2, s[6:7] offset:1024
    v_exp_f32 v116, v116
    v_exp_f32 v117, v117
    v_exp_f32 v118, v118
    v_exp_f32 v119, v119
    v_cvt_pk_bf16_f32 v142, v116, v117
    v_cvt_pk_bf16_f32 v143, v118, v119
    v_mfma_f32_32x32x16_bf16 v[104:119], v[176:179], v[24:27], 0
    v_exp_f32 v120, v120
    v_exp_f32 v121, v121
    v_exp_f32 v122, v122
    v_exp_f32 v123, v123
    v_cvt_pk_bf16_f32 v144, v120, v121
    v_cvt_pk_bf16_f32 v145, v122, v123
    v_mfma_f32_32x32x16_bf16 v[104:119], v[180:183], v[28:31], v[104:119]
    v_exp_f32 v124, v124
    v_exp_f32 v125, v125
    v_exp_f32 v126, v126
    v_exp_f32 v127, v127
    v_cvt_pk_bf16_f32 v146, v124, v125
    v_cvt_pk_bf16_f32 v147, v126, v127
    v_mfma_f32_32x32x16_bf16 v[40:55], v[184:187], v[136:139], v[40:55]
    v_exp_f32 v128, v128
    v_exp_f32 v129, v129
    v_exp_f32 v130, v130
    v_exp_f32 v131, v131
    v_cvt_pk_bf16_f32 v148, v128, v129
    v_cvt_pk_bf16_f32 v149, v130, v131
    v_mfma_f32_32x32x16_bf16 v[40:55], v[188:191], v[140:143], v[40:55]
    v_exp_f32 v132, v132
    v_exp_f32 v133, v133
    v_exp_f32 v134, v134
    v_exp_f32 v135, v135
    v_cvt_pk_bf16_f32 v150, v132, v133
    v_cvt_pk_bf16_f32 v151, v134, v135
    v_mfma_f32_32x32x16_bf16 v[120:135], v[176:179], v[32:35], 0
    v_exp_f32 v104, v104
    v_exp_f32 v105, v105
    v_exp_f32 v106, v106
    v_exp_f32 v107, v107
    v_cvt_pk_bf16_f32 v136, v104, v105
    v_cvt_pk_bf16_f32 v137, v106, v107
    v_mfma_f32_32x32x16_bf16 v[120:135], v[180:183], v[36:39], v[120:135]
    v_exp_f32 v108, v108
    v_exp_f32 v109, v109
    v_exp_f32 v110, v110
    v_exp_f32 v111, v111
    v_cvt_pk_bf16_f32 v138, v108, v109
    v_cvt_pk_bf16_f32 v139, v110, v111
    v_mfma_f32_32x32x16_bf16 v[56:71], v[184:187], v[144:147], v[56:71]
    s_waitcnt vmcnt(12)
    v_bitop3_b32 v244, v192, v196, v240 bitop3:0x7e
    v_bitop3_b32 v245, v200, v204, v240 bitop3:0x7e
    v_bitop3_b32 v244, v244, s93, v245 bitop3:0xc8
    v_cmp_ne_u32 vcc, 0, v244
    v_exp_f32 v112, v112
    v_exp_f32 v113, v113
    v_exp_f32 v114, v114
    v_exp_f32 v115, v115
    v_cvt_pk_bf16_f32 v140, v112, v113
    v_cvt_pk_bf16_f32 v141, v114, v115
    v_mfma_f32_32x32x16_bf16 v[56:71], v[188:191], v[148:151], v[56:71]
    s_cbranch_vccnz b_chk12_r
b_chk12_d:
    v_exp_f32 v116, v116
    v_exp_f32 v117, v117
    v_exp_f32 v118, v118
    v_exp_f32 v119, v119
    v_cvt_pk_bf16_f32 v142, v116, v117
    v_cvt_pk_bf16_f32 v143, v118, v119
    v_mfma_f32_32x32x16_bf16 v[104:119], v[192:195], v[8:11], 0
    v_exp_f32 v120, v120
    v_exp_f32 v121, v121
    v_exp_f32 v122, v122
    v_exp_f32 v123, v123
    v_cvt_pk_bf16_f32 v144, v120, v121
    v_cvt_pk_bf16_f32 v145, v122, v123
    v_mfma_f32_32x32x16_bf16 v[104:119], v[196:199], v[12:15], v[104:119]
    v_exp_f32 v124, v124
    v_exp_f32 v125, v125
    v_exp_f32 v126, v126
    v_exp_f32 v127, v127
    v_cvt_pk_bf16_f32 v146, v124, v125
    v_cvt_pk_bf16_f32 v147, v126, v127
    v_mfma_f32_32x32x16_bf16 v[72:87], v[184:187], v[136:139], v[72:87]
    v_exp_f32 v128, v128
    v_exp_f32 v129, v129
    v_exp_f32 v130, v130
    v_exp_f32 v131, v131
    v_cvt_pk_bf16_f32 v148, v128, v129
    v_cvt_pk_bf16_f32 v149, v130, v131
    v_mfma_f32_32x32x16_bf16 v[72:87], v[188:191], v[140:143], v[72:87]
    v_exp_f32 v132, v132
    v_exp_f32 v133, v133
    v_exp_f32 v134, v134
    v_exp_f32 v135, v135
    v_cvt_pk_bf16_f32 v150, v132, v133
    v_cvt_pk_bf16_f32 v151, v134, v135
    v_mfma_f32_32x32x16_bf16 v[120:135], v[192:195], v[16:19], 0
    v_exp_f32 v104, v104
    v_exp_f32 v105, v105
    v_exp_f32 v106, v106
    v_exp_f32 v107, v107
    v_cvt_pk_bf16_f32 v136, v104, v105
    v_cvt_pk_bf16_f32 v137, v106, v107
    v_mfma_f32_32x32x16_bf16 v[120:135], v[196:199], v[20:23], v[120:135]
    v_exp_f32 v108, v108
    v_exp_f32 v109, v109
    v_exp_f32 v110, v110
    v_exp_f32 v111, v111
    v_cvt_pk_bf16_f32 v138, v108, v109
    v_cvt_pk_bf16_f32 v139, v110, v111
    v_mfma_f32_32x32x16_bf16 v[88:103], v[184:187], v[144:147], v[88:103]
    v_exp_f32 v112, v112
    v_exp_f32 v113, v113
    v_exp_f32 v114, v114
    v_exp_f32 v115, v115
    v_cvt_pk_bf16_f32 v140, v112, v113
    v_cvt_pk_bf16_f32 v141, v114, v115
    v_mfma_f32_32x32x16_bf16 v[88:103], v[188:191], v[148:151], v[88:103]
    v_exp_f32 v116, v116
    v_exp_f32 v117, v117
    v_exp_f32 v118, v118
    v_exp_f32 v119, v119
    v_cvt_pk_bf16_f32 v142, v116, v117
    v_cvt_pk_bf16_f32 v143, v118, v119
    v_mfma_f32_32x32x16_bf16 v[104:119], v[192:195], v[24:27], 0
    v_exp_f32 v120, v120
    v_exp_f32 v121, v121
    v_exp_f32 v122, v122
    v_exp_f32 v123, v123
    v_cvt_pk_bf16_f32 v144, v120, v121
    v_cvt_pk_bf16_f32 v145, v122, v123
    v_mfma_f32_32x32x16_bf16 v[104:119], v[196:199], v[28:31], v[104:119]
    v_exp_f32 v124, v124
    v_exp_f32 v125, v125
    v_exp_f32 v126, v126
    v_exp_f32 v127, v127
    v_cvt_pk_bf16_f32 v146, v124, v125
    v_cvt_pk_bf16_f32 v147, v126, v127
    v_mfma_f32_32x32x16_bf16 v[40:55], v[200:203], v[136:139], v[40:55]
    v_exp_f32 v128, v128
    v_exp_f32 v129, v129
    v_exp_f32 v130, v130
    v_exp_f32 v131, v131
    v_cvt_pk_bf16_f32 v148, v128, v129
    v_cvt_pk_bf16_f32 v149, v130, v131
    v_mfma_f32_32x32x16_bf16 v[40:55], v[204:207], v[140:143], v[40:55]
    v_exp_f32 v132, v132
    v_exp_f32 v133, v133
    v_exp_f32 v134, v134
    v_exp_f32 v135, v135
    v_cvt_pk_bf16_f32 v150, v132, v133
    v_cvt_pk_bf16_f32 v151, v134, v135
    v_mfma_f32_32x32x16_bf16 v[120:135], v[192:195], v[32:35], 0
    v_exp_f32 v104, v104
    v_exp_f32 v105, v105
    v_exp_f32 v106, v106
    v_exp_f32 v107, v107
    v_cvt_pk_bf16_f32 v136, v104, v105
    v_cvt_pk_bf16_f32 v137, v106, v107
    v_mfma_f32_32x32x16_bf16 v[120:135], v[196:199], v[36:39], v[120:135]
    v_exp_f32 v108, v108
    v_exp_f32 v109, v109
    v_exp_f32 v110, v110
    v_exp_f32 v111, v111
    v_cvt_pk_bf16_f32 v138, v108, v109
    v_cvt_pk_bf16_f32 v139, v110, v111
    v_mfma_f32_32x32x16_bf16 v[56:71], v[200:203], v[144:147], v[56:71]
    s_waitcnt vmcnt(8)
    v_bitop3_b32 v244, v208, v212, v240 bitop3:0x7e
    v_bitop3_b32 v245, v216, v220, v240 bitop3:0x7e
    v_bitop3_b32 v244, v244, s93, v245 bitop3:0xc8
    v_cmp_ne_u32 vcc, 0, v244
    v_exp_f32 v112, v112
    v_exp_f32 v113, v113
    v_exp_f32 v114, v114
    v_exp_f32 v115, v115
    v_cvt_pk_bf16_f32 v140, v112, v113
    v_cvt_pk_bf16_f32 v141, v114, v115
    v_mfma_f32_32x32x16_bf16 v[56:71], v[204:207], v[148:151], v[56:71]
    s_cbranch_vccnz b_chk13_r
b_chk13_d:
    v_exp_f32 v116, v116
    v_exp_f32 v117, v117
    v_exp_f32 v118, v118
    v_exp_f32 v119, v119
    v_cvt_pk_bf16_f32 v142, v116, v117
    v_cvt_pk_bf16_f32 v143, v118, v119
    v_mfma_f32_32x32x16_bf16 v[104:119], v[208:211], v[8:11], 0
    v_exp_f32 v120, v120
    v_exp_f32 v121, v121
    v_exp_f32 v122, v122
    v_exp_f32 v123, v123
    v_cvt_pk_bf16_f32 v144, v120, v121
    v_cvt_pk_bf16_f32 v145, v122, v123
    v_mfma_f32_32x32x16_bf16 v[104:119], v[212:215], v[12:15], v[104:119]
    v_exp_f32 v124, v124
    v_exp_f32 v125, v125
    v_exp_f32 v126, v126
    v_exp_f32 v127, v127
    v_cvt_pk_bf16_f32 v146, v124, v125
    v_cvt_pk_bf16_f32 v147, v126, v127
    v_mfma_f32_32x32x16_bf16 v[72:87], v[200:203], v[136:139], v[72:87]
    s_waitcnt vmcnt(4)
    v_bitop3_b32 v244, v224, v228, v240 bitop3:0x7e
    v_bitop3_b32 v245, v232, v236, v240 bitop3:0x7e
    v_bitop3_b32 v244, v244, s93, v245 bitop3:0xc8
    v_cmp_ne_u32 vcc, 0, v244
    v_exp_f32 v128, v128
    v_exp_f32 v129, v129
    v_exp_f32 v130, v130
    v_exp_f32 v131, v131
    v_cvt_pk_bf16_f32 v148, v128, v129
    v_cvt_pk_bf16_f32 v149, v130, v131
    v_mfma_f32_32x32x16_bf16 v[72:87], v[204:207], v[140:143], v[72:87]
    s_cbranch_vccnz b_chk14_r
b_chk14_d:
    v_exp_f32 v132, v132
    v_exp_f32 v133, v133
    v_exp_f32 v134, v134
    v_exp_f32 v135, v135
    v_cvt_pk_bf16_f32 v150, v132, v133
    v_cvt_pk_bf16_f32 v151, v134, v135
    v_mfma_f32_32x32x16_bf16 v[120:135], v[224:227], v[8:11], 0
    v_exp_f32 v104, v104
    v_exp_f32 v105, v105
    v_exp_f32 v106, v106
    v_exp_f32 v107, v107
    v_cvt_pk_bf16_f32 v136, v104, v105
    v_cvt_pk_bf16_f32 v137, v106, v107
    v_mfma_f32_32x32x16_bf16 v[120:135], v[228:231], v[12:15], v[120:135]
    v_exp_f32 v108, v108
    v_exp_f32 v109, v109
    v_exp_f32 v110, v110
    v_exp_f32 v111, v111
    v_cvt_pk_bf16_f32 v138, v108, v109
    v_cvt_pk_bf16_f32 v139, v110, v111
    v_mfma_f32_32x32x16_bf16 v[88:103], v[200:203], v[144:147], v[88:103]
    s_waitcnt vmcnt(0)
    v_bitop3_b32 v244, v160, v164, v240 bitop3:0x7e
    v_bitop3_b32 v245, v168, v172, v240 bitop3:0x7e
    v_bitop3_b32 v244, v244, s93, v245 bitop3:0xc8
    v_cmp_ne_u32 vcc, 0, v244
    v_exp_f32 v112, v112
    v_exp_f32 v113, v113
    v_exp_f32 v114, v114
    v_exp_f32 v115, v115
    v_cvt_pk_bf16_f32 v140, v112, v113
    v_cvt_pk_bf16_f32 v141, v114, v115
    v_mfma_f32_32x32x16_bf16 v[88:103], v[204:207], v[148:151], v[88:103]
    s_cbranch_vccnz b_chk15_r
b_chk15_d:
    v_exp_f32 v116, v116
    v_exp_f32 v117, v117
    v_exp_f32 v118, v118
    v_exp_f32 v119, v119
    v_cvt_pk_bf16_f32 v142, v116, v117
    v_cvt_pk_bf16_f32 v143, v118, v119
    v_mfma_f32_32x32x16_bf16 v[104:119], v[160:163], v[8:11], 0
    v_exp_f32 v120, v120
    v_exp_f32 v121, v121
    v_exp_f32 v122, v122
    v_exp_f32 v123, v123
    v_cvt_pk_bf16_f32 v144, v120, v121
    v_cvt_pk_bf16_f32 v145, v122, v123
    v_mfma_f32_32x32x16_bf16 v[104:119], v[164:167], v[12:15], v[104:119]
    v_exp_f32 v124, v124
    v_exp_f32 v125, v125
    v_exp_f32 v126, v126
    v_exp_f32 v127, v127
    v_cvt_pk_bf16_f32 v146, v124, v125
    v_cvt_pk_bf16_f32 v147, v126, v127
    v_mfma_f32_32x32x16_bf16 v[40:55], v[216:219], v[136:139], v[40:55]
    v_exp_f32 v128, v128
    v_exp_f32 v129, v129
    v_exp_f32 v130, v130
    v_exp_f32 v131, v131
    v_cvt_pk_bf16_f32 v148, v128, v129
    v_cvt_pk_bf16_f32 v149, v130, v131
    v_mfma_f32_32x32x16_bf16 v[40:55], v[220:223], v[140:143], v[40:55]
    v_exp_f32 v132, v132
    v_exp_f32 v133, v133
    v_exp_f32 v134, v134
    v_exp_f32 v135, v135
    v_cvt_pk_bf16_f32 v150, v132, v133
    v_cvt_pk_bf16_f32 v151, v134, v135
    v_mfma_f32_32x32x16_bf16 v[120:135], v[208:211], v[16:19], 0
    ds_read_b32 v6, v4 offset:20
    v_exp_f32 v104, v104
    v_exp_f32 v105, v105
    v_exp_f32 v106, v106
    v_exp_f32 v107, v107
    v_cvt_pk_bf16_f32 v136, v104, v105
    v_cvt_pk_bf16_f32 v137, v106, v107
    v_mfma_f32_32x32x16_bf16 v[120:135], v[212:215], v[20:23], v[120:135]
    v_exp_f32 v108, v108
    v_exp_f32 v109, v109
    v_exp_f32 v110, v110
    v_exp_f32 v111, v111
    v_cvt_pk_bf16_f32 v138, v108, v109
    v_cvt_pk_bf16_f32 v139, v110, v111
    v_mfma_f32_32x32x16_bf16 v[40:55], v[232:235], v[144:147], v[40:55]
    v_exp_f32 v112, v112
    v_exp_f32 v113, v113
    v_exp_f32 v114, v114
    v_exp_f32 v115, v115
    v_cvt_pk_bf16_f32 v140, v112, v113
    v_cvt_pk_bf16_f32 v141, v114, v115
    v_mfma_f32_32x32x16_bf16 v[40:55], v[236:239], v[148:151], v[40:55]
    v_exp_f32 v116, v116
    v_exp_f32 v117, v117
    v_exp_f32 v118, v118
    v_exp_f32 v119, v119
    v_cvt_pk_bf16_f32 v142, v116, v117
    v_cvt_pk_bf16_f32 v143, v118, v119
    v_mfma_f32_32x32x16_bf16 v[104:119], v[224:227], v[16:19], 0
    v_exp_f32 v120, v120
    v_exp_f32 v121, v121
    v_exp_f32 v122, v122
    v_exp_f32 v123, v123
    v_cvt_pk_bf16_f32 v144, v120, v121
    v_cvt_pk_bf16_f32 v145, v122, v123
    v_mfma_f32_32x32x16_bf16 v[104:119], v[228:231], v[20:23], v[104:119]
    v_exp_f32 v124, v124
    v_exp_f32 v125, v125
    v_exp_f32 v126, v126
    v_exp_f32 v127, v127
    v_cvt_pk_bf16_f32 v146, v124, v125
    v_cvt_pk_bf16_f32 v147, v126, v127
    v_mfma_f32_32x32x16_bf16 v[40:55], v[168:171], v[136:139], v[40:55]
    v_exp_f32 v128, v128
    v_exp_f32 v129, v129
    v_exp_f32 v130, v130
    v_exp_f32 v131, v131
    v_cvt_pk_bf16_f32 v148, v128, v129
    v_cvt_pk_bf16_f32 v149, v130, v131
    v_mfma_f32_32x32x16_bf16 v[40:55], v[172:175], v[140:143], v[40:55]
    v_exp_f32 v132, v132
    v_exp_f32 v133, v133
    v_exp_f32 v134, v134
    v_exp_f32 v135, v135
    v_cvt_pk_bf16_f32 v150, v132, v133
    v_cvt_pk_bf16_f32 v151, v134, v135
    s_waitcnt lgkmcnt(0)
    v_readfirstlane_b32 s8, v6
    s_nop 3
    s_cmp_ge_u32 s8, 4
    s_cbranch_scc1 ad_32
    s_mov_b32 s69, 400000
wc_33:
    ds_read_b32 v6, v4 offset:20
    s_waitcnt lgkmcnt(0)
    v_readfirstlane_b32 s8, v6
    s_sub_u32 s69, s69, 1
    s_cmp_ge_u32 s8, 4
    s_cbranch_scc1 wc_33_d
    s_sleep 1
    s_cmp_lg_u32 s69, 0
    s_cbranch_scc1 wc_33
wc_33_d:
ad_32:
    s_add_u32 s8, s5, 1
    s_and_b32 s8, s8, 3
    s_mul_i32 s8, s8, 12288
    s_add_u32 s8, s8, 101376
    v_add_u32 v156, s8, v3
    v_mfma_f32_32x32x16_bf16 v[120:135], v[160:163], v[16:19], 0
    v_exp_f32 v104, v104
    v_exp_f32 v105, v105
    v_exp_f32 v106, v106
    v_exp_f32 v107, v107
    v_cvt_pk_bf16_f32 v136, v104, v105
    v_cvt_pk_bf16_f32 v137, v106, v107
    v_mfma_f32_32x32x16_bf16 v[120:135], v[164:167], v[20:23], v[120:135]
    ds_write_b128 v156, v[40:43] offset:0
    ds_write_b128 v156, v[44:47] offset:1024
    v_exp_f32 v108, v108
    v_exp_f32 v109, v109
    v_exp_f32 v110, v110
    v_exp_f32 v111, v111
    v_cvt_pk_bf16_f32 v138, v108, v109
    v_cvt_pk_bf16_f32 v139, v110, v111
    v_mfma_f32_32x32x16_bf16 v[56:71], v[216:219], v[144:147], v[56:71]
    ds_write_b128 v156, v[48:51] offset:2048
    v_exp_f32 v112, v112
    v_exp_f32 v113, v113
    v_exp_f32 v114, v114
    v_exp_f32 v115, v115
    v_cvt_pk_bf16_f32 v140, v112, v113
    v_cvt_pk_bf16_f32 v141, v114, v115
    v_mfma_f32_32x32x16_bf16 v[56:71], v[220:223], v[148:151], v[56:71]
    ds_write_b128 v156, v[52:55] offset:3072
    v_exp_f32 v116, v116
    v_exp_f32 v117, v117
    v_exp_f32 v118, v118
    v_exp_f32 v119, v119
    v_cvt_pk_bf16_f32 v142, v116, v117
    v_cvt_pk_bf16_f32 v143, v118, v119
    v_mfma_f32_32x32x16_bf16 v[104:119], v[208:211], v[24:27], 0
    v_exp_f32 v120, v120
    v_exp_f32 v121, v121
    v_exp_f32 v122, v122
    v_exp_f32 v123, v123
    v_cvt_pk_bf16_f32 v144, v120, v121
    v_cvt_pk_bf16_f32 v145, v122, v123
    v_mfma_f32_32x32x16_bf16 v[104:119], v[212:215], v[28:31], v[104:119]
    v_exp_f32 v124, v124
    v_exp_f32 v125, v125
    v_exp_f32 v126, v126
    v_exp_f32 v127, v127
    v_cvt_pk_bf16_f32 v146, v124, v125
    v_cvt_pk_bf16_f32 v147, v126, v127
    v_mfma_f32_32x32x16_bf16 v[56:71], v[232:235], v[136:139], v[56:71]
    v_exp_f32 v128, v128
    v_exp_f32 v129, v129
    v_exp_f32 v130, v130
    v_exp_f32 v131, v131
    v_cvt_pk_bf16_f32 v148, v128, v129
    v_cvt_pk_bf16_f32 v149, v130, v131
    v_mfma_f32_32x32x16_bf16 v[56:71], v[236:239], v[140:143], v[56:71]
    v_exp_f32 v132, v132
    v_exp_f32 v133, v133
    v_exp_f32 v134, v134
    v_exp_f32 v135, v135
    v_cvt_pk_bf16_f32 v150, v132, v133
    v_cvt_pk_bf16_f32 v151, v134, v135
    v_mfma_f32_32x32x16_bf16 v[120:135], v[224:227], v[24:27], 0
    v_exp_f32 v104, v104
    v_exp_f32 v105, v105
    v_exp_f32 v106, v106
    v_exp_f32 v107, v107
    v_cvt_pk_bf16_f32 v136, v104, v105
    v_cvt_pk_bf16_f32 v137, v106, v107
    v_mfma_f32_32x32x16_bf16 v[120:135], v[228:231], v[28:31], v[120:135]
    v_exp_f32 v108, v108
    v_exp_f32 v109, v109
    v_exp_f32 v110, v110
    v_exp_f32 v111, v111
    v_cvt_pk_bf16_f32 v138, v108, v109
    v_cvt_pk_bf16_f32 v139, v110, v111
    v_mfma_f32_32x32x16_bf16 v[56:71], v[168:171], v[144:147], v[56:71]
    v_exp_f32 v112, v112
    v_exp_f32 v113, v113
    v_exp_f32 v114, v114
    v_exp_f32 v115, v115
    v_cvt_pk_bf16_f32 v140, v112, v113
    v_cvt_pk_bf16_f32 v141, v114, v115
    v_mfma_f32_32x32x16_bf16 v[56:71], v[172:175], v[148:151], v[56:71]
    v_exp_f32 v116, v116
    v_exp_f32 v117, v117
    v_exp_f32 v118, v118
    v_exp_f32 v119, v119
    v_cvt_pk_bf16_f32 v142, v116, v117
    v_cvt_pk_bf16_f32 v143, v118, v119
    s_add_u32 s8, s5, 2
    s_and_b32 s8, s8, 3
    s_mul_i32 s8, s8, 12288
    s_add_u32 s8, s8, 105472
    v_add_u32 v156, s8, v3
    v_mfma_f32_32x32x16_bf16 v[104:119], v[160:163], v[24:27], 0
    v_exp_f32 v120, v120
    v_exp_f32 v121, v121
    v_exp_f32 v122, v122
    v_exp_f32 v123, v123
    v_cvt_pk_bf16_f32 v144, v120, v121
    v_cvt_pk_bf16_f32 v145, v122, v123
    v_mfma_f32_32x32x16_bf16 v[104:119], v[164:167], v[28:31], v[104:119]
    ds_write_b128 v156, v[56:59] offset:0
    ds_write_b128 v156, v[60:63] offset:1024
    v_exp_f32 v124, v124
    v_exp_f32 v125, v125
    v_exp_f32 v126, v126
    v_exp_f32 v127, v127
    v_cvt_pk_bf16_f32 v146, v124, v125
    v_cvt_pk_bf16_f32 v147, v126, v127
    v_mfma_f32_32x32x16_bf16 v[72:87], v[216:219], v[136:139], v[72:87]
    ds_write_b128 v156, v[64:67] offset:2048
    v_exp_f32 v128, v128
    v_exp_f32 v129, v129
    v_exp_f32 v130, v130
    v_exp_f32 v131, v131
    v_cvt_pk_bf16_f32 v148, v128, v129
    v_cvt_pk_bf16_f32 v149, v130, v131
    v_mfma_f32_32x32x16_bf16 v[72:87], v[220:223], v[140:143], v[72:87]
    ds_write_b128 v156, v[68:71] offset:3072
    v_exp_f32 v132, v132
    v_exp_f32 v133, v133
    v_exp_f32 v134, v134
    v_exp_f32 v135, v135
    v_cvt_pk_bf16_f32 v150, v132, v133
    v_cvt_pk_bf16_f32 v151, v134, v135
    v_mfma_f32_32x32x16_bf16 v[120:135], v[208:211], v[32:35], 0
    v_exp_f32 v104, v104
    v_exp_f32 v105, v105
    v_exp_f32 v106, v106
    v_exp_f32 v107, v107
    v_cvt_pk_bf16_f32 v136, v104, v105
    v_cvt_pk_bf16_f32 v137, v106, v107
    v_mfma_f32_32x32x16_bf16 v[120:135], v[212:215], v[36:39], v[120:135]
    v_exp_f32 v108, v108
    v_exp_f32 v109, v109
    v_exp_f32 v110, v110
    v_exp_f32 v111, v111
    v_cvt_pk_bf16_f32 v138, v108, v109
    v_cvt_pk_bf16_f32 v139, v110, v111
    v_mfma_f32_32x32x16_bf16 v[72:87], v[232:235], v[144:147], v[72:87]
    v_exp_f32 v112, v112
    v_exp_f32 v113, v113
    v_exp_f32 v114, v114
    v_exp_f32 v115, v115
    v_cvt_pk_bf16_f32 v140, v112, v113
    v_cvt_pk_bf16_f32 v141, v114, v115
    v_mfma_f32_32x32x16_bf16 v[72:87], v[236:239], v[148:151], v[72:87]
    v_exp_f32 v116, v116
    v_exp_f32 v117, v117
    v_exp_f32 v118, v118
    v_exp_f32 v119, v119
    v_cvt_pk_bf16_f32 v142, v116, v117
    v_cvt_pk_bf16_f32 v143, v118, v119
    v_mfma_f32_32x32x16_bf16 v[104:119], v[224:227], v[32:35], 0
    v_exp_f32 v120, v120
    v_exp_f32 v121, v121
    v_exp_f32 v122, v122
    v_exp_f32 v123, v123
    v_cvt_pk_bf16_f32 v144, v120, v121
    v_cvt_pk_bf16_f32 v145, v122, v123
    v_mfma_f32_32x32x16_bf16 v[104:119], v[228:231], v[36:39], v[104:119]
    v_exp_f32 v124, v124
    v_exp_f32 v125, v125
    v_exp_f32 v126, v126
    v_exp_f32 v127, v127
    v_cvt_pk_bf16_f32 v146, v124, v125
    v_cvt_pk_bf16_f32 v147, v126, v127
    v_mfma_f32_32x32x16_bf16 v[72:87], v[168:171], v[136:139], v[72:87]
    v_exp_f32 v128, v128
    v_exp_f32 v129, v129
    v_exp_f32 v130, v130
    v_exp_f32 v131, v131
    v_cvt_pk_bf16_f32 v148, v128, v129
    v_cvt_pk_bf16_f32 v149, v130, v131
    v_mfma_f32_32x32x16_bf16 v[72:87], v[172:175], v[140:143], v[72:87]
    v_exp_f32 v132, v132
    v_exp_f32 v133, v133
    v_exp_f32 v134, v134
    v_exp_f32 v135, v135
    v_cvt_pk_bf16_f32 v150, v132, v133
    v_cvt_pk_bf16_f32 v151, v134, v135
    s_add_u32 s8, s5, 3
    s_and_b32 s8, s8, 3
    s_mul_i32 s8, s8, 12288
    s_add_u32 s8, s8, 109568
    v_add_u32 v156, s8, v3
    v_mfma_f32_32x32x16_bf16 v[120:135], v[160:163], v[32:35], 0
    v_exp_f32 v104, v104
    v_exp_f32 v105, v105
    v_exp_f32 v106, v106
    v_exp_f32 v107, v107
    v_cvt_pk_bf16_f32 v136, v104, v105
    v_cvt_pk_bf16_f32 v137, v106, v107
    v_mfma_f32_32x32x16_bf16 v[120:135], v[164:167], v[36:39], v[120:135]
    ds_write_b128 v156, v[72:75] offset:0
    ds_write_b128 v156, v[76:79] offset:1024
    v_exp_f32 v108, v108
    v_exp_f32 v109, v109
    v_exp_f32 v110, v110
    v_exp_f32 v111, v111
    v_cvt_pk_bf16_f32 v138, v108, v109
    v_cvt_pk_bf16_f32 v139, v110, v111
    v_mfma_f32_32x32x16_bf16 v[88:103], v[216:219], v[144:147], v[88:103]
    ds_write_b128 v156, v[80:83] offset:2048
    v_exp_f32 v112, v112
    v_exp_f32 v113, v113
    v_exp_f32 v114, v114
    v_exp_f32 v115, v115
    v_cvt_pk_bf16_f32 v140, v112, v113
    v_cvt_pk_bf16_f32 v141, v114, v115
    v_mfma_f32_32x32x16_bf16 v[88:103], v[220:223], v[148:151], v[88:103]
    ds_write_b128 v156, v[84:87] offset:3072
    v_exp_f32 v116, v116
    v_exp_f32 v117, v117
    v_exp_f32 v118, v118
    v_exp_f32 v119, v119
    v_cvt_pk_bf16_f32 v142, v116, v117
    v_cvt_pk_bf16_f32 v143, v118, v119
    v_exp_f32 v120, v120
    v_exp_f32 v121, v121
    v_exp_f32 v122, v122
    v_exp_f32 v123, v123
    v_cvt_pk_bf16_f32 v144, v120, v121
    v_cvt_pk_bf16_f32 v145, v122, v123
    v_exp_f32 v124, v124
    v_exp_f32 v125, v125
    v_exp_f32 v126, v126
    v_exp_f32 v127, v127
    v_cvt_pk_bf16_f32 v146, v124, v125
    v_cvt_pk_bf16_f32 v147, v126, v127
    v_mfma_f32_32x32x16_bf16 v[88:103], v[232:235], v[136:139], v[88:103]
    s_waitcnt lgkmcnt(0)
    s_mov_b64 exec, 1
    ds_add_u32 v4, v5 offset:36
    s_mov_b64 exec, -1
    v_exp_f32 v128, v128
    v_exp_f32 v129, v129
    v_exp_f32 v130, v130
    v_exp_f32 v131, v131
    v_cvt_pk_bf16_f32 v148, v128, v129
    v_cvt_pk_bf16_f32 v149, v130, v131
    v_mfma_f32_32x32x16_bf16 v[88:103], v[236:239], v[140:143], v[88:103]
    v_exp_f32 v132, v132
    v_exp_f32 v133, v133
    v_exp_f32 v134, v134
    v_exp_f32 v135, v135
    v_cvt_pk_bf16_f32 v150, v132, v133
    v_cvt_pk_bf16_f32 v151, v134, v135
    s_nop 1
    v_mfma_f32_32x32x16_bf16 v[88:103], v[168:171], v[144:147], v[88:103]
    v_mfma_f32_32x32x16_bf16 v[88:103], v[172:175], v[148:151], v[88:103]
    s_mov_b32 s69, 400000
wc_34:
    ds_read_b32 v6, v4 offset:36
    s_waitcnt lgkmcnt(0)
    v_readfirstlane_b32 s8, v6
    s_sub_u32 s69, s69, 1
    s_cmp_ge_u32 s8, s66
    s_cbranch_scc1 wc_34_d
    s_sleep 1
    s_cmp_lg_u32 s69, 0
    s_cbranch_scc1 wc_34
wc_34_d:
    s_mul_i32 s8, s5, 12288
    s_add_u32 s8, s8, 101376
    v_add_u32 v156, s8, v3
    ds_read_b128 v[40:43], v156 offset:0
    ds_read_b128 v[44:47], v156 offset:1024
    ds_read_b128 v[48:51], v156 offset:2048
    ds_read_b128 v[52:55], v156 offset:3072
    ds_read_b128 v[56:59], v156 offset:4096
    ds_read_b128 v[60:63], v156 offset:5120
    ds_read_b128 v[64:67], v156 offset:6144
    ds_read_b128 v[68:71], v156 offset:7168
    ds_read_b128 v[72:75], v156 offset:8192
    ds_read_b128 v[76:79], v156 offset:9216
    ds_read_b128 v[80:83], v156 offset:10240
    ds_read_b128 v[84:87], v156 offset:11264
    s_mov_b32 s8, 0x17800000
    s_mov_b32 s9, 0x71800000
    s_mov_b32 s10, 0x7f000000
    s_waitcnt lgkmcnt(8)
    v_pk_add_f32 v[100:101], v[100:101], v[52:53]
    v_pk_add_f32 v[102:103], v[102:103], v[54:55]
    v_pk_add_f32 v[88:89], v[88:89], v[40:41]
    v_pk_add_f32 v[90:91], v[90:91], v[42:43]
    v_pk_add_f32 v[92:93], v[92:93], v[44:45]
    v_pk_add_f32 v[94:95], v[94:95], v[46:47]
    v_pk_add_f32 v[96:97], v[96:97], v[48:49]
    v_pk_add_f32 v[98:99], v[98:99], v[50:51]
    s_waitcnt lgkmcnt(4)
    v_pk_add_f32 v[100:101], v[100:101], v[68:69]
    v_pk_add_f32 v[102:103], v[102:103], v[70:71]
    v_pk_add_f32 v[88:89], v[88:89], v[56:57]
    v_pk_add_f32 v[90:91], v[90:91], v[58:59]
    v_pk_add_f32 v[92:93], v[92:93], v[60:61]
    v_pk_add_f32 v[94:95], v[94:95], v[62:63]
    v_pk_add_f32 v[96:97], v[96:97], v[64:65]
    v_pk_add_f32 v[98:99], v[98:99], v[66:67]
    s_waitcnt lgkmcnt(0)
    v_pk_add_f32 v[100:101], v[100:101], v[84:85]
    v_pk_add_f32 v[102:103], v[102:103], v[86:87]
    v_pk_add_f32 v[88:89], v[88:89], v[72:73]
    v_pk_add_f32 v[90:91], v[90:91], v[74:75]
    v_pk_add_f32 v[92:93], v[92:93], v[76:77]
    v_pk_add_f32 v[94:95], v[94:95], v[78:79]
    v_pk_add_f32 v[96:97], v[96:97], v[80:81]
    v_pk_add_f32 v[98:99], v[98:99], v[82:83]
    v_mov_b32 v156, v100
    v_mov_b32 v157, v100
    v_pk_add_f32 v[40:41], v[88:89], v[90:91]
    v_pk_add_f32 v[42:43], v[92:93], v[94:95]
    v_pk_add_f32 v[44:45], v[96:97], v[98:99]
    v_pk_add_f32 v[46:47], v[100:101], v[102:103]
    v_permlane32_swap_b32 v156, v157
    v_pk_add_f32 v[40:41], v[40:41], v[44:45]
    v_pk_add_f32 v[42:43], v[42:43], v[46:47]
    v_cmp_le_f32 s[52:53], s8, v157
    v_cmp_ge_f32 s[54:55], s9, v157
    v_rcp_f32 v156, v157
    v_pk_add_f32 v[40:41], v[40:41], v[42:43]
    v_add_f32 v40, v40, v41
    v_cmp_ge_f32 s[56:57], s10, abs(v40)
    v_pk_mul_f32 v[88:89], v[88:89], v[156:157] op_sel_hi:[1,0]
    v_pk_mul_f32 v[90:91], v[90:91], v[156:157] op_sel_hi:[1,0]
    v_pk_mul_f32 v[92:93], v[92:93], v[156:157] op_sel_hi:[1,0]
    v_pk_mul_f32 v[94:95], v[94:95], v[156:157] op_sel_hi:[1,0]
    v_pk_mul_f32 v[96:97], v[96:97], v[156:157] op_sel_hi:[1,0]
    v_pk_mul_f32 v[98:99], v[98:99], v[156:157] op_sel_hi:[1,0]
    v_pk_mul_f32 v[100:101], v[100:101], v[156:157] op_sel_hi:[1,0]
    v_pk_mul_f32 v[102:103], v[102:103], v[156:157] op_sel_hi:[1,0]
    s_and_b64 s[52:53], s[52:53], s[54:55]
    s_and_b64 s[52:53], s[52:53], s[56:57]
    v_cvt_pk_bf16_f32 v136, v88, v89
    v_cvt_pk_bf16_f32 v137, v90, v91
    v_cvt_pk_bf16_f32 v138, v92, v93
    v_cvt_pk_bf16_f32 v139, v94, v95
    v_cvt_pk_bf16_f32 v140, v96, v97
    v_cvt_pk_bf16_f32 v141, v98, v99
    v_cvt_pk_bf16_f32 v142, v100, v101
    v_cvt_pk_bf16_f32 v143, v102, v103
    s_mov_b32 exec_lo, 0
    v_mov_b32 v142, 0
    v_mov_b32 v143, 0
    s_mov_b64 exec, -1
    v_bfi_b32 v136, s93, v240, v136
    v_bfi_b32 v140, s93, v240, v140
    s_lshl_b32 s10, s4, 2
    s_add_u32 s10, s10, s5
    s_lshl_b32 s10, s10, 4
    s_add_u32 s10, s10, s3
    s_lshl_b32 s8, s10, 11
    s_add_u32 s8, s8, 4194304
    s_cmp_lg_u32 s64, 0
    s_cbranch_scc1 b_nofail
    s_cmp_eq_u64 s[52:53], -1
    s_cbranch_scc1 b_nofail
    s_mov_b64 exec, 1
    ds_add_u32 v4, v5 offset:52
    s_mov_b64 exec, -1
    s_branch b_nost
b_nofail:
    buffer_store_dwordx4 v[136:139], v3, s[44:47], s8 offen offset:0 sc1
    buffer_store_dwordx4 v[140:143], v3, s[44:47], s8 offen offset:1024 sc1
b_nost:
    s_waitcnt lgkmcnt(0)
    s_mov_b64 exec, 1
    ds_add_u32 v4, v5 offset:40
    s_mov_b64 exec, -1
    s_mov_b32 s69, 400000
wc_35:
    ds_read_b32 v6, v4 offset:40
    s_waitcnt lgkmcnt(0)
    v_readfirstlane_b32 s8, v6
    s_sub_u32 s69, s69, 1
    s_cmp_ge_u32 s8, s66
    s_cbranch_scc1 wc_35_d
    s_sleep 1
    s_cmp_lg_u32 s69, 0
    s_cbranch_scc1 wc_35
wc_35_d:
    s_cmp_lg_u32 s64, 0
    s_cbranch_scc1 b_pub
    ds_read_b32 v6, v4 offset:52
    s_waitcnt lgkmcnt(0)
    v_readfirstlane_b32 s8, v6
    s_nop 3
    s_cmp_lg_u32 s8, 0
    s_cbranch_scc1 b_slow
b_pub:
    s_mov_b32 s69, 400000
wc_36:
    ds_read_b32 v6, v4 offset:48
    s_waitcnt lgkmcnt(0)
    v_readfirstlane_b32 s8, v6
    s_sub_u32 s69, s69, 1
    s_cmp_ge_u32 s8, 4
    s_cbranch_scc1 wc_36_d
    s_sleep 1
    s_cmp_lg_u32 s69, 0
    s_cbranch_scc1 wc_36
wc_36_d:
    v_lshrrev_b32 v6, 5, v1
    v_lshlrev_b32 v6, 4, v6
    v_bfe_u32 v7, v1, 2, 2
    v_add_u32 v6, v6, v7
    v_mul_u32_u24 v6, 224, v6
    v_and_b32 v7, 1, v1
    v_lshl_add_u32 v6, v7, 5, v6
    v_bfe_u32 v7, v1, 4, 1
    v_lshl_add_u32 v6, v7, 4, v6
    v_bfe_u32 v7, v1, 1, 1
    v_lshl_add_u32 v6, v7, 3, v6
    s_lshl_b32 s8, s5, 6
    v_add_u32 v6, s8, v6
    s_add_u32 s8, s5, 0
    s_and_b32 s8, s8, 3
    s_mul_i32 s9, s8, 25088
    v_add_u32 v244, s9, v6
    s_add_u32 s8, s5, 1
    s_and_b32 s8, s8, 3
    s_mul_i32 s9, s8, 25088
    v_add_u32 v245, s9, v6
    s_lshl_b32 s8, s8, 13
    s_add_u32 s8, s8, 101376
    v_add_u32 v248, s8, v3
    s_add_u32 s8, s5, 2
    s_and_b32 s8, s8, 3
    s_mul_i32 s9, s8, 25088
    v_add_u32 v246, s9, v6
    s_lshl_b32 s8, s8, 13
    s_add_u32 s8, s8, 101376
    v_add_u32 v249, s8, v3
    s_add_u32 s8, s5, 3
    s_and_b32 s8, s8, 3
    s_mul_i32 s9, s8, 25088
    v_add_u32 v247, s9, v6
    s_lshl_b32 s8, s8, 13
    s_add_u32 s8, s8, 101376
    v_add_u32 v250, s8, v3
    ds_read_b64_tr_b16 v[8:9], v244 offset:0
    ds_read_b64_tr_b16 v[10:11], v244 offset:896
    ds_read_b64_tr_b16 v[12:13], v244 offset:1792
    ds_read_b64_tr_b16 v[14:15], v244 offset:2688
    ds_read_b64_tr_b16 v[16:17], v244 offset:6272
    ds_read_b64_tr_b16 v[18:19], v244 offset:7168
    ds_read_b64_tr_b16 v[20:21], v244 offset:8064
    ds_read_b64_tr_b16 v[22:23], v244 offset:8960
    ds_read_b64_tr_b16 v[24:25], v244 offset:12544
    ds_read_b64_tr_b16 v[26:27], v244 offset:13440
    ds_read_b64_tr_b16 v[28:29], v244 offset:14336
    ds_read_b64_tr_b16 v[30:31], v244 offset:15232
    ds_read_b64_tr_b16 v[32:33], v244 offset:18816
    ds_read_b64_tr_b16 v[34:35], v244 offset:19712
    ds_read_b64_tr_b16 v[36:37], v244 offset:20608
    ds_read_b64_tr_b16 v[38:39], v244 offset:21504
    ds_read_b64_tr_b16 v[40:41], v245 offset:0
    ds_read_b64_tr_b16 v[42:43], v245 offset:896
    ds_read_b64_tr_b16 v[44:45], v245 offset:1792
    ds_read_b64_tr_b16 v[46:47], v245 offset:2688
    ds_read_b64_tr_b16 v[48:49], v245 offset:6272
    ds_read_b64_tr_b16 v[50:51], v245 offset:7168
    ds_read_b64_tr_b16 v[52:53], v245 offset:8064
    ds_read_b64_tr_b16 v[54:55], v245 offset:8960
    ds_read_b64_tr_b16 v[56:57], v245 offset:12544
    ds_read_b64_tr_b16 v[58:59], v245 offset:13440
    ds_read_b64_tr_b16 v[60:61], v245 offset:14336
    ds_read_b64_tr_b16 v[62:63], v245 offset:15232
    ds_read_b64_tr_b16 v[64:65], v245 offset:18816
    ds_read_b64_tr_b16 v[66:67], v245 offset:19712
    ds_read_b64_tr_b16 v[68:69], v245 offset:20608
    ds_read_b64_tr_b16 v[70:71], v245 offset:21504
    ds_read_b64_tr_b16 v[72:73], v246 offset:0
    ds_read_b64_tr_b16 v[74:75], v246 offset:896
    ds_read_b64_tr_b16 v[76:77], v246 offset:1792
    ds_read_b64_tr_b16 v[78:79], v246 offset:2688
    ds_read_b64_tr_b16 v[80:81], v246 offset:6272
    ds_read_b64_tr_b16 v[82:83], v246 offset:7168
    ds_read_b64_tr_b16 v[84:85], v246 offset:8064
    ds_read_b64_tr_b16 v[86:87], v246 offset:8960
    ds_read_b64_tr_b16 v[88:89], v246 offset:12544
    ds_read_b64_tr_b16 v[90:91], v246 offset:13440
    ds_read_b64_tr_b16 v[92:93], v246 offset:14336
    ds_read_b64_tr_b16 v[94:95], v246 offset:15232
    ds_read_b64_tr_b16 v[96:97], v246 offset:18816
    ds_read_b64_tr_b16 v[98:99], v246 offset:19712
    ds_read_b64_tr_b16 v[100:101], v246 offset:20608
    ds_read_b64_tr_b16 v[102:103], v246 offset:21504
    ds_read_b64_tr_b16 v[104:105], v247 offset:0
    ds_read_b64_tr_b16 v[106:107], v247 offset:896
    ds_read_b64_tr_b16 v[108:109], v247 offset:1792
    ds_read_b64_tr_b16 v[110:111], v247 offset:2688
    ds_read_b64_tr_b16 v[112:113], v247 offset:6272
    ds_read_b64_tr_b16 v[114:115], v247 offset:7168
    ds_read_b64_tr_b16 v[116:117], v247 offset:8064
    ds_read_b64_tr_b16 v[118:119], v247 offset:8960
    ds_read_b64_tr_b16 v[120:121], v247 offset:12544
    ds_read_b64_tr_b16 v[122:123], v247 offset:13440
    ds_read_b64_tr_b16 v[124:125], v247 offset:14336
    ds_read_b64_tr_b16 v[126:127], v247 offset:15232
    ds_read_b64_tr_b16 v[128:129], v247 offset:18816
    ds_read_b64_tr_b16 v[130:131], v247 offset:19712
    ds_read_b64_tr_b16 v[132:133], v247 offset:20608
    ds_read_b64_tr_b16 v[134:135], v247 offset:21504
    s_and_b32 s12, s60, 1
    s_lshl_b32 s12, s12, 5
    s_lshr_b32 s11, s60, 1
    s_lshl_b32 s11, s11, 3
    s_add_u32 s12, s12, s11
    s_lshr_b32 s11, s61, 2
    s_add_u32 s12, s12, s11
    s_lshl_b32 s11, s12, 4
    s_lshl_b32 s8, s5, 2
    s_add_u32 s11, s11, s8
    s_lshl_b32 s11, s11, 11
    s_add_u32 s11, s11, 4194304
    s_lshl_b32 s8, s5, 13
    s_add_u32 s8, s8, 101376
    s_mov_b32 s14, 20000
    v_add_u32 v7, s8, v3
    s_mov_b64 s[52:53], -1
    s_mov_b64 s[54:55], -1
    s_mov_b64 s[56:57], -1
    s_mov_b64 s[58:59], -1
b_opoll:
    s_cmp_eq_u64 s[52:53], 0
    s_cbranch_scc1 b_od0
    s_add_u32 m0, s8, 0
    s_add_u32 s9, s11, 0
    buffer_load_dwordx4 v3, s[44:47], s9 offen sc1 lds
    s_add_u32 m0, s8, 1024
    s_add_u32 s9, s11, 1024
    buffer_load_dwordx4 v3, s[44:47], s9 offen sc1 lds
b_od0:
    s_cmp_eq_u64 s[54:55], 0
    s_cbranch_scc1 b_od1
    s_add_u32 m0, s8, 2048
    s_add_u32 s9, s11, 2048
    buffer_load_dwordx4 v3, s[44:47], s9 offen sc1 lds
    s_add_u32 m0, s8, 3072
    s_add_u32 s9, s11, 3072
    buffer_load_dwordx4 v3, s[44:47], s9 offen sc1 lds
b_od1:
    s_cmp_eq_u64 s[56:57], 0
    s_cbranch_scc1 b_od2
    s_add_u32 m0, s8, 4096
    s_add_u32 s9, s11, 4096
    buffer_load_dwordx4 v3, s[44:47], s9 offen sc1 lds
    s_add_u32 m0, s8, 5120
    s_add_u32 s9, s11, 5120
    buffer_load_dwordx4 v3, s[44:47], s9 offen sc1 lds
b_od2:
    s_cmp_eq_u64 s[58:59], 0
    s_cbranch_scc1 b_od3
    s_add_u32 m0, s8, 6144
    s_add_u32 s9, s11, 6144
    buffer_load_dwordx4 v3, s[44:47], s9 offen sc1 lds
    s_add_u32 m0, s8, 7168
    s_add_u32 s9, s11, 7168
    buffer_load_dwordx4 v3, s[44:47], s9 offen sc1 lds
b_od3:
b_opoll1:
    s_waitcnt vmcnt(0)
    s_cmp_eq_u64 s[52:53], 0
    s_cbranch_scc1 b_or0
    ds_read_b128 v[152:155], v7 offset:0
    ds_read_b128 v[156:159], v7 offset:1024
b_or0:
    s_cmp_eq_u64 s[54:55], 0
    s_cbranch_scc1 b_or1
    ds_read_b128 v[160:163], v7 offset:2048
    ds_read_b128 v[164:167], v7 offset:3072
b_or1:
    s_cmp_eq_u64 s[56:57], 0
    s_cbranch_scc1 b_or2
    ds_read_b128 v[168:171], v7 offset:4096
    ds_read_b128 v[172:175], v7 offset:5120
b_or2:
    s_cmp_eq_u64 s[58:59], 0
    s_cbranch_scc1 b_or3
    ds_read_b128 v[176:179], v7 offset:6144
    ds_read_b128 v[180:183], v7 offset:7168
b_or3:
    s_waitcnt lgkmcnt(0)
    v_bitop3_b32 v232, v152, v156, v240 bitop3:0x7e
    v_bitop3_b32 v233, v160, v164, v240 bitop3:0x7e
    v_bitop3_b32 v234, v168, v172, v240 bitop3:0x7e
    v_bitop3_b32 v235, v176, v180, v240 bitop3:0x7e
    v_and_b32 v232, s93, v232
    v_and_b32 v233, s93, v233
    v_and_b32 v234, s93, v234
    v_and_b32 v235, s93, v235
    v_cmp_ne_u32 s[52:53], 0, v232
    v_cmp_ne_u32 s[54:55], 0, v233
    v_cmp_ne_u32 s[56:57], 0, v234
    v_cmp_ne_u32 s[58:59], 0, v235
    s_nop 3
    s_or_b64 vcc, s[52:53], s[54:55]
    s_or_b64 vcc, vcc, s[56:57]
    s_or_b64 vcc, vcc, s[58:59]
    s_cbranch_scc0 b_opoll_d
    s_sleep 2
    s_sub_u32 s14, s14, 1
    s_cmp_lg_u32 s14, 0
    s_cbranch_scc1 b_opoll
b_opoll_d:
    s_mov_b64 exec, 1
    ds_add_u32 v4, v5 offset:44
    s_mov_b64 exec, -1
    v_mfma_f32_32x32x16_bf16 v[216:231], v[8:11], v[152:155], 0
    v_mfma_f32_32x32x16_bf16 v[216:231], v[12:15], v[156:159], v[216:231]
    v_mfma_f32_32x32x16_bf16 v[216:231], v[16:19], v[160:163], v[216:231]
    v_mfma_f32_32x32x16_bf16 v[216:231], v[20:23], v[164:167], v[216:231]
    v_mfma_f32_32x32x16_bf16 v[216:231], v[24:27], v[168:171], v[216:231]
    v_mfma_f32_32x32x16_bf16 v[216:231], v[28:31], v[172:175], v[216:231]
    v_mfma_f32_32x32x16_bf16 v[216:231], v[32:35], v[176:179], v[216:231]
    v_mfma_f32_32x32x16_bf16 v[216:231], v[36:39], v[180:183], v[216:231]
    s_mov_b32 s69, 400000
wc_37:
    ds_read_b32 v6, v4 offset:44
    s_waitcnt lgkmcnt(0)
    v_readfirstlane_b32 s8, v6
    s_sub_u32 s69, s69, 1
    s_cmp_ge_u32 s8, 4
    s_cbranch_scc1 wc_37_d
    s_sleep 1
    s_cmp_lg_u32 s69, 0
    s_cbranch_scc1 wc_37
wc_37_d:
    ds_read_b128 v[184:187], v248 offset:0
    ds_read_b128 v[188:191], v248 offset:1024
    ds_read_b128 v[192:195], v248 offset:2048
    ds_read_b128 v[196:199], v248 offset:3072
    ds_read_b128 v[200:203], v248 offset:4096
    ds_read_b128 v[204:207], v248 offset:5120
    ds_read_b128 v[208:211], v248 offset:6144
    ds_read_b128 v[212:215], v248 offset:7168
    ds_read_b128 v[152:155], v249 offset:0
    ds_read_b128 v[156:159], v249 offset:1024
    ds_read_b128 v[160:163], v249 offset:2048
    ds_read_b128 v[164:167], v249 offset:3072
    ds_read_b128 v[168:171], v249 offset:4096
    ds_read_b128 v[172:175], v249 offset:5120
    ds_read_b128 v[176:179], v249 offset:6144
    ds_read_b128 v[180:183], v249 offset:7168
    s_waitcnt lgkmcnt(15)
    v_mfma_f32_32x32x16_bf16 v[216:231], v[40:43], v[184:187], v[216:231]
    s_waitcnt lgkmcnt(14)
    v_mfma_f32_32x32x16_bf16 v[216:231], v[44:47], v[188:191], v[216:231]
    s_waitcnt lgkmcnt(13)
    v_mfma_f32_32x32x16_bf16 v[216:231], v[48:51], v[192:195], v[216:231]
    s_waitcnt lgkmcnt(12)
    v_mfma_f32_32x32x16_bf16 v[216:231], v[52:55], v[196:199], v[216:231]
    s_waitcnt lgkmcnt(11)
    v_mfma_f32_32x32x16_bf16 v[216:231], v[56:59], v[200:203], v[216:231]
    s_waitcnt lgkmcnt(10)
    v_mfma_f32_32x32x16_bf16 v[216:231], v[60:63], v[204:207], v[216:231]
    s_waitcnt lgkmcnt(9)
    v_mfma_f32_32x32x16_bf16 v[216:231], v[64:67], v[208:211], v[216:231]
    s_waitcnt lgkmcnt(8)
    v_mfma_f32_32x32x16_bf16 v[216:231], v[68:71], v[212:215], v[216:231]
    ds_read_b128 v[184:187], v250 offset:0
    ds_read_b128 v[188:191], v250 offset:1024
    ds_read_b128 v[192:195], v250 offset:2048
    ds_read_b128 v[196:199], v250 offset:3072
    ds_read_b128 v[200:203], v250 offset:4096
    ds_read_b128 v[204:207], v250 offset:5120
    ds_read_b128 v[208:211], v250 offset:6144
    ds_read_b128 v[212:215], v250 offset:7168
    s_waitcnt lgkmcnt(15)
    v_mfma_f32_32x32x16_bf16 v[216:231], v[72:75], v[152:155], v[216:231]
    s_waitcnt lgkmcnt(14)
    v_mfma_f32_32x32x16_bf16 v[216:231], v[76:79], v[156:159], v[216:231]
    s_waitcnt lgkmcnt(13)
    v_mfma_f32_32x32x16_bf16 v[216:231], v[80:83], v[160:163], v[216:231]
    s_waitcnt lgkmcnt(12)
    v_mfma_f32_32x32x16_bf16 v[216:231], v[84:87], v[164:167], v[216:231]
    s_waitcnt lgkmcnt(11)
    v_mfma_f32_32x32x16_bf16 v[216:231], v[88:91], v[168:171], v[216:231]
    s_waitcnt lgkmcnt(10)
    v_mfma_f32_32x32x16_bf16 v[216:231], v[92:95], v[172:175], v[216:231]
    s_waitcnt lgkmcnt(9)
    v_mfma_f32_32x32x16_bf16 v[216:231], v[96:99], v[176:179], v[216:231]
    s_waitcnt lgkmcnt(8)
    v_mfma_f32_32x32x16_bf16 v[216:231], v[100:103], v[180:183], v[216:231]
    s_waitcnt lgkmcnt(7)
    v_mfma_f32_32x32x16_bf16 v[216:231], v[104:107], v[184:187], v[216:231]
    s_waitcnt lgkmcnt(6)
    v_mfma_f32_32x32x16_bf16 v[216:231], v[108:111], v[188:191], v[216:231]
    s_waitcnt lgkmcnt(5)
    v_mfma_f32_32x32x16_bf16 v[216:231], v[112:115], v[192:195], v[216:231]
    s_waitcnt lgkmcnt(4)
    v_mfma_f32_32x32x16_bf16 v[216:231], v[116:119], v[196:199], v[216:231]
    s_waitcnt lgkmcnt(3)
    v_mfma_f32_32x32x16_bf16 v[216:231], v[120:123], v[200:203], v[216:231]
    s_waitcnt lgkmcnt(2)
    v_mfma_f32_32x32x16_bf16 v[216:231], v[124:127], v[204:207], v[216:231]
    s_waitcnt lgkmcnt(1)
    v_mfma_f32_32x32x16_bf16 v[216:231], v[128:131], v[208:211], v[216:231]
    s_waitcnt lgkmcnt(0)
    v_mfma_f32_32x32x16_bf16 v[216:231], v[132:135], v[212:215], v[216:231]
    v_and_b32 v6, 31, v1
    v_mul_u32_u24 v6, 1792, v6
    v_lshrrev_b32 v7, 5, v1
    v_lshl_add_u32 v6, v7, 5, v6
    s_mul_i32 s7, s12, 57344
    s_mov_b32 s8, s90
    s_mul_i32 s8, s8, 224
    s_add_u32 s7, s7, s8
    s_lshl_b32 s8, s5, 6
    s_add_u32 s7, s7, s8
    s_add_u32 s7, s7, 896
    s_nop 1
    v_cvt_pk_bf16_f32 v152, v216, v217
    v_cvt_pk_bf16_f32 v153, v218, v219
    v_cvt_pk_bf16_f32 v154, v220, v221
    v_cvt_pk_bf16_f32 v155, v222, v223
    v_cvt_pk_bf16_f32 v156, v224, v225
    v_cvt_pk_bf16_f32 v157, v226, v227
    v_cvt_pk_bf16_f32 v158, v228, v229
    v_cvt_pk_bf16_f32 v159, v230, v231
    s_cmp_lg_u32 s5, 3
    s_cbranch_scc1 b_st
    s_mov_b32 exec_hi, 0
b_st:
    buffer_store_dwordx4 v[152:155], v6, s[48:51], s7 offen offset:0
    buffer_store_dwordx4 v[156:159], v6, s[48:51], s7 offen offset:16
    s_mov_b64 exec, -1
    s_or_b32 s8, s2, s5
    s_cmp_lg_u32 s8, 0
    s_cbranch_scc1 b_noep
    s_mov_b64 exec, 1
    v_mov_b32 v6, s67
    v_mov_b32 v7, 0
    s_mov_b32 s8, 11010048
    buffer_store_dword v6, v7, s[44:47], s8 offen sc1
    s_mov_b64 exec, -1
b_noep:
    s_endpgm
b_chk0_r:
    s_sub_u32 s14, s14, 1
    s_cmp_le_i32 s14, 0
    s_cbranch_scc1 b_chk0_d
    s_sleep 1
    s_cmp_gt_u32 s14, 19996
    s_cbranch_scc1 b_chk0_g
    s_xor_b32 s15, s15, 16777216
    s_mov_b64 exec, 1
    ds_add_u32 v4, v5 offset:96
    s_mov_b64 exec, -1
b_chk0_g:
    s_add_u32 s8, s12, 0
    s_and_b32 s8, s8, 31
    s_lshl_b32 s8, s8, 11
    s_add_u32 s8, s8, s15
    s_add_u32 s9, s8, 2097152
    buffer_load_dwordx4 v[160:163], v3, s[44:47], s8 offen offset:0 sc1
    buffer_load_dwordx4 v[164:167], v3, s[44:47], s8 offen offset:1024 sc1
    buffer_load_dwordx4 v[168:171], v3, s[44:47], s9 offen offset:0 sc1
    buffer_load_dwordx4 v[172:175], v3, s[44:47], s9 offen offset:1024 sc1
    s_add_u32 s8, s12, 1
    s_and_b32 s8, s8, 31
    s_lshl_b32 s8, s8, 11
    s_add_u32 s8, s8, s15
    s_add_u32 s9, s8, 2097152
    buffer_load_dwordx4 v[176:179], v3, s[44:47], s8 offen offset:0 sc1
    buffer_load_dwordx4 v[180:183], v3, s[44:47], s8 offen offset:1024 sc1
    buffer_load_dwordx4 v[184:187], v3, s[44:47], s9 offen offset:0 sc1
    buffer_load_dwordx4 v[188:191], v3, s[44:47], s9 offen offset:1024 sc1
    s_waitcnt vmcnt(0)
    s_branch b_chk0
b_chk1_r:
    s_sub_u32 s14, s14, 1
    s_cmp_le_i32 s14, 0
    s_cbranch_scc1 b_chk1_d
    s_sleep 1
    s_cmp_gt_u32 s14, 19996
    s_cbranch_scc1 b_chk1_g
    s_xor_b32 s15, s15, 16777216
    s_mov_b64 exec, 1
    ds_add_u32 v4, v5 offset:96
    s_mov_b64 exec, -1
b_chk1_g:
    s_add_u32 s8, s12, 1
    s_and_b32 s8, s8, 31
    s_lshl_b32 s8, s8, 11
    s_add_u32 s8, s8, s15
    s_add_u32 s9, s8, 2097152
    buffer_load_dwordx4 v[176:179], v3, s[44:47], s8 offen offset:0 sc1
    buffer_load_dwordx4 v[180:183], v3, s[44:47], s8 offen offset:1024 sc1
    buffer_load_dwordx4 v[184:187], v3, s[44:47], s9 offen offset:0 sc1
    buffer_load_dwordx4 v[188:191], v3, s[44:47], s9 offen offset:1024 sc1
    s_add_u32 s8, s12, 2
    s_and_b32 s8, s8, 31
    s_lshl_b32 s8, s8, 11
    s_add_u32 s8, s8, s15
    s_add_u32 s9, s8, 2097152
    buffer_load_dwordx4 v[192:195], v3, s[44:47], s8 offen offset:0 sc1
    buffer_load_dwordx4 v[196:199], v3, s[44:47], s8 offen offset:1024 sc1
    buffer_load_dwordx4 v[200:203], v3, s[44:47], s9 offen offset:0 sc1
    buffer_load_dwordx4 v[204:207], v3, s[44:47], s9 offen offset:1024 sc1
    s_waitcnt vmcnt(0)
    s_branch b_chk1
b_chk2_r:
    s_sub_u32 s14, s14, 1
    s_cmp_le_i32 s14, 0
    s_cbranch_scc1 b_chk2_d
    s_sleep 1
    s_cmp_gt_u32 s14, 19996
    s_cbranch_scc1 b_chk2_g
    s_xor_b32 s15, s15, 16777216
    s_mov_b64 exec, 1
    ds_add_u32 v4, v5 offset:96
    s_mov_b64 exec, -1
b_chk2_g:
    s_add_u32 s8, s12, 2
    s_and_b32 s8, s8, 31
    s_lshl_b32 s8, s8, 11
    s_add_u32 s8, s8, s15
    s_add_u32 s9, s8, 2097152
    buffer_load_dwordx4 v[192:195], v3, s[44:47], s8 offen offset:0 sc1
    buffer_load_dwordx4 v[196:199], v3, s[44:47], s8 offen offset:1024 sc1
    buffer_load_dwordx4 v[200:203], v3, s[44:47], s9 offen offset:0 sc1
    buffer_load_dwordx4 v[204:207], v3, s[44:47], s9 offen offset:1024 sc1
    s_add_u32 s8, s12, 3
    s_and_b32 s8, s8, 31
    s_lshl_b32 s8, s8, 11
    s_add_u32 s8, s8, s15
    s_add_u32 s9, s8, 2097152
    buffer_load_dwordx4 v[208:211], v3, s[44:47], s8 offen offset:0 sc1
    buffer_load_dwordx4 v[212:215], v3, s[44:47], s8 offen offset:1024 sc1
    buffer_load_dwordx4 v[216:219], v3, s[44:47], s9 offen offset:0 sc1
    buffer_load_dwordx4 v[220:223], v3, s[44:47], s9 offen offset:1024 sc1
    s_add_u32 s8, s12, 4
    s_and_b32 s8, s8, 31
    s_lshl_b32 s8, s8, 11
    s_add_u32 s8, s8, s15
    s_add_u32 s9, s8, 2097152
    buffer_load_dwordx4 v[224:227], v3, s[44:47], s8 offen offset:0 sc1
    buffer_load_dwordx4 v[228:231], v3, s[44:47], s8 offen offset:1024 sc1
    buffer_load_dwordx4 v[232:235], v3, s[44:47], s9 offen offset:0 sc1
    buffer_load_dwordx4 v[236:239], v3, s[44:47], s9 offen offset:1024 sc1
    s_add_u32 s8, s12, 5
    s_and_b32 s8, s8, 31
    s_lshl_b32 s8, s8, 11
    s_add_u32 s8, s8, s15
    s_add_u32 s9, s8, 2097152
    buffer_load_dwordx4 v[160:163], v3, s[44:47], s8 offen offset:0 sc1
    buffer_load_dwordx4 v[164:167], v3, s[44:47], s8 offen offset:1024 sc1
    buffer_load_dwordx4 v[168:171], v3, s[44:47], s9 offen offset:0 sc1
    buffer_load_dwordx4 v[172:175], v3, s[44:47], s9 offen offset:1024 sc1
    s_waitcnt vmcnt(0)
    v_bitop3_b32 v244, v192, v196, v240 bitop3:0x7e
    v_bitop3_b32 v245, v200, v204, v240 bitop3:0x7e
    v_bitop3_b32 v244, v244, s93, v245 bitop3:0xc8
    v_cmp_ne_u32 vcc, 0, v244
    s_cbranch_vccnz b_chk2_r
    s_branch b_chk2_d
b_chk3_r:
    s_sub_u32 s14, s14, 1
    s_cmp_le_i32 s14, 0
    s_cbranch_scc1 b_chk3_d
    s_sleep 1
    s_cmp_gt_u32 s14, 19996
    s_cbranch_scc1 b_chk3_g
    s_xor_b32 s15, s15, 16777216
b_chk3_g:
    s_add_u32 s8, s12, 3
    s_and_b32 s8, s8, 31
    s_lshl_b32 s8, s8, 11
    s_add_u32 s8, s8, s15
    s_add_u32 s9, s8, 2097152
    buffer_load_dwordx4 v[208:211], v3, s[44:47], s8 offen offset:0 sc1
    buffer_load_dwordx4 v[212:215], v3, s[44:47], s8 offen offset:1024 sc1
    buffer_load_dwordx4 v[216:219], v3, s[44:47], s9 offen offset:0 sc1
    buffer_load_dwordx4 v[220:223], v3, s[44:47], s9 offen offset:1024 sc1
    s_add_u32 s8, s12, 4
    s_and_b32 s8, s8, 31
    s_lshl_b32 s8, s8, 11
    s_add_u32 s8, s8, s15
    s_add_u32 s9, s8, 2097152
    buffer_load_dwordx4 v[224:227], v3, s[44:47], s8 offen offset:0 sc1
    buffer_load_dwordx4 v[228:231], v3, s[44:47], s8 offen offset:1024 sc1
    buffer_load_dwordx4 v[232:235], v3, s[44:47], s9 offen offset:0 sc1
    buffer_load_dwordx4 v[236:239], v3, s[44:47], s9 offen offset:1024 sc1
    s_add_u32 s8, s12, 5
    s_and_b32 s8, s8, 31
    s_lshl_b32 s8, s8, 11
    s_add_u32 s8, s8, s15
    s_add_u32 s9, s8, 2097152
    buffer_load_dwordx4 v[160:163], v3, s[44:47], s8 offen offset:0 sc1
    buffer_load_dwordx4 v[164:167], v3, s[44:47], s8 offen offset:1024 sc1
    buffer_load_dwordx4 v[168:171], v3, s[44:47], s9 offen offset:0 sc1
    buffer_load_dwordx4 v[172:175], v3, s[44:47], s9 offen offset:1024 sc1
    s_add_u32 s8, s12, 6
    s_and_b32 s8, s8, 31
    s_lshl_b32 s8, s8, 11
    s_add_u32 s8, s8, s15
    s_add_u32 s9, s8, 2097152
    buffer_load_dwordx4 v[176:179], v3, s[44:47], s8 offen offset:0 sc1
    buffer_load_dwordx4 v[180:183], v3, s[44:47], s8 offen offset:1024 sc1
    buffer_load_dwordx4 v[184:187], v3, s[44:47], s9 offen offset:0 sc1
    buffer_load_dwordx4 v[188:191], v3, s[44:47], s9 offen offset:1024 sc1
    s_waitcnt vmcnt(0)
    v_bitop3_b32 v244, v208, v212, v240 bitop3:0x7e
    v_bitop3_b32 v245, v216, v220, v240 bitop3:0x7e
    v_bitop3_b32 v244, v244, s93, v245 bitop3:0xc8
    v_cmp_ne_u32 vcc, 0, v244
    s_cbranch_vccnz b_chk3_r
    s_branch b_chk3_d
b_chk4_r:
    s_sub_u32 s14, s14, 1
    s_cmp_le_i32 s14, 0
    s_cbranch_scc1 b_chk4_d
    s_sleep 1
    s_cmp_gt_u32 s14, 19996
    s_cbranch_scc1 b_chk4_g
    s_xor_b32 s15, s15, 16777216
b_chk4_g:
    s_add_u32 s8, s12, 4
    s_and_b32 s8, s8, 31
    s_lshl_b32 s8, s8, 11
    s_add_u32 s8, s8, s15
    s_add_u32 s9, s8, 2097152
    buffer_load_dwordx4 v[224:227], v3, s[44:47], s8 offen offset:0 sc1
    buffer_load_dwordx4 v[228:231], v3, s[44:47], s8 offen offset:1024 sc1
    buffer_load_dwordx4 v[232:235], v3, s[44:47], s9 offen offset:0 sc1
    buffer_load_dwordx4 v[236:239], v3, s[44:47], s9 offen offset:1024 sc1
    s_add_u32 s8, s12, 5
    s_and_b32 s8, s8, 31
    s_lshl_b32 s8, s8, 11
    s_add_u32 s8, s8, s15
    s_add_u32 s9, s8, 2097152
    buffer_load_dwordx4 v[160:163], v3, s[44:47], s8 offen offset:0 sc1
    buffer_load_dwordx4 v[164:167], v3, s[44:47], s8 offen offset:1024 sc1
    buffer_load_dwordx4 v[168:171], v3, s[44:47], s9 offen offset:0 sc1
    buffer_load_dwordx4 v[172:175], v3, s[44:47], s9 offen offset:1024 sc1
    s_add_u32 s8, s12, 6
    s_and_b32 s8, s8, 31
    s_lshl_b32 s8, s8, 11
    s_add_u32 s8, s8, s15
    s_add_u32 s9, s8, 2097152
    buffer_load_dwordx4 v[176:179], v3, s[44:47], s8 offen offset:0 sc1
    buffer_load_dwordx4 v[180:183], v3, s[44:47], s8 offen offset:1024 sc1
    buffer_load_dwordx4 v[184:187], v3, s[44:47], s9 offen offset:0 sc1
    buffer_load_dwordx4 v[188:191], v3, s[44:47], s9 offen offset:1024 sc1
    s_add_u32 s8, s12, 7
    s_and_b32 s8, s8, 31
    s_lshl_b32 s8, s8, 11
    s_add_u32 s8, s8, s15
    s_add_u32 s9, s8, 2097152
    buffer_load_dwordx4 v[192:195], v3, s[44:47], s8 offen offset:0 sc1
    buffer_load_dwordx4 v[196:199], v3, s[44:47], s8 offen offset:1024 sc1
    buffer_load_dwordx4 v[200:203], v3, s[44:47], s9 offen offset:0 sc1
    buffer_load_dwordx4 v[204:207], v3, s[44:47], s9 offen offset:1024 sc1
    s_waitcnt vmcnt(0)
    v_bitop3_b32 v244, v224, v228, v240 bitop3:0x7e
    v_bitop3_b32 v245, v232, v236, v240 bitop3:0x7e
    v_bitop3_b32 v244, v244, s93, v245 bitop3:0xc8
    v_cmp_ne_u32 vcc, 0, v244
    s_cbranch_vccnz b_chk4_r
    s_branch b_chk4_d
b_chk5_r:
    s_sub_u32 s14, s14, 1
    s_cmp_le_i32 s14, 0
    s_cbranch_scc1 b_chk5_d
    s_sleep 1
    s_cmp_gt_u32 s14, 19996
    s_cbranch_scc1 b_chk5_g
    s_xor_b32 s15, s15, 16777216
b_chk5_g:
    s_add_u32 s8, s12, 5
    s_and_b32 s8, s8, 31
    s_lshl_b32 s8, s8, 11
    s_add_u32 s8, s8, s15
    s_add_u32 s9, s8, 2097152
    buffer_load_dwordx4 v[160:163], v3, s[44:47], s8 offen offset:0 sc1
    buffer_load_dwordx4 v[164:167], v3, s[44:47], s8 offen offset:1024 sc1
    buffer_load_dwordx4 v[168:171], v3, s[44:47], s9 offen offset:0 sc1
    buffer_load_dwordx4 v[172:175], v3, s[44:47], s9 offen offset:1024 sc1
    s_add_u32 s8, s12, 6
    s_and_b32 s8, s8, 31
    s_lshl_b32 s8, s8, 11
    s_add_u32 s8, s8, s15
    s_add_u32 s9, s8, 2097152
    buffer_load_dwordx4 v[176:179], v3, s[44:47], s8 offen offset:0 sc1
    buffer_load_dwordx4 v[180:183], v3, s[44:47], s8 offen offset:1024 sc1
    buffer_load_dwordx4 v[184:187], v3, s[44:47], s9 offen offset:0 sc1
    buffer_load_dwordx4 v[188:191], v3, s[44:47], s9 offen offset:1024 sc1
    s_add_u32 s8, s12, 7
    s_and_b32 s8, s8, 31
    s_lshl_b32 s8, s8, 11
    s_add_u32 s8, s8, s15
    s_add_u32 s9, s8, 2097152
    buffer_load_dwordx4 v[192:195], v3, s[44:47], s8 offen offset:0 sc1
    buffer_load_dwordx4 v[196:199], v3, s[44:47], s8 offen offset:1024 sc1
    buffer_load_dwordx4 v[200:203], v3, s[44:47], s9 offen offset:0 sc1
    buffer_load_dwordx4 v[204:207], v3, s[44:47], s9 offen offset:1024 sc1
    s_add_u32 s8, s12, 0
    s_and_b32 s8, s8, 31
    s_lshl_b32 s8, s8, 11
    s_add_u32 s8, s8, s68
    s_add_u32 s9, s8, 2097152
    buffer_load_dwordx4 v[208:211], v3, s[44:47], s8 offen offset:0 sc1
    buffer_load_dwordx4 v[212:215], v3, s[44:47], s8 offen offset:1024 sc1
    buffer_load_dwordx4 v[216:219], v3, s[44:47], s9 offen offset:0 sc1
    buffer_load_dwordx4 v[220:223], v3, s[44:47], s9 offen offset:1024 sc1
    s_waitcnt vmcnt(0)
    v_bitop3_b32 v244, v160, v164, v240 bitop3:0x7e
    v_bitop3_b32 v245, v168, v172, v240 bitop3:0x7e
    v_bitop3_b32 v244, v244, s93, v245 bitop3:0xc8
    v_cmp_ne_u32 vcc, 0, v244
    s_cbranch_vccnz b_chk5_r
    s_branch b_chk5_d
b_chk6_r:
    s_sub_u32 s14, s14, 1
    s_cmp_le_i32 s14, 0
    s_cbranch_scc1 b_chk6_d
    s_sleep 1
    s_cmp_gt_u32 s14, 19996
    s_cbranch_scc1 b_chk6_g
    s_xor_b32 s15, s15, 16777216
b_chk6_g:
    s_add_u32 s8, s12, 6
    s_and_b32 s8, s8, 31
    s_lshl_b32 s8, s8, 11
    s_add_u32 s8, s8, s15
    s_add_u32 s9, s8, 2097152
    buffer_load_dwordx4 v[176:179], v3, s[44:47], s8 offen offset:0 sc1
    buffer_load_dwordx4 v[180:183], v3, s[44:47], s8 offen offset:1024 sc1
    buffer_load_dwordx4 v[184:187], v3, s[44:47], s9 offen offset:0 sc1
    buffer_load_dwordx4 v[188:191], v3, s[44:47], s9 offen offset:1024 sc1
    s_add_u32 s8, s12, 7
    s_and_b32 s8, s8, 31
    s_lshl_b32 s8, s8, 11
    s_add_u32 s8, s8, s15
    s_add_u32 s9, s8, 2097152
    buffer_load_dwordx4 v[192:195], v3, s[44:47], s8 offen offset:0 sc1
    buffer_load_dwordx4 v[196:199], v3, s[44:47], s8 offen offset:1024 sc1
    buffer_load_dwordx4 v[200:203], v3, s[44:47], s9 offen offset:0 sc1
    buffer_load_dwordx4 v[204:207], v3, s[44:47], s9 offen offset:1024 sc1
    s_add_u32 s8, s12, 0
    s_and_b32 s8, s8, 31
    s_lshl_b32 s8, s8, 11
    s_add_u32 s8, s8, s68
    s_add_u32 s9, s8, 2097152
    buffer_load_dwordx4 v[208:211], v3, s[44:47], s8 offen offset:0 sc1
    buffer_load_dwordx4 v[212:215], v3, s[44:47], s8 offen offset:1024 sc1
    buffer_load_dwordx4 v[216:219], v3, s[44:47], s9 offen offset:0 sc1
    buffer_load_dwordx4 v[220:223], v3, s[44:47], s9 offen offset:1024 sc1
    s_add_u32 s8, s12, 1
    s_and_b32 s8, s8, 31
    s_lshl_b32 s8, s8, 11
    s_add_u32 s8, s8, s68
    s_add_u32 s9, s8, 2097152
    buffer_load_dwordx4 v[224:227], v3, s[44:47], s8 offen offset:0 sc1
    buffer_load_dwordx4 v[228:231], v3, s[44:47], s8 offen offset:1024 sc1
    buffer_load_dwordx4 v[232:235], v3, s[44:47], s9 offen offset:0 sc1
    buffer_load_dwordx4 v[236:239], v3, s[44:47], s9 offen offset:1024 sc1
    s_waitcnt vmcnt(0)
    v_bitop3_b32 v244, v176, v180, v240 bitop3:0x7e
    v_bitop3_b32 v245, v184, v188, v240 bitop3:0x7e
    v_bitop3_b32 v244, v244, s93, v245 bitop3:0xc8
    v_cmp_ne_u32 vcc, 0, v244
    s_cbranch_vccnz b_chk6_r
    s_branch b_chk6_d
b_chk7_r:
    s_sub_u32 s14, s14, 1
    s_cmp_le_i32 s14, 0
    s_cbranch_scc1 b_chk7_d
    s_sleep 1
    s_cmp_gt_u32 s14, 19996
    s_cbranch_scc1 b_chk7_g
    s_xor_b32 s15, s15, 16777216
b_chk7_g:
    s_add_u32 s8, s12, 7
    s_and_b32 s8, s8, 31
    s_lshl_b32 s8, s8, 11
    s_add_u32 s8, s8, s15
    s_add_u32 s9, s8, 2097152
    buffer_load_dwordx4 v[192:195], v3, s[44:47], s8 offen offset:0 sc1
    buffer_load_dwordx4 v[196:199], v3, s[44:47], s8 offen offset:1024 sc1
    buffer_load_dwordx4 v[200:203], v3, s[44:47], s9 offen offset:0 sc1
    buffer_load_dwordx4 v[204:207], v3, s[44:47], s9 offen offset:1024 sc1
    s_add_u32 s8, s12, 0
    s_and_b32 s8, s8, 31
    s_lshl_b32 s8, s8, 11
    s_add_u32 s8, s8, s68
    s_add_u32 s9, s8, 2097152
    buffer_load_dwordx4 v[208:211], v3, s[44:47], s8 offen offset:0 sc1
    buffer_load_dwordx4 v[212:215], v3, s[44:47], s8 offen offset:1024 sc1
    buffer_load_dwordx4 v[216:219], v3, s[44:47], s9 offen offset:0 sc1
    buffer_load_dwordx4 v[220:223], v3, s[44:47], s9 offen offset:1024 sc1
    s_add_u32 s8, s12, 1
    s_and_b32 s8, s8, 31
    s_lshl_b32 s8, s8, 11
    s_add_u32 s8, s8, s68
    s_add_u32 s9, s8, 2097152
    buffer_load_dwordx4 v[224:227], v3, s[44:47], s8 offen offset:0 sc1
    buffer_load_dwordx4 v[228:231], v3, s[44:47], s8 offen offset:1024 sc1
    buffer_load_dwordx4 v[232:235], v3, s[44:47], s9 offen offset:0 sc1
    buffer_load_dwordx4 v[236:239], v3, s[44:47], s9 offen offset:1024 sc1
    s_add_u32 s8, s12, 2
    s_and_b32 s8, s8, 31
    s_lshl_b32 s8, s8, 11
    s_add_u32 s8, s8, s68
    s_add_u32 s9, s8, 2097152
    buffer_load_dwordx4 v[160:163], v3, s[44:47], s8 offen offset:0 sc1
    buffer_load_dwordx4 v[164:167], v3, s[44:47], s8 offen offset:1024 sc1
    buffer_load_dwordx4 v[168:171], v3, s[44:47], s9 offen offset:0 sc1
    buffer_load_dwordx4 v[172:175], v3, s[44:47], s9 offen offset:1024 sc1
    s_waitcnt vmcnt(0)
    v_bitop3_b32 v244, v192, v196, v240 bitop3:0x7e
    v_bitop3_b32 v245, v200, v204, v240 bitop3:0x7e
    v_bitop3_b32 v244, v244, s93, v245 bitop3:0xc8
    v_cmp_ne_u32 vcc, 0, v244
    s_cbranch_vccnz b_chk7_r
    s_branch b_chk7_d
b_chk8_r:
    s_sub_u32 s14, s14, 1
    s_cmp_le_i32 s14, 0
    s_cbranch_scc1 b_chk8_d
    s_sleep 1
    s_add_u32 s8, s12, 0
    s_and_b32 s8, s8, 31
    s_lshl_b32 s8, s8, 11
    s_add_u32 s8, s8, s68
    s_add_u32 s9, s8, 2097152
    buffer_load_dwordx4 v[208:211], v3, s[44:47], s8 offen offset:0 sc1
    buffer_load_dwordx4 v[212:215], v3, s[44:47], s8 offen offset:1024 sc1
    buffer_load_dwordx4 v[216:219], v3, s[44:47], s9 offen offset:0 sc1
    buffer_load_dwordx4 v[220:223], v3, s[44:47], s9 offen offset:1024 sc1
    s_add_u32 s8, s12, 1
    s_and_b32 s8, s8, 31
    s_lshl_b32 s8, s8, 11
    s_add_u32 s8, s8, s68
    s_add_u32 s9, s8, 2097152
    buffer_load_dwordx4 v[224:227], v3, s[44:47], s8 offen offset:0 sc1
    buffer_load_dwordx4 v[228:231], v3, s[44:47], s8 offen offset:1024 sc1
    buffer_load_dwordx4 v[232:235], v3, s[44:47], s9 offen offset:0 sc1
    buffer_load_dwordx4 v[236:239], v3, s[44:47], s9 offen offset:1024 sc1
    s_add_u32 s8, s12, 2
    s_and_b32 s8, s8, 31
    s_lshl_b32 s8, s8, 11
    s_add_u32 s8, s8, s68
    s_add_u32 s9, s8, 2097152
    buffer_load_dwordx4 v[160:163], v3, s[44:47], s8 offen offset:0 sc1
    buffer_load_dwordx4 v[164:167], v3, s[44:47], s8 offen offset:1024 sc1
    buffer_load_dwordx4 v[168:171], v3, s[44:47], s9 offen offset:0 sc1
    buffer_load_dwordx4 v[172:175], v3, s[44:47], s9 offen offset:1024 sc1
    s_add_u32 s8, s12, 3
    s_and_b32 s8, s8, 31
    s_lshl_b32 s8, s8, 11
    s_add_u32 s8, s8, s68
    s_add_u32 s9, s8, 2097152
    buffer_load_dwordx4 v[176:179], v3, s[44:47], s8 offen offset:0 sc1
    buffer_load_dwordx4 v[180:183], v3, s[44:47], s8 offen offset:1024 sc1
    buffer_load_dwordx4 v[184:187], v3, s[44:47], s9 offen offset:0 sc1
    buffer_load_dwordx4 v[188:191], v3, s[44:47], s9 offen offset:1024 sc1
    s_waitcnt vmcnt(0)
    v_bitop3_b32 v244, v208, v212, v240 bitop3:0x7e
    v_bitop3_b32 v245, v216, v220, v240 bitop3:0x7e
    v_bitop3_b32 v244, v244, s93, v245 bitop3:0xc8
    v_cmp_ne_u32 vcc, 0, v244
    s_cbranch_vccnz b_chk8_r
    s_branch b_chk8_d
b_chk9_r:
    s_sub_u32 s14, s14, 1
    s_cmp_le_i32 s14, 0
    s_cbranch_scc1 b_chk9_d
    s_sleep 1
    s_add_u32 s8, s12, 1
    s_and_b32 s8, s8, 31
    s_lshl_b32 s8, s8, 11
    s_add_u32 s8, s8, s68
    s_add_u32 s9, s8, 2097152
    buffer_load_dwordx4 v[224:227], v3, s[44:47], s8 offen offset:0 sc1
    buffer_load_dwordx4 v[228:231], v3, s[44:47], s8 offen offset:1024 sc1
    buffer_load_dwordx4 v[232:235], v3, s[44:47], s9 offen offset:0 sc1
    buffer_load_dwordx4 v[236:239], v3, s[44:47], s9 offen offset:1024 sc1
    s_add_u32 s8, s12, 2
    s_and_b32 s8, s8, 31
    s_lshl_b32 s8, s8, 11
    s_add_u32 s8, s8, s68
    s_add_u32 s9, s8, 2097152
    buffer_load_dwordx4 v[160:163], v3, s[44:47], s8 offen offset:0 sc1
    buffer_load_dwordx4 v[164:167], v3, s[44:47], s8 offen offset:1024 sc1
    buffer_load_dwordx4 v[168:171], v3, s[44:47], s9 offen offset:0 sc1
    buffer_load_dwordx4 v[172:175], v3, s[44:47], s9 offen offset:1024 sc1
    s_add_u32 s8, s12, 3
    s_and_b32 s8, s8, 31
    s_lshl_b32 s8, s8, 11
    s_add_u32 s8, s8, s68
    s_add_u32 s9, s8, 2097152
    buffer_load_dwordx4 v[176:179], v3, s[44:47], s8 offen offset:0 sc1
    buffer_load_dwordx4 v[180:183], v3, s[44:47], s8 offen offset:1024 sc1
    buffer_load_dwordx4 v[184:187], v3, s[44:47], s9 offen offset:0 sc1
    buffer_load_dwordx4 v[188:191], v3, s[44:47], s9 offen offset:1024 sc1
    s_add_u32 s8, s12, 4
    s_and_b32 s8, s8, 31
    s_lshl_b32 s8, s8, 11
    s_add_u32 s8, s8, s68
    s_add_u32 s9, s8, 2097152
    buffer_load_dwordx4 v[192:195], v3, s[44:47], s8 offen offset:0 sc1
    buffer_load_dwordx4 v[196:199], v3, s[44:47], s8 offen offset:1024 sc1
    buffer_load_dwordx4 v[200:203], v3, s[44:47], s9 offen offset:0 sc1
    buffer_load_dwordx4 v[204:207], v3, s[44:47], s9 offen offset:1024 sc1
    s_waitcnt vmcnt(0)
    v_bitop3_b32 v244, v224, v228, v240 bitop3:0x7e
    v_bitop3_b32 v245, v232, v236, v240 bitop3:0x7e
    v_bitop3_b32 v244, v244, s93, v245 bitop3:0xc8
    v_cmp_ne_u32 vcc, 0, v244
    s_cbranch_vccnz b_chk9_r
    s_branch b_chk9_d
b_chk10_r:
    s_sub_u32 s14, s14, 1
    s_cmp_le_i32 s14, 0
    s_cbranch_scc1 b_chk10_d
    s_sleep 1
    s_add_u32 s8, s12, 2
    s_and_b32 s8, s8, 31
    s_lshl_b32 s8, s8, 11
    s_add_u32 s8, s8, s68
    s_add_u32 s9, s8, 2097152
    buffer_load_dwordx4 v[160:163], v3, s[44:47], s8 offen offset:0 sc1
    buffer_load_dwordx4 v[164:167], v3, s[44:47], s8 offen offset:1024 sc1
    buffer_load_dwordx4 v[168:171], v3, s[44:47], s9 offen offset:0 sc1
    buffer_load_dwordx4 v[172:175], v3, s[44:47], s9 offen offset:1024 sc1
    s_add_u32 s8, s12, 3
    s_and_b32 s8, s8, 31
    s_lshl_b32 s8, s8, 11
    s_add_u32 s8, s8, s68
    s_add_u32 s9, s8, 2097152
    buffer_load_dwordx4 v[176:179], v3, s[44:47], s8 offen offset:0 sc1
    buffer_load_dwordx4 v[180:183], v3, s[44:47], s8 offen offset:1024 sc1
    buffer_load_dwordx4 v[184:187], v3, s[44:47], s9 offen offset:0 sc1
    buffer_load_dwordx4 v[188:191], v3, s[44:47], s9 offen offset:1024 sc1
    s_add_u32 s8, s12, 4
    s_and_b32 s8, s8, 31
    s_lshl_b32 s8, s8, 11
    s_add_u32 s8, s8, s68
    s_add_u32 s9, s8, 2097152
    buffer_load_dwordx4 v[192:195], v3, s[44:47], s8 offen offset:0 sc1
    buffer_load_dwordx4 v[196:199], v3, s[44:47], s8 offen offset:1024 sc1
    buffer_load_dwordx4 v[200:203], v3, s[44:47], s9 offen offset:0 sc1
    buffer_load_dwordx4 v[204:207], v3, s[44:47], s9 offen offset:1024 sc1
    s_add_u32 s8, s12, 5
    s_and_b32 s8, s8, 31
    s_lshl_b32 s8, s8, 11
    s_add_u32 s8, s8, s68
    s_add_u32 s9, s8, 2097152
    buffer_load_dwordx4 v[208:211], v3, s[44:47], s8 offen offset:0 sc1
    buffer_load_dwordx4 v[212:215], v3, s[44:47], s8 offen offset:1024 sc1
    buffer_load_dwordx4 v[216:219], v3, s[44:47], s9 offen offset:0 sc1
    buffer_load_dwordx4 v[220:223], v3, s[44:47], s9 offen offset:1024 sc1
    s_waitcnt vmcnt(0)
    v_bitop3_b32 v244, v160, v164, v240 bitop3:0x7e
    v_bitop3_b32 v245, v168, v172, v240 bitop3:0x7e
    v_bitop3_b32 v244, v244, s93, v245 bitop3:0xc8
    v_cmp_ne_u32 vcc, 0, v244
    s_cbranch_vccnz b_chk10_r
    s_branch b_chk10_d
b_chk11_r:
    s_sub_u32 s14, s14, 1
    s_cmp_le_i32 s14, 0
    s_cbranch_scc1 b_chk11_d
    s_sleep 1
    s_add_u32 s8, s12, 3
    s_and_b32 s8, s8, 31
    s_lshl_b32 s8, s8, 11
    s_add_u32 s8, s8, s68
    s_add_u32 s9, s8, 2097152
    buffer_load_dwordx4 v[176:179], v3, s[44:47], s8 offen offset:0 sc1
    buffer_load_dwordx4 v[180:183], v3, s[44:47], s8 offen offset:1024 sc1
    buffer_load_dwordx4 v[184:187], v3, s[44:47], s9 offen offset:0 sc1
    buffer_load_dwordx4 v[188:191], v3, s[44:47], s9 offen offset:1024 sc1
    s_add_u32 s8, s12, 4
    s_and_b32 s8, s8, 31
    s_lshl_b32 s8, s8, 11
    s_add_u32 s8, s8, s68
    s_add_u32 s9, s8, 2097152
    buffer_load_dwordx4 v[192:195], v3, s[44:47], s8 offen offset:0 sc1
    buffer_load_dwordx4 v[196:199], v3, s[44:47], s8 offen offset:1024 sc1
    buffer_load_dwordx4 v[200:203], v3, s[44:47], s9 offen offset:0 sc1
    buffer_load_dwordx4 v[204:207], v3, s[44:47], s9 offen offset:1024 sc1
    s_add_u32 s8, s12, 5
    s_and_b32 s8, s8, 31
    s_lshl_b32 s8, s8, 11
    s_add_u32 s8, s8, s68
    s_add_u32 s9, s8, 2097152
    buffer_load_dwordx4 v[208:211], v3, s[44:47], s8 offen offset:0 sc1
    buffer_load_dwordx4 v[212:215], v3, s[44:47], s8 offen offset:1024 sc1
    buffer_load_dwordx4 v[216:219], v3, s[44:47], s9 offen offset:0 sc1
    buffer_load_dwordx4 v[220:223], v3, s[44:47], s9 offen offset:1024 sc1
    s_add_u32 s8, s12, 6
    s_and_b32 s8, s8, 31
    s_lshl_b32 s8, s8, 11
    s_add_u32 s8, s8, s68
    s_add_u32 s9, s8, 2097152
    buffer_load_dwordx4 v[224:227], v3, s[44:47], s8 offen offset:0 sc1
    buffer_load_dwordx4 v[228:231], v3, s[44:47], s8 offen offset:1024 sc1
    buffer_load_dwordx4 v[232:235], v3, s[44:47], s9 offen offset:0 sc1
    buffer_load_dwordx4 v[236:239], v3, s[44:47], s9 offen offset:1024 sc1
    s_waitcnt vmcnt(0)
    v_bitop3_b32 v244, v176, v180, v240 bitop3:0x7e
    v_bitop3_b32 v245, v184, v188, v240 bitop3:0x7e
    v_bitop3_b32 v244, v244, s93, v245 bitop3:0xc8
    v_cmp_ne_u32 vcc, 0, v244
    s_cbranch_vccnz b_chk11_r
    s_branch b_chk11_d
b_chk12_r:
    s_sub_u32 s14, s14, 1
    s_cmp_le_i32 s14, 0
    s_cbranch_scc1 b_chk12_d
    s_sleep 1
    s_add_u32 s8, s12, 4
    s_and_b32 s8, s8, 31
    s_lshl_b32 s8, s8, 11
    s_add_u32 s8, s8, s68
    s_add_u32 s9, s8, 2097152
    buffer_load_dwordx4 v[192:195], v3, s[44:47], s8 offen offset:0 sc1
    buffer_load_dwordx4 v[196:199], v3, s[44:47], s8 offen offset:1024 sc1
    buffer_load_dwordx4 v[200:203], v3, s[44:47], s9 offen offset:0 sc1
    buffer_load_dwordx4 v[204:207], v3, s[44:47], s9 offen offset:1024 sc1
    s_add_u32 s8, s12, 5
    s_and_b32 s8, s8, 31
    s_lshl_b32 s8, s8, 11
    s_add_u32 s8, s8, s68
    s_add_u32 s9, s8, 2097152
    buffer_load_dwordx4 v[208:211], v3, s[44:47], s8 offen offset:0 sc1
    buffer_load_dwordx4 v[212:215], v3, s[44:47], s8 offen offset:1024 sc1
    buffer_load_dwordx4 v[216:219], v3, s[44:47], s9 offen offset:0 sc1
    buffer_load_dwordx4 v[220:223], v3, s[44:47], s9 offen offset:1024 sc1
    s_add_u32 s8, s12, 6
    s_and_b32 s8, s8, 31
    s_lshl_b32 s8, s8, 11
    s_add_u32 s8, s8, s68
    s_add_u32 s9, s8, 2097152
    buffer_load_dwordx4 v[224:227], v3, s[44:47], s8 offen offset:0 sc1
    buffer_load_dwordx4 v[228:231], v3, s[44:47], s8 offen offset:1024 sc1
    buffer_load_dwordx4 v[232:235], v3, s[44:47], s9 offen offset:0 sc1
    buffer_load_dwordx4 v[236:239], v3, s[44:47], s9 offen offset:1024 sc1
    s_add_u32 s8, s12, 7
    s_and_b32 s8, s8, 31
    s_lshl_b32 s8, s8, 11
    s_add_u32 s8, s8, s68
    s_add_u32 s9, s8, 2097152
    buffer_load_dwordx4 v[160:163], v3, s[44:47], s8 offen offset:0 sc1
    buffer_load_dwordx4 v[164:167], v3, s[44:47], s8 offen offset:1024 sc1
    buffer_load_dwordx4 v[168:171], v3, s[44:47], s9 offen offset:0 sc1
    buffer_load_dwordx4 v[172:175], v3, s[44:47], s9 offen offset:1024 sc1
    s_waitcnt vmcnt(0)
    v_bitop3_b32 v244, v192, v196, v240 bitop3:0x7e
    v_bitop3_b32 v245, v200, v204, v240 bitop3:0x7e
    v_bitop3_b32 v244, v244, s93, v245 bitop3:0xc8
    v_cmp_ne_u32 vcc, 0, v244
    s_cbranch_vccnz b_chk12_r
    s_branch b_chk12_d
b_chk13_r:
    s_sub_u32 s14, s14, 1
    s_cmp_le_i32 s14, 0
    s_cbranch_scc1 b_chk13_d
    s_sleep 1
    s_add_u32 s8, s12, 5
    s_and_b32 s8, s8, 31
    s_lshl_b32 s8, s8, 11
    s_add_u32 s8, s8, s68
    s_add_u32 s9, s8, 2097152
    buffer_load_dwordx4 v[208:211], v3, s[44:47], s8 offen offset:0 sc1
    buffer_load_dwordx4 v[212:215], v3, s[44:47], s8 offen offset:1024 sc1
    buffer_load_dwordx4 v[216:219], v3, s[44:47], s9 offen offset:0 sc1
    buffer_load_dwordx4 v[220:223], v3, s[44:47], s9 offen offset:1024 sc1
    s_add_u32 s8, s12, 6
    s_and_b32 s8, s8, 31
    s_lshl_b32 s8, s8, 11
    s_add_u32 s8, s8, s68
    s_add_u32 s9, s8, 2097152
    buffer_load_dwordx4 v[224:227], v3, s[44:47], s8 offen offset:0 sc1
    buffer_load_dwordx4 v[228:231], v3, s[44:47], s8 offen offset:1024 sc1
    buffer_load_dwordx4 v[232:235], v3, s[44:47], s9 offen offset:0 sc1
    buffer_load_dwordx4 v[236:239], v3, s[44:47], s9 offen offset:1024 sc1
    s_add_u32 s8, s12, 7
    s_and_b32 s8, s8, 31
    s_lshl_b32 s8, s8, 11
    s_add_u32 s8, s8, s68
    s_add_u32 s9, s8, 2097152
    buffer_load_dwordx4 v[160:163], v3, s[44:47], s8 offen offset:0 sc1
    buffer_load_dwordx4 v[164:167], v3, s[44:47], s8 offen offset:1024 sc1
    buffer_load_dwordx4 v[168:171], v3, s[44:47], s9 offen offset:0 sc1
    buffer_load_dwordx4 v[172:175], v3, s[44:47], s9 offen offset:1024 sc1
    s_waitcnt vmcnt(0)
    v_bitop3_b32 v244, v208, v212, v240 bitop3:0x7e
    v_bitop3_b32 v245, v216, v220, v240 bitop3:0x7e
    v_bitop3_b32 v244, v244, s93, v245 bitop3:0xc8
    v_cmp_ne_u32 vcc, 0, v244
    s_cbranch_vccnz b_chk13_r
    s_branch b_chk13_d
b_chk14_r:
    s_sub_u32 s14, s14, 1
    s_cmp_le_i32 s14, 0
    s_cbranch_scc1 b_chk14_d
    s_sleep 1
    s_add_u32 s8, s12, 6
    s_and_b32 s8, s8, 31
    s_lshl_b32 s8, s8, 11
    s_add_u32 s8, s8, s68
    s_add_u32 s9, s8, 2097152
    buffer_load_dwordx4 v[224:227], v3, s[44:47], s8 offen offset:0 sc1
    buffer_load_dwordx4 v[228:231], v3, s[44:47], s8 offen offset:1024 sc1
    buffer_load_dwordx4 v[232:235], v3, s[44:47], s9 offen offset:0 sc1
    buffer_load_dwordx4 v[236:239], v3, s[44:47], s9 offen offset:1024 sc1
    s_add_u32 s8, s12, 7
    s_and_b32 s8, s8, 31
    s_lshl_b32 s8, s8, 11
    s_add_u32 s8, s8, s68
    s_add_u32 s9, s8, 2097152
    buffer_load_dwordx4 v[160:163], v3, s[44:47], s8 offen offset:0 sc1
    buffer_load_dwordx4 v[164:167], v3, s[44:47], s8 offen offset:1024 sc1
    buffer_load_dwordx4 v[168:171], v3, s[44:47], s9 offen offset:0 sc1
    buffer_load_dwordx4 v[172:175], v3, s[44:47], s9 offen offset:1024 sc1
    s_waitcnt vmcnt(0)
    v_bitop3_b32 v244, v224, v228, v240 bitop3:0x7e
    v_bitop3_b32 v245, v232, v236, v240 bitop3:0x7e
    v_bitop3_b32 v244, v244, s93, v245 bitop3:0xc8
    v_cmp_ne_u32 vcc, 0, v244
    s_cbranch_vccnz b_chk14_r
    s_branch b_chk14_d
b_chk15_r:
    s_sub_u32 s14, s14, 1
    s_cmp_le_i32 s14, 0
    s_cbranch_scc1 b_chk15_d
    s_sleep 1
    s_add_u32 s8, s12, 7
    s_and_b32 s8, s8, 31
    s_lshl_b32 s8, s8, 11
    s_add_u32 s8, s8, s68
    s_add_u32 s9, s8, 2097152
    buffer_load_dwordx4 v[160:163], v3, s[44:47], s8 offen offset:0 sc1
    buffer_load_dwordx4 v[164:167], v3, s[44:47], s8 offen offset:1024 sc1
    buffer_load_dwordx4 v[168:171], v3, s[44:47], s9 offen offset:0 sc1
    buffer_load_dwordx4 v[172:175], v3, s[44:47], s9 offen offset:1024 sc1
    s_waitcnt vmcnt(0)
    v_bitop3_b32 v244, v160, v164, v240 bitop3:0x7e
    v_bitop3_b32 v245, v168, v172, v240 bitop3:0x7e
    v_bitop3_b32 v244, v244, s93, v245 bitop3:0xc8
    v_cmp_ne_u32 vcc, 0, v244
    s_cbranch_vccnz b_chk15_r
    s_branch b_chk15_d
b_slow:
    s_mov_b32 s64, 1
    s_mov_b32 s66, 8
    s_lshr_b32 s87, s87, 1
    s_add_u32 s87, s87, 25165824
    s_mov_b32 s88, s87
    s_waitcnt vmcnt(0)
    v_mov_b32 v152, 0xff800000
    v_mov_b32 v153, 0xff800000
    v_mov_b32 v154, 0xff800000
    v_mov_b32 v155, 0xff800000
    s_mov_b32 s14, 16
    s_mov_b32 s69, 20000
b_mloop:
    s_and_b32 s13, s14, 7
    s_add_u32 s13, s13, s12
    s_and_b32 s13, s13, 31
    s_lshl_b32 s8, s13, 11
    s_bitcmp1_b32 s14, 3
    s_cselect_b32 s9, s15, s68
    s_add_u32 s8, s8, s9
    buffer_load_dwordx4 v[160:163], v3, s[44:47], s8 offen offset:0 sc1
    buffer_load_dwordx4 v[164:167], v3, s[44:47], s8 offen offset:1024 sc1
    s_waitcnt vmcnt(0)
    v_bitop3_b32 v244, v160, v164, v240 bitop3:0x7e
    v_and_b32 v244, s93, v244
    v_cmp_ne_u32 vcc, 0, v244
    s_cbranch_vccz b_mok
    s_xor_b32 s15, s15, 16777216
    s_sub_u32 s69, s69, 1
    s_cmp_gt_i32 s69, 0
    s_cbranch_scc1 b_mloop
b_mok:
    v_mfma_f32_32x32x16_bf16 v[104:119], v[160:163], v[8:11], 0
    v_mfma_f32_32x32x16_bf16 v[104:119], v[164:167], v[12:15], v[104:119]
    s_nop 11
    v_max3_f32 v152, v152, v104, v105
    v_max3_f32 v152, v152, v106, v107
    v_max3_f32 v152, v152, v108, v109
    v_max3_f32 v152, v152, v110, v111
    v_max3_f32 v152, v152, v112, v113
    v_max3_f32 v152, v152, v114, v115
    v_max3_f32 v152, v152, v116, v117
    v_max3_f32 v152, v152, v118, v119
    v_mfma_f32_32x32x16_bf16 v[104:119], v[160:163], v[16:19], 0
    v_mfma_f32_32x32x16_bf16 v[104:119], v[164:167], v[20:23], v[104:119]
    s_nop 11
    v_max3_f32 v153, v153, v104, v105
    v_max3_f32 v153, v153, v106, v107
    v_max3_f32 v153, v153, v108, v109
    v_max3_f32 v153, v153, v110, v111
    v_max3_f32 v153, v153, v112, v113
    v_max3_f32 v153, v153, v114, v115
    v_max3_f32 v153, v153, v116, v117
    v_max3_f32 v153, v153, v118, v119
    v_mfma_f32_32x32x16_bf16 v[104:119], v[160:163], v[24:27], 0
    v_mfma_f32_32x32x16_bf16 v[104:119], v[164:167], v[28:31], v[104:119]
    s_nop 11
    v_max3_f32 v154, v154, v104, v105
    v_max3_f32 v154, v154, v106, v107
    v_max3_f32 v154, v154, v108, v109
    v_max3_f32 v154, v154, v110, v111
    v_max3_f32 v154, v154, v112, v113
    v_max3_f32 v154, v154, v114, v115
    v_max3_f32 v154, v154, v116, v117
    v_max3_f32 v154, v154, v118, v119
    v_mfma_f32_32x32x16_bf16 v[104:119], v[160:163], v[32:35], 0
    v_mfma_f32_32x32x16_bf16 v[104:119], v[164:167], v[36:39], v[104:119]
    s_nop 11
    v_max3_f32 v155, v155, v104, v105
    v_max3_f32 v155, v155, v106, v107
    v_max3_f32 v155, v155, v108, v109
    v_max3_f32 v155, v155, v110, v111
    v_max3_f32 v155, v155, v112, v113
    v_max3_f32 v155, v155, v114, v115
    v_max3_f32 v155, v155, v116, v117
    v_max3_f32 v155, v155, v118, v119
    s_sub_u32 s14, s14, 1
    s_cmp_lg_u32 s14, 0
    s_cbranch_scc1 b_mloop
    v_lshlrev_b32 v156, 2, v1
    s_lshl_b32 s9, s5, 10
    s_add_u32 s8, s5, 1
    s_and_b32 s8, s8, 3
    s_lshl_b32 s8, s8, 8
    s_add_u32 s8, s8, 101376
    s_add_u32 s8, s8, s9
    v_add_u32 v157, s8, v156
    ds_write_b32 v157, v152
    s_add_u32 s8, s5, 2
    s_and_b32 s8, s8, 3
    s_lshl_b32 s8, s8, 8
    s_add_u32 s8, s8, 101376
    s_add_u32 s8, s8, s9
    v_add_u32 v157, s8, v156
    ds_write_b32 v157, v153
    s_add_u32 s8, s5, 3
    s_and_b32 s8, s8, 3
    s_lshl_b32 s8, s8, 8
    s_add_u32 s8, s8, 101376
    s_add_u32 s8, s8, s9
    v_add_u32 v157, s8, v156
    ds_write_b32 v157, v154
    s_add_u32 s8, s5, 4
    s_and_b32 s8, s8, 3
    s_lshl_b32 s8, s8, 8
    s_add_u32 s8, s8, 101376
    s_add_u32 s8, s8, s9
    v_add_u32 v157, s8, v156
    ds_write_b32 v157, v155
    s_waitcnt lgkmcnt(0)
    s_mov_b64 exec, 1
    ds_add_u32 v4, v5 offset:56
    s_mov_b64 exec, -1
    s_mov_b32 s69, 400000
wc_38:
    ds_read_b32 v6, v4 offset:56
    s_waitcnt lgkmcnt(0)
    v_readfirstlane_b32 s8, v6
    s_sub_u32 s69, s69, 1
    s_cmp_ge_u32 s8, 4
    s_cbranch_scc1 wc_38_d
    s_sleep 1
    s_cmp_lg_u32 s69, 0
    s_cbranch_scc1 wc_38
wc_38_d:
    v_and_b32 v156, 31, v1
    v_lshlrev_b32 v156, 2, v156
    s_add_u32 s8, s5, 1
    s_and_b32 s8, s8, 3
    s_lshl_b32 s8, s8, 8
    s_add_u32 s8, s8, 101376
    v_add_u32 v157, s8, v156
    ds_read_b32 v104, v157 offset:0
    ds_read_b32 v105, v157 offset:128
    ds_read_b32 v106, v157 offset:1024
    ds_read_b32 v107, v157 offset:1152
    ds_read_b32 v108, v157 offset:2048
    ds_read_b32 v109, v157 offset:2176
    ds_read_b32 v110, v157 offset:3072
    ds_read_b32 v111, v157 offset:3200
    s_waitcnt lgkmcnt(0)
    v_max3_f32 v152, v104, v105, v106
    v_max3_f32 v152, v152, v107, v108
    v_max3_f32 v152, v152, v109, v110
    v_max_f32 v152, v152, v111
    s_add_u32 s8, s5, 2
    s_and_b32 s8, s8, 3
    s_lshl_b32 s8, s8, 8
    s_add_u32 s8, s8, 101376
    v_add_u32 v157, s8, v156
    ds_read_b32 v104, v157 offset:0
    ds_read_b32 v105, v157 offset:128
    ds_read_b32 v106, v157 offset:1024
    ds_read_b32 v107, v157 offset:1152
    ds_read_b32 v108, v157 offset:2048
    ds_read_b32 v109, v157 offset:2176
    ds_read_b32 v110, v157 offset:3072
    ds_read_b32 v111, v157 offset:3200
    s_waitcnt lgkmcnt(0)
    v_max3_f32 v153, v104, v105, v106
    v_max3_f32 v153, v153, v107, v108
    v_max3_f32 v153, v153, v109, v110
    v_max_f32 v153, v153, v111
    s_add_u32 s8, s5, 3
    s_and_b32 s8, s8, 3
    s_lshl_b32 s8, s8, 8
    s_add_u32 s8, s8, 101376
    v_add_u32 v157, s8, v156
    ds_read_b32 v104, v157 offset:0
    ds_read_b32 v105, v157 offset:128
    ds_read_b32 v106, v157 offset:1024
    ds_read_b32 v107, v157 offset:1152
    ds_read_b32 v108, v157 offset:2048
    ds_read_b32 v109, v157 offset:2176
    ds_read_b32 v110, v157 offset:3072
    ds_read_b32 v111, v157 offset:3200
    s_waitcnt lgkmcnt(0)
    v_max3_f32 v154, v104, v105, v106
    v_max3_f32 v154, v154, v107, v108
    v_max3_f32 v154, v154, v109, v110
    v_max_f32 v154, v154, v111
    s_add_u32 s8, s5, 4
    s_and_b32 s8, s8, 3
    s_lshl_b32 s8, s8, 8
    s_add_u32 s8, s8, 101376
    v_add_u32 v157, s8, v156
    ds_read_b32 v104, v157 offset:0
    ds_read_b32 v105, v157 offset:128
    ds_read_b32 v106, v157 offset:1024
    ds_read_b32 v107, v157 offset:1152
    ds_read_b32 v108, v157 offset:2048
    ds_read_b32 v109, v157 offset:2176
    ds_read_b32 v110, v157 offset:3072
    ds_read_b32 v111, v157 offset:3200
    s_waitcnt lgkmcnt(0)
    v_max3_f32 v155, v104, v105, v106
    v_max3_f32 v155, v155, v107, v108
    v_max3_f32 v155, v155, v109, v110
    v_max_f32 v155, v155, v111
    s_mov_b32 s8, -1.0
    s_mov_b32 exec_lo, 0
    v_mul_f32 v156, s8, v152
    v_and_b32 v157, 0xffff0000, v156
    v_sub_f32 v156, v156, v157
    v_and_b32 v159, 0xffff0000, v156
    v_sub_f32 v156, v156, v159
    v_lshrrev_b32 v157, 16, v157
    v_or_b32 v14, v157, v159
    v_lshrrev_b32 v15, 16, v156
    v_mul_f32 v156, s8, v153
    v_and_b32 v157, 0xffff0000, v156
    v_sub_f32 v156, v156, v157
    v_and_b32 v159, 0xffff0000, v156
    v_sub_f32 v156, v156, v159
    v_lshrrev_b32 v157, 16, v157
    v_or_b32 v22, v157, v159
    v_lshrrev_b32 v23, 16, v156
    v_mul_f32 v156, s8, v154
    v_and_b32 v157, 0xffff0000, v156
    v_sub_f32 v156, v156, v157
    v_and_b32 v159, 0xffff0000, v156
    v_sub_f32 v156, v156, v159
    v_lshrrev_b32 v157, 16, v157
    v_or_b32 v30, v157, v159
    v_lshrrev_b32 v31, 16, v156
    v_mul_f32 v156, s8, v155
    v_and_b32 v157, 0xffff0000, v156
    v_sub_f32 v156, v156, v157
    v_and_b32 v159, 0xffff0000, v156
    v_sub_f32 v156, v156, v159
    v_lshrrev_b32 v157, 16, v157
    v_or_b32 v38, v157, v159
    v_lshrrev_b32 v39, 16, v156
    s_mov_b64 exec, -1
    s_mov_b32 s14, 20000
    s_branch b_main
a_wave:
    s_and_b32 s60, s2, 7
    s_lshr_b32 s61, s2, 3
    s_and_b32 s15, s61, 1
    s_and_b32 s90, s61, 3
    s_lshr_b32 s3, s60, 1
    s_lshl_b32 s3, s3, 2
    s_add_u32 s3, s3, s90
    s_lshr_b32 s86, s3, 1
    s_and_b32 s4, s60, 1
    s_lshl_b32 s4, s4, 3
    s_lshr_b32 s6, s61, 2
    s_add_u32 s4, s4, s6
    v_lshlrev_b32 v3, 4, v1
    s_and_b32 s35, s5, 3
    s_lshl_b32 s11, s35, 12
    s_lshl_b32 s12, s35, 11
    s_lshl_b32 s9, s60, 2
    s_add_u32 s62, s9, s90
    v_and_b32 v8, 31, v1
    v_lshrrev_b32 v9, 5, v1
    s_lshr_b32 s63, s2, 6
    s_lshr_b32 s89, s61, 2
    s_lshl_b32 s67, s60, 3
    s_and_b32 s9, s61, 7
    s_add_u32 s67, s67, s9
    s_lshr_b32 s91, s61, 3
    s_lshl_b32 s91, s91, 1
    s_lshr_b32 s9, s35, 1
    s_add_u32 s91, s91, s9
    s_and_b32 s68, s35, 1
    v_and_b32 v202, 3, v8
    v_lshrrev_b32 v203, 3, v8
    v_lshl_add_u32 v202, v203, 2, v202
    v_bfe_u32 v203, v8, 2, 1
    v_lshlrev_b32 v203, 4, v203
    s_mul_i32 s9, s91, 28
    v_add3_u32 v202, v202, v203, s9
    s_mul_i32 s9, s68, 0x3e800000
    v_mov_b32 v204, s9
    v_cvt_f32_u32 v202, v202
    v_mul_f32 v202, 0x3b124925, v202
    v_lshlrev_b32 v203, 3, v9
    v_cvt_f32_u32 v203, v203
    v_fma_f32 v204, v203, v202, v204
    v_cos_f32 v200, v202
    s_nop 0
    v_add_f32 v200, v200, v200
    v_mov_b32 v201, v200
    v_fmamk_f32 v168, v202, 0x0, v204
    v_fmamk_f32 v169, v202, 0x41800000, v204
    v_fmamk_f32 v170, v202, 0x3f800000, v204
    v_fmamk_f32 v171, v202, 0x41880000, v204
    v_cos_f32 v168, v168
    v_cos_f32 v169, v169
    v_cos_f32 v170, v170
    v_cos_f32 v171, v171
    s_nop 0
    v_pk_fma_f32 v[172:173], v[200:201], v[170:171], v[168:169] neg_lo:[0,0,1] neg_hi:[0,0,1]
    v_fmamk_f32 v184, v202, 0x42000000, v204
    v_cvt_pk_bf16_f32 v16, v168, v170
    v_fmamk_f32 v185, v202, 0x42400000, v204
    v_cvt_pk_bf16_f32 v20, v169, v171
    v_fmamk_f32 v186, v202, 0x42040000, v204
    v_pk_fma_f32 v[174:175], v[200:201], v[172:173], v[170:171] neg_lo:[0,0,1] neg_hi:[0,0,1]
    v_fmamk_f32 v187, v202, 0x42440000, v204
    v_pk_fma_f32 v[176:177], v[200:201], v[174:175], v[172:173] neg_lo:[0,0,1] neg_hi:[0,0,1]
    v_cos_f32 v184, v184
    v_cvt_pk_bf16_f32 v17, v172, v174
    v_cos_f32 v185, v185
    v_cvt_pk_bf16_f32 v21, v173, v175
    v_cos_f32 v186, v186
    v_pk_fma_f32 v[178:179], v[200:201], v[176:177], v[174:175] neg_lo:[0,0,1] neg_hi:[0,0,1]
    v_cos_f32 v187, v187
    v_pk_fma_f32 v[180:181], v[200:201], v[178:179], v[176:177] neg_lo:[0,0,1] neg_hi:[0,0,1]
    v_cvt_pk_bf16_f32 v18, v176, v178
    v_cvt_pk_bf16_f32 v22, v177, v179
    v_pk_fma_f32 v[182:183], v[200:201], v[180:181], v[178:179] neg_lo:[0,0,1] neg_hi:[0,0,1]
    v_cvt_pk_bf16_f32 v19, v180, v182
    v_cvt_pk_bf16_f32 v23, v181, v183
    v_pk_fma_f32 v[188:189], v[200:201], v[186:187], v[184:185] neg_lo:[0,0,1] neg_hi:[0,0,1]
    v_fmamk_f32 v168, v202, 0x42800000, v204
    v_cvt_pk_bf16_f32 v24, v184, v186
    v_fmamk_f32 v169, v202, 0x42a00000, v204
    v_cvt_pk_bf16_f32 v28, v185, v187
    v_fmamk_f32 v170, v202, 0x42820000, v204
    v_pk_fma_f32 v[190:191], v[200:201], v[188:189], v[186:187] neg_lo:[0,0,1] neg_hi:[0,0,1]
    v_fmamk_f32 v171, v202, 0x42a20000, v204
    v_pk_fma_f32 v[192:193], v[200:201], v[190:191], v[188:189] neg_lo:[0,0,1] neg_hi:[0,0,1]
    v_cos_f32 v168, v168
    v_cvt_pk_bf16_f32 v25, v188, v190
    v_cos_f32 v169, v169
    v_cvt_pk_bf16_f32 v29, v189, v191
    v_cos_f32 v170, v170
    v_pk_fma_f32 v[194:195], v[200:201], v[192:193], v[190:191] neg_lo:[0,0,1] neg_hi:[0,0,1]
    v_cos_f32 v171, v171
    v_pk_fma_f32 v[196:197], v[200:201], v[194:195], v[192:193] neg_lo:[0,0,1] neg_hi:[0,0,1]
    v_cvt_pk_bf16_f32 v26, v192, v194
    v_cvt_pk_bf16_f32 v30, v193, v195
    v_pk_fma_f32 v[198:199], v[200:201], v[196:197], v[194:195] neg_lo:[0,0,1] neg_hi:[0,0,1]
    v_cvt_pk_bf16_f32 v27, v196, v198
    v_cvt_pk_bf16_f32 v31, v197, v199
    v_pk_fma_f32 v[172:173], v[200:201], v[170:171], v[168:169] neg_lo:[0,0,1] neg_hi:[0,0,1]
    v_fmamk_f32 v184, v202, 0x42c00000, v204
    v_cvt_pk_bf16_f32 v32, v168, v170
    v_fmamk_f32 v185, v202, 0x42e00000, v204
    v_cvt_pk_bf16_f32 v36, v169, v171
    v_fmamk_f32 v186, v202, 0x42c20000, v204
    v_pk_fma_f32 v[174:175], v[200:201], v[172:173], v[170:171] neg_lo:[0,0,1] neg_hi:[0,0,1]
    v_fmamk_f32 v187, v202, 0x42e20000, v204
    v_pk_fma_f32 v[176:177], v[200:201], v[174:175], v[172:173] neg_lo:[0,0,1] neg_hi:[0,0,1]
    v_cos_f32 v184, v184
    v_cvt_pk_bf16_f32 v33, v172, v174
    v_cos_f32 v185, v185
    v_cvt_pk_bf16_f32 v37, v173, v175
    v_cos_f32 v186, v186
    v_pk_fma_f32 v[178:179], v[200:201], v[176:177], v[174:175] neg_lo:[0,0,1] neg_hi:[0,0,1]
    v_cos_f32 v187, v187
    v_pk_fma_f32 v[180:181], v[200:201], v[178:179], v[176:177] neg_lo:[0,0,1] neg_hi:[0,0,1]
    v_cvt_pk_bf16_f32 v34, v176, v178
    v_cvt_pk_bf16_f32 v38, v177, v179
    v_pk_fma_f32 v[182:183], v[200:201], v[180:181], v[178:179] neg_lo:[0,0,1] neg_hi:[0,0,1]
    v_cvt_pk_bf16_f32 v35, v180, v182
    v_cvt_pk_bf16_f32 v39, v181, v183
    v_pk_fma_f32 v[188:189], v[200:201], v[186:187], v[184:185] neg_lo:[0,0,1] neg_hi:[0,0,1]
    v_fmamk_f32 v168, v202, 0x43000000, v204
    v_cvt_pk_bf16_f32 v40, v184, v186
    v_fmamk_f32 v169, v202, 0x43100000, v204
    v_cvt_pk_bf16_f32 v44, v185, v187
    v_fmamk_f32 v170, v202, 0x43010000, v204
    v_pk_fma_f32 v[190:191], v[200:201], v[188:189], v[186:187] neg_lo:[0,0,1] neg_hi:[0,0,1]
    v_fmamk_f32 v171, v202, 0x43110000, v204
    v_pk_fma_f32 v[192:193], v[200:201], v[190:191], v[188:189] neg_lo:[0,0,1] neg_hi:[0,0,1]
    v_cos_f32 v168, v168
    v_cvt_pk_bf16_f32 v41, v188, v190
    v_cos_f32 v169, v169
    v_cvt_pk_bf16_f32 v45, v189, v191
    v_cos_f32 v170, v170
    v_pk_fma_f32 v[194:195], v[200:201], v[192:193], v[190:191] neg_lo:[0,0,1] neg_hi:[0,0,1]
    v_cos_f32 v171, v171
    v_pk_fma_f32 v[196:197], v[200:201], v[194:195], v[192:193] neg_lo:[0,0,1] neg_hi:[0,0,1]
    v_cvt_pk_bf16_f32 v42, v192, v194
    v_cvt_pk_bf16_f32 v46, v193, v195
    v_pk_fma_f32 v[198:199], v[200:201], v[196:197], v[194:195] neg_lo:[0,0,1] neg_hi:[0,0,1]
    v_cvt_pk_bf16_f32 v43, v196, v198
    v_cvt_pk_bf16_f32 v47, v197, v199
    v_pk_fma_f32 v[172:173], v[200:201], v[170:171], v[168:169] neg_lo:[0,0,1] neg_hi:[0,0,1]
    v_fmamk_f32 v184, v202, 0x43200000, v204
    v_cvt_pk_bf16_f32 v48, v168, v170
    v_fmamk_f32 v185, v202, 0x43300000, v204
    v_cvt_pk_bf16_f32 v52, v169, v171
    v_fmamk_f32 v186, v202, 0x43210000, v204
    v_pk_fma_f32 v[174:175], v[200:201], v[172:173], v[170:171] neg_lo:[0,0,1] neg_hi:[0,0,1]
    v_fmamk_f32 v187, v202, 0x43310000, v204
    v_pk_fma_f32 v[176:177], v[200:201], v[174:175], v[172:173] neg_lo:[0,0,1] neg_hi:[0,0,1]
    v_cos_f32 v184, v184
    v_cvt_pk_bf16_f32 v49, v172, v174
    v_cos_f32 v185, v185
    v_cvt_pk_bf16_f32 v53, v173, v175
    v_cos_f32 v186, v186
    v_pk_fma_f32 v[178:179], v[200:201], v[176:177], v[174:175] neg_lo:[0,0,1] neg_hi:[0,0,1]
    v_cos_f32 v187, v187
    v_pk_fma_f32 v[180:181], v[200:201], v[178:179], v[176:177] neg_lo:[0,0,1] neg_hi:[0,0,1]
    v_cvt_pk_bf16_f32 v50, v176, v178
    v_cvt_pk_bf16_f32 v54, v177, v179
    v_pk_fma_f32 v[182:183], v[200:201], v[180:181], v[178:179] neg_lo:[0,0,1] neg_hi:[0,0,1]
    v_cvt_pk_bf16_f32 v51, v180, v182
    v_cvt_pk_bf16_f32 v55, v181, v183
    v_pk_fma_f32 v[188:189], v[200:201], v[186:187], v[184:185] neg_lo:[0,0,1] neg_hi:[0,0,1]
    v_fmamk_f32 v168, v202, 0x43400000, v204
    v_cvt_pk_bf16_f32 v56, v184, v186
    v_fmamk_f32 v169, v202, 0x43500000, v204
    v_cvt_pk_bf16_f32 v60, v185, v187
    v_fmamk_f32 v170, v202, 0x43410000, v204
    v_pk_fma_f32 v[190:191], v[200:201], v[188:189], v[186:187] neg_lo:[0,0,1] neg_hi:[0,0,1]
    v_fmamk_f32 v171, v202, 0x43510000, v204
    v_pk_fma_f32 v[192:193], v[200:201], v[190:191], v[188:189] neg_lo:[0,0,1] neg_hi:[0,0,1]
    v_cos_f32 v168, v168
    v_cvt_pk_bf16_f32 v57, v188, v190
    v_cos_f32 v169, v169
    v_cvt_pk_bf16_f32 v61, v189, v191
    v_cos_f32 v170, v170
    v_pk_fma_f32 v[194:195], v[200:201], v[192:193], v[190:191] neg_lo:[0,0,1] neg_hi:[0,0,1]
    v_cos_f32 v171, v171
    v_pk_fma_f32 v[196:197], v[200:201], v[194:195], v[192:193] neg_lo:[0,0,1] neg_hi:[0,0,1]
    v_cvt_pk_bf16_f32 v58, v192, v194
    v_cvt_pk_bf16_f32 v62, v193, v195
    v_pk_fma_f32 v[198:199], v[200:201], v[196:197], v[194:195] neg_lo:[0,0,1] neg_hi:[0,0,1]
    v_cvt_pk_bf16_f32 v59, v196, v198
    v_cvt_pk_bf16_f32 v63, v197, v199
    v_pk_fma_f32 v[172:173], v[200:201], v[170:171], v[168:169] neg_lo:[0,0,1] neg_hi:[0,0,1]
    v_fmamk_f32 v184, v202, 0x43600000, v204
    v_cvt_pk_bf16_f32 v64, v168, v170
    v_fmamk_f32 v185, v202, 0x43700000, v204
    v_cvt_pk_bf16_f32 v68, v169, v171
    v_fmamk_f32 v186, v202, 0x43610000, v204
    v_pk_fma_f32 v[174:175], v[200:201], v[172:173], v[170:171] neg_lo:[0,0,1] neg_hi:[0,0,1]
    v_fmamk_f32 v187, v202, 0x43710000, v204
    v_pk_fma_f32 v[176:177], v[200:201], v[174:175], v[172:173] neg_lo:[0,0,1] neg_hi:[0,0,1]
    v_cos_f32 v184, v184
    v_cvt_pk_bf16_f32 v65, v172, v174
    v_cos_f32 v185, v185
    v_cvt_pk_bf16_f32 v69, v173, v175
    v_cos_f32 v186, v186
    v_pk_fma_f32 v[178:179], v[200:201], v[176:177], v[174:175] neg_lo:[0,0,1] neg_hi:[0,0,1]
    v_cos_f32 v187, v187
    v_pk_fma_f32 v[180:181], v[200:201], v[178:179], v[176:177] neg_lo:[0,0,1] neg_hi:[0,0,1]
    v_cvt_pk_bf16_f32 v66, v176, v178
    v_cvt_pk_bf16_f32 v70, v177, v179
    v_pk_fma_f32 v[182:183], v[200:201], v[180:181], v[178:179] neg_lo:[0,0,1] neg_hi:[0,0,1]
    v_cvt_pk_bf16_f32 v67, v180, v182
    v_cvt_pk_bf16_f32 v71, v181, v183
    v_pk_fma_f32 v[188:189], v[200:201], v[186:187], v[184:185] neg_lo:[0,0,1] neg_hi:[0,0,1]
    v_fmamk_f32 v168, v202, 0x43800000, v204
    v_cvt_pk_bf16_f32 v72, v184, v186
    v_fmamk_f32 v169, v202, 0x43880000, v204
    v_cvt_pk_bf16_f32 v76, v185, v187
    v_fmamk_f32 v170, v202, 0x43808000, v204
    v_pk_fma_f32 v[190:191], v[200:201], v[188:189], v[186:187] neg_lo:[0,0,1] neg_hi:[0,0,1]
    v_fmamk_f32 v171, v202, 0x43888000, v204
    v_pk_fma_f32 v[192:193], v[200:201], v[190:191], v[188:189] neg_lo:[0,0,1] neg_hi:[0,0,1]
    v_cos_f32 v168, v168
    v_cvt_pk_bf16_f32 v73, v188, v190
    v_cos_f32 v169, v169
    v_cvt_pk_bf16_f32 v77, v189, v191
    v_cos_f32 v170, v170
    v_pk_fma_f32 v[194:195], v[200:201], v[192:193], v[190:191] neg_lo:[0,0,1] neg_hi:[0,0,1]
    v_cos_f32 v171, v171
    v_pk_fma_f32 v[196:197], v[200:201], v[194:195], v[192:193] neg_lo:[0,0,1] neg_hi:[0,0,1]
    v_cvt_pk_bf16_f32 v74, v192, v194
    v_cvt_pk_bf16_f32 v78, v193, v195
    v_pk_fma_f32 v[198:199], v[200:201], v[196:197], v[194:195] neg_lo:[0,0,1] neg_hi:[0,0,1]
    v_cvt_pk_bf16_f32 v75, v196, v198
    v_cvt_pk_bf16_f32 v79, v197, v199
    v_pk_fma_f32 v[172:173], v[200:201], v[170:171], v[168:169] neg_lo:[0,0,1] neg_hi:[0,0,1]
    v_fmamk_f32 v184, v202, 0x43900000, v204
    v_cvt_pk_bf16_f32 v80, v168, v170
    v_fmamk_f32 v185, v202, 0x43980000, v204
    v_cvt_pk_bf16_f32 v84, v169, v171
    v_fmamk_f32 v186, v202, 0x43908000, v204
    v_pk_fma_f32 v[174:175], v[200:201], v[172:173], v[170:171] neg_lo:[0,0,1] neg_hi:[0,0,1]
    v_fmamk_f32 v187, v202, 0x43988000, v204
    v_pk_fma_f32 v[176:177], v[200:201], v[174:175], v[172:173] neg_lo:[0,0,1] neg_hi:[0,0,1]
    v_cos_f32 v184, v184
    v_cvt_pk_bf16_f32 v81, v172, v174
    v_cos_f32 v185, v185
    v_cvt_pk_bf16_f32 v85, v173, v175
    v_cos_f32 v186, v186
    v_pk_fma_f32 v[178:179], v[200:201], v[176:177], v[174:175] neg_lo:[0,0,1] neg_hi:[0,0,1]
    v_cos_f32 v187, v187
    v_pk_fma_f32 v[180:181], v[200:201], v[178:179], v[176:177] neg_lo:[0,0,1] neg_hi:[0,0,1]
    v_cvt_pk_bf16_f32 v82, v176, v178
    v_cvt_pk_bf16_f32 v86, v177, v179
    v_pk_fma_f32 v[182:183], v[200:201], v[180:181], v[178:179] neg_lo:[0,0,1] neg_hi:[0,0,1]
    v_cvt_pk_bf16_f32 v83, v180, v182
    v_cvt_pk_bf16_f32 v87, v181, v183
    v_pk_fma_f32 v[188:189], v[200:201], v[186:187], v[184:185] neg_lo:[0,0,1] neg_hi:[0,0,1]
    v_fmamk_f32 v168, v202, 0x43a00000, v204
    v_cvt_pk_bf16_f32 v88, v184, v186
    v_fmamk_f32 v169, v202, 0x43a80000, v204
    v_cvt_pk_bf16_f32 v92, v185, v187
    v_fmamk_f32 v170, v202, 0x43a08000, v204
    v_pk_fma_f32 v[190:191], v[200:201], v[188:189], v[186:187] neg_lo:[0,0,1] neg_hi:[0,0,1]
    v_fmamk_f32 v171, v202, 0x43a88000, v204
    v_pk_fma_f32 v[192:193], v[200:201], v[190:191], v[188:189] neg_lo:[0,0,1] neg_hi:[0,0,1]
    v_cos_f32 v168, v168
    v_cvt_pk_bf16_f32 v89, v188, v190
    v_cos_f32 v169, v169
    v_cvt_pk_bf16_f32 v93, v189, v191
    v_cos_f32 v170, v170
    v_pk_fma_f32 v[194:195], v[200:201], v[192:193], v[190:191] neg_lo:[0,0,1] neg_hi:[0,0,1]
    v_cos_f32 v171, v171
    v_pk_fma_f32 v[196:197], v[200:201], v[194:195], v[192:193] neg_lo:[0,0,1] neg_hi:[0,0,1]
    v_cvt_pk_bf16_f32 v90, v192, v194
    v_cvt_pk_bf16_f32 v94, v193, v195
    v_pk_fma_f32 v[198:199], v[200:201], v[196:197], v[194:195] neg_lo:[0,0,1] neg_hi:[0,0,1]
    v_cvt_pk_bf16_f32 v91, v196, v198
    v_cvt_pk_bf16_f32 v95, v197, v199
    v_pk_fma_f32 v[172:173], v[200:201], v[170:171], v[168:169] neg_lo:[0,0,1] neg_hi:[0,0,1]
    v_fmamk_f32 v184, v202, 0x43b00000, v204
    v_cvt_pk_bf16_f32 v96, v168, v170
    v_fmamk_f32 v185, v202, 0x43b80000, v204
    v_cvt_pk_bf16_f32 v100, v169, v171
    v_fmamk_f32 v186, v202, 0x43b08000, v204
    v_pk_fma_f32 v[174:175], v[200:201], v[172:173], v[170:171] neg_lo:[0,0,1] neg_hi:[0,0,1]
    v_fmamk_f32 v187, v202, 0x43b88000, v204
    v_pk_fma_f32 v[176:177], v[200:201], v[174:175], v[172:173] neg_lo:[0,0,1] neg_hi:[0,0,1]
    v_cos_f32 v184, v184
    v_cvt_pk_bf16_f32 v97, v172, v174
    v_cos_f32 v185, v185
    v_cvt_pk_bf16_f32 v101, v173, v175
    v_cos_f32 v186, v186
    v_pk_fma_f32 v[178:179], v[200:201], v[176:177], v[174:175] neg_lo:[0,0,1] neg_hi:[0,0,1]
    v_cos_f32 v187, v187
    v_pk_fma_f32 v[180:181], v[200:201], v[178:179], v[176:177] neg_lo:[0,0,1] neg_hi:[0,0,1]
    v_cvt_pk_bf16_f32 v98, v176, v178
    v_cvt_pk_bf16_f32 v102, v177, v179
    v_pk_fma_f32 v[182:183], v[200:201], v[180:181], v[178:179] neg_lo:[0,0,1] neg_hi:[0,0,1]
    v_cvt_pk_bf16_f32 v99, v180, v182
    v_cvt_pk_bf16_f32 v103, v181, v183
    v_pk_fma_f32 v[188:189], v[200:201], v[186:187], v[184:185] neg_lo:[0,0,1] neg_hi:[0,0,1]
    v_fmamk_f32 v168, v202, 0x43c00000, v204
    v_cvt_pk_bf16_f32 v104, v184, v186
    v_fmamk_f32 v169, v202, 0x43c80000, v204
    v_cvt_pk_bf16_f32 v108, v185, v187
    v_fmamk_f32 v170, v202, 0x43c08000, v204
    v_pk_fma_f32 v[190:191], v[200:201], v[188:189], v[186:187] neg_lo:[0,0,1] neg_hi:[0,0,1]
    v_fmamk_f32 v171, v202, 0x43c88000, v204
    v_pk_fma_f32 v[192:193], v[200:201], v[190:191], v[188:189] neg_lo:[0,0,1] neg_hi:[0,0,1]
    v_cos_f32 v168, v168
    v_cvt_pk_bf16_f32 v105, v188, v190
    v_cos_f32 v169, v169
    v_cvt_pk_bf16_f32 v109, v189, v191
    v_cos_f32 v170, v170
    v_pk_fma_f32 v[194:195], v[200:201], v[192:193], v[190:191] neg_lo:[0,0,1] neg_hi:[0,0,1]
    v_cos_f32 v171, v171
    v_pk_fma_f32 v[196:197], v[200:201], v[194:195], v[192:193] neg_lo:[0,0,1] neg_hi:[0,0,1]
    v_cvt_pk_bf16_f32 v106, v192, v194
    v_cvt_pk_bf16_f32 v110, v193, v195
    v_pk_fma_f32 v[198:199], v[200:201], v[196:197], v[194:195] neg_lo:[0,0,1] neg_hi:[0,0,1]
    v_cvt_pk_bf16_f32 v107, v196, v198
    v_cvt_pk_bf16_f32 v111, v197, v199
    v_pk_fma_f32 v[172:173], v[200:201], v[170:171], v[168:169] neg_lo:[0,0,1] neg_hi:[0,0,1]
    v_fmamk_f32 v184, v202, 0x43d00000, v204
    v_cvt_pk_bf16_f32 v112, v168, v170
    v_fmamk_f32 v185, v202, 0x43d80000, v204
    v_cvt_pk_bf16_f32 v116, v169, v171
    v_fmamk_f32 v186, v202, 0x43d08000, v204
    v_pk_fma_f32 v[174:175], v[200:201], v[172:173], v[170:171] neg_lo:[0,0,1] neg_hi:[0,0,1]
    v_fmamk_f32 v187, v202, 0x43d88000, v204
    v_pk_fma_f32 v[176:177], v[200:201], v[174:175], v[172:173] neg_lo:[0,0,1] neg_hi:[0,0,1]
    v_cos_f32 v184, v184
    v_cvt_pk_bf16_f32 v113, v172, v174
    v_cos_f32 v185, v185
    v_cvt_pk_bf16_f32 v117, v173, v175
    v_cos_f32 v186, v186
    v_pk_fma_f32 v[178:179], v[200:201], v[176:177], v[174:175] neg_lo:[0,0,1] neg_hi:[0,0,1]
    v_cos_f32 v187, v187
    v_pk_fma_f32 v[180:181], v[200:201], v[178:179], v[176:177] neg_lo:[0,0,1] neg_hi:[0,0,1]
    v_cvt_pk_bf16_f32 v114, v176, v178
    v_cvt_pk_bf16_f32 v118, v177, v179
    v_pk_fma_f32 v[182:183], v[200:201], v[180:181], v[178:179] neg_lo:[0,0,1] neg_hi:[0,0,1]
    v_cvt_pk_bf16_f32 v115, v180, v182
    v_cvt_pk_bf16_f32 v119, v181, v183
    v_pk_fma_f32 v[188:189], v[200:201], v[186:187], v[184:185] neg_lo:[0,0,1] neg_hi:[0,0,1]
    v_cvt_pk_bf16_f32 v120, v184, v186
    v_cvt_pk_bf16_f32 v124, v185, v187
    v_pk_fma_f32 v[190:191], v[200:201], v[188:189], v[186:187] neg_lo:[0,0,1] neg_hi:[0,0,1]
    v_pk_fma_f32 v[192:193], v[200:201], v[190:191], v[188:189] neg_lo:[0,0,1] neg_hi:[0,0,1]
    v_cvt_pk_bf16_f32 v121, v188, v190
    v_cvt_pk_bf16_f32 v125, v189, v191
    v_pk_fma_f32 v[194:195], v[200:201], v[192:193], v[190:191] neg_lo:[0,0,1] neg_hi:[0,0,1]
    v_pk_fma_f32 v[196:197], v[200:201], v[194:195], v[192:193] neg_lo:[0,0,1] neg_hi:[0,0,1]
    v_cvt_pk_bf16_f32 v122, v192, v194
    v_cvt_pk_bf16_f32 v126, v193, v195
    v_pk_fma_f32 v[198:199], v[200:201], v[196:197], v[194:195] neg_lo:[0,0,1] neg_hi:[0,0,1]
    v_cvt_pk_bf16_f32 v123, v196, v198
    v_cvt_pk_bf16_f32 v127, v197, v199
    s_lshl_b32 s13, s68, 31
    s_lshr_b32 s8, s13, 16
    s_or_b32 s13, s13, s8
    v_cvt_f32_u32 v204, v8
    v_mul_f32 v204, 0x3a000000, v204
    v_lshlrev_b32 v205, 8, v9
    v_add_u32 v205, s67, v205
    v_cvt_f32_u32 v205, v205
    v_mul_f32 v205, v205, v204
    v_fmamk_f32 v206, v204, 0x0, v205
    v_fmamk_f32 v207, v204, 0x42800000, v205
    v_cos_f32 v208, v206
    v_cos_f32 v209, v207
    v_sin_f32 v206, v206
    v_sin_f32 v207, v207
    v_cvt_pk_bf16_f32 v128, v208, v209
    v_cvt_pk_bf16_f32 v136, v206, v207
    v_xor_b32 v136, s13, v136
    v_fmamk_f32 v206, v204, 0x43000000, v205
    v_fmamk_f32 v207, v204, 0x43400000, v205
    v_cos_f32 v208, v206
    v_cos_f32 v209, v207
    v_sin_f32 v206, v206
    v_sin_f32 v207, v207
    v_cvt_pk_bf16_f32 v129, v208, v209
    v_cvt_pk_bf16_f32 v137, v206, v207
    v_xor_b32 v137, s13, v137
    v_fmamk_f32 v206, v204, 0x44000000, v205
    v_fmamk_f32 v207, v204, 0x44100000, v205
    v_cos_f32 v208, v206
    v_cos_f32 v209, v207
    v_sin_f32 v206, v206
    v_sin_f32 v207, v207
    v_cvt_pk_bf16_f32 v130, v208, v209
    v_cvt_pk_bf16_f32 v138, v206, v207
    v_xor_b32 v138, s13, v138
    v_fmamk_f32 v206, v204, 0x44200000, v205
    v_fmamk_f32 v207, v204, 0x44300000, v205
    v_cos_f32 v208, v206
    v_cos_f32 v209, v207
    v_sin_f32 v206, v206
    v_sin_f32 v207, v207
    v_cvt_pk_bf16_f32 v131, v208, v209
    v_cvt_pk_bf16_f32 v139, v206, v207
    v_xor_b32 v139, s13, v139
    v_fmamk_f32 v206, v204, 0x44800000, v205
    v_fmamk_f32 v207, v204, 0x44880000, v205
    v_cos_f32 v208, v206
    v_cos_f32 v209, v207
    v_sin_f32 v206, v206
    v_sin_f32 v207, v207
    v_cvt_pk_bf16_f32 v132, v208, v209
    v_cvt_pk_bf16_f32 v140, v206, v207
    v_xor_b32 v140, s13, v140
    v_fmamk_f32 v206, v204, 0x44900000, v205
    v_fmamk_f32 v207, v204, 0x44980000, v205
    v_cos_f32 v208, v206
    v_cos_f32 v209, v207
    v_sin_f32 v206, v206
    v_sin_f32 v207, v207
    v_cvt_pk_bf16_f32 v133, v208, v209
    v_cvt_pk_bf16_f32 v141, v206, v207
    v_xor_b32 v141, s13, v141
    v_fmamk_f32 v206, v204, 0x44c00000, v205
    v_fmamk_f32 v207, v204, 0x44c80000, v205
    v_cos_f32 v208, v206
    v_cos_f32 v209, v207
    v_sin_f32 v206, v206
    v_sin_f32 v207, v207
    v_cvt_pk_bf16_f32 v134, v208, v209
    v_cvt_pk_bf16_f32 v142, v206, v207
    v_xor_b32 v142, s13, v142
    v_fmamk_f32 v206, v204, 0x44d00000, v205
    v_fmamk_f32 v207, v204, 0x44d80000, v205
    v_cos_f32 v208, v206
    v_cos_f32 v209, v207
    v_sin_f32 v206, v206
    v_sin_f32 v207, v207
    v_cvt_pk_bf16_f32 v135, v208, v209
    v_cvt_pk_bf16_f32 v143, v206, v207
    v_xor_b32 v143, s13, v143
    s_waitcnt lgkmcnt(0)
    s_mov_b32 s44, s32
    s_mov_b32 s45, s33
    s_mov_b32 s46, 33554432
    s_mov_b32 s47, 0x20000
    s_lshl_b32 s8, s35, 4
    v_and_b32 v186, 15, v1
    v_add_u32 v186, s8, v186
    v_cvt_f32_u32 v186, v186
    v_mul_f32 v186, 0x3c800000, v186
    v_lshrrev_b32 v187, 4, v1
    v_lshlrev_b32 v187, 2, v187
    v_cvt_f32_u32 v187, v187
    v_mul_f32 v187, v187, v186
    v_fmamk_f32 v188, v186, 0x0, v187
    v_fmamk_f32 v189, v186, 0x3f800000, v187
    v_fmamk_f32 v190, v186, 0x40000000, v187
    v_fmamk_f32 v191, v186, 0x40400000, v187
    v_cos_f32 v192, v188
    v_cos_f32 v193, v189
    v_cos_f32 v194, v190
    v_cos_f32 v195, v191
    v_sin_f32 v188, v188
    v_sin_f32 v189, v189
    v_sin_f32 v190, v190
    v_sin_f32 v191, v191
    v_cvt_pk_bf16_f32 v216, v192, v193
    v_cvt_pk_bf16_f32 v217, v194, v195
    v_cvt_pk_bf16_f32 v224, v188, v189
    v_cvt_pk_bf16_f32 v225, v190, v191
    v_xor_b32 v160, 0x80008000, v224
    v_xor_b32 v161, 0x80008000, v225
    v_fmamk_f32 v188, v186, 0x41800000, v187
    v_fmamk_f32 v189, v186, 0x41880000, v187
    v_fmamk_f32 v190, v186, 0x41900000, v187
    v_fmamk_f32 v191, v186, 0x41980000, v187
    v_cos_f32 v192, v188
    v_cos_f32 v193, v189
    v_cos_f32 v194, v190
    v_cos_f32 v195, v191
    v_sin_f32 v188, v188
    v_sin_f32 v189, v189
    v_sin_f32 v190, v190
    v_sin_f32 v191, v191
    v_cvt_pk_bf16_f32 v218, v192, v193
    v_cvt_pk_bf16_f32 v219, v194, v195
    v_cvt_pk_bf16_f32 v226, v188, v189
    v_cvt_pk_bf16_f32 v227, v190, v191
    v_xor_b32 v162, 0x80008000, v226
    v_xor_b32 v163, 0x80008000, v227
    v_fmamk_f32 v188, v186, 0x42000000, v187
    v_fmamk_f32 v189, v186, 0x42040000, v187
    v_fmamk_f32 v190, v186, 0x42080000, v187
    v_fmamk_f32 v191, v186, 0x420c0000, v187
    v_cos_f32 v192, v188
    v_cos_f32 v193, v189
    v_cos_f32 v194, v190
    v_cos_f32 v195, v191
    v_sin_f32 v188, v188
    v_sin_f32 v189, v189
    v_sin_f32 v190, v190
    v_sin_f32 v191, v191
    v_cvt_pk_bf16_f32 v220, v192, v193
    v_cvt_pk_bf16_f32 v221, v194, v195
    v_cvt_pk_bf16_f32 v228, v188, v189
    v_cvt_pk_bf16_f32 v229, v190, v191
    v_xor_b32 v164, 0x80008000, v228
    v_xor_b32 v165, 0x80008000, v229
    v_fmamk_f32 v188, v186, 0x42400000, v187
    v_fmamk_f32 v189, v186, 0x42440000, v187
    v_fmamk_f32 v190, v186, 0x42480000, v187
    v_fmamk_f32 v191, v186, 0x424c0000, v187
    v_cos_f32 v192, v188
    v_cos_f32 v193, v189
    v_cos_f32 v194, v190
    v_cos_f32 v195, v191
    v_sin_f32 v188, v188
    v_sin_f32 v189, v189
    v_sin_f32 v190, v190
    v_sin_f32 v191, v191
    v_cvt_pk_bf16_f32 v222, v192, v193
    v_cvt_pk_bf16_f32 v223, v194, v195
    v_cvt_pk_bf16_f32 v230, v188, v189
    v_cvt_pk_bf16_f32 v231, v190, v191
    v_xor_b32 v166, 0x80008000, v230
    v_xor_b32 v167, 0x80008000, v231
    s_mov_b32 s8, 0x36124925
    s_lshl_b32 s9, s68, 31
    s_xor_b32 s9, s9, s8
    s_xor_b32 s9, s9, 0x80000000
    v_lshlrev_b32 v186, 6, v8
    v_add_u32 v186, s67, v186
    v_cvt_f32_u32 v186, v186
    v_mul_f32 v186, 0x3a000000, v186
    v_lshlrev_b32 v187, 3, v9
    v_cvt_f32_u32 v187, v187
    v_mul_f32 v187, v187, v186
    v_fmamk_f32 v188, v186, 0x0, v187
    v_fmamk_f32 v189, v186, 0x3f800000, v187
    v_fmamk_f32 v190, v186, 0x40000000, v187
    v_fmamk_f32 v191, v186, 0x40400000, v187
    v_cos_f32 v192, v188
    v_cos_f32 v193, v189
    v_cos_f32 v194, v190
    v_cos_f32 v195, v191
    v_sin_f32 v188, v188
    v_sin_f32 v189, v189
    v_sin_f32 v190, v190
    v_sin_f32 v191, v191
    v_mul_f32 v192, s8, v192
    v_mul_f32 v193, s8, v193
    v_mul_f32 v194, s8, v194
    v_mul_f32 v195, s8, v195
    v_mul_f32 v188, s9, v188
    v_mul_f32 v189, s9, v189
    v_mul_f32 v190, s9, v190
    v_mul_f32 v191, s9, v191
    v_cvt_pk_bf16_f32 v144, v192, v193
    v_cvt_pk_bf16_f32 v145, v194, v195
    v_cvt_pk_bf16_f32 v152, v188, v189
    v_cvt_pk_bf16_f32 v153, v190, v191
    v_fmamk_f32 v188, v186, 0x40800000, v187
    v_fmamk_f32 v189, v186, 0x40a00000, v187
    v_fmamk_f32 v190, v186, 0x40c00000, v187
    v_fmamk_f32 v191, v186, 0x40e00000, v187
    v_cos_f32 v192, v188
    v_cos_f32 v193, v189
    v_cos_f32 v194, v190
    v_cos_f32 v195, v191
    v_sin_f32 v188, v188
    v_sin_f32 v189, v189
    v_sin_f32 v190, v190
    v_sin_f32 v191, v191
    v_mul_f32 v192, s8, v192
    v_mul_f32 v193, s8, v193
    v_mul_f32 v194, s8, v194
    v_mul_f32 v195, s8, v195
    v_mul_f32 v188, s9, v188
    v_mul_f32 v189, s9, v189
    v_mul_f32 v190, s9, v190
    v_mul_f32 v191, s9, v191
    v_cvt_pk_bf16_f32 v146, v192, v193
    v_cvt_pk_bf16_f32 v147, v194, v195
    v_cvt_pk_bf16_f32 v154, v188, v189
    v_cvt_pk_bf16_f32 v155, v190, v191
    v_fmamk_f32 v188, v186, 0x41800000, v187
    v_fmamk_f32 v189, v186, 0x41880000, v187
    v_fmamk_f32 v190, v186, 0x41900000, v187
    v_fmamk_f32 v191, v186, 0x41980000, v187
    v_cos_f32 v192, v188
    v_cos_f32 v193, v189
    v_cos_f32 v194, v190
    v_cos_f32 v195, v191
    v_sin_f32 v188, v188
    v_sin_f32 v189, v189
    v_sin_f32 v190, v190
    v_sin_f32 v191, v191
    v_mul_f32 v192, s8, v192
    v_mul_f32 v193, s8, v193
    v_mul_f32 v194, s8, v194
    v_mul_f32 v195, s8, v195
    v_mul_f32 v188, s9, v188
    v_mul_f32 v189, s9, v189
    v_mul_f32 v190, s9, v190
    v_mul_f32 v191, s9, v191
    v_cvt_pk_bf16_f32 v148, v192, v193
    v_cvt_pk_bf16_f32 v149, v194, v195
    v_cvt_pk_bf16_f32 v156, v188, v189
    v_cvt_pk_bf16_f32 v157, v190, v191
    v_fmamk_f32 v188, v186, 0x41a00000, v187
    v_fmamk_f32 v189, v186, 0x41a80000, v187
    v_fmamk_f32 v190, v186, 0x41b00000, v187
    v_fmamk_f32 v191, v186, 0x41b80000, v187
    v_cos_f32 v192, v188
    v_cos_f32 v193, v189
    v_cos_f32 v194, v190
    v_cos_f32 v195, v191
    v_sin_f32 v188, v188
    v_sin_f32 v189, v189
    v_sin_f32 v190, v190
    v_sin_f32 v191, v191
    v_mul_f32 v192, s8, v192
    v_mul_f32 v193, s8, v193
    v_mul_f32 v194, s8, v194
    v_mul_f32 v195, s8, v195
    v_mul_f32 v188, s9, v188
    v_mul_f32 v189, s9, v189
    v_mul_f32 v190, s9, v190
    v_mul_f32 v191, s9, v191
    v_cvt_pk_bf16_f32 v150, v192, v193
    v_cvt_pk_bf16_f32 v151, v194, v195
    v_cvt_pk_bf16_f32 v158, v188, v189
    v_cvt_pk_bf16_f32 v159, v190, v191
    s_mov_b32 s40, s26
    s_mov_b32 s41, s27
    s_mov_b32 s42, 401408
    s_mov_b32 s43, 0x20000
    s_mov_b32 s48, s28
    s_mov_b32 s49, s29
    s_mov_b32 s50, 3670016
    s_mov_b32 s51, 0x20000
    v_bfe_u32 v10, v8, 1, 3
    v_lshlrev_b32 v6, 7, v8
    v_add_u32 v6, 118784, v6
    v_add_u32 v7, 0, v9
    v_xor_b32 v7, v7, v10
    v_lshl_add_u32 v12, v7, 4, v6
    v_add_u32 v7, 2, v9
    v_xor_b32 v7, v7, v10
    v_lshl_add_u32 v13, v7, 4, v6
    v_add_u32 v7, 4, v9
    v_xor_b32 v7, v7, v10
    v_lshl_add_u32 v14, v7, 4, v6
    v_add_u32 v7, 6, v9
    v_xor_b32 v7, v7, v10
    v_lshl_add_u32 v15, v7, 4, v6
    s_setprio 0
    s_mov_b32 s69, 400000
a_xw:
    ds_read_b128 v[200:203], v4 offset:112
    s_waitcnt lgkmcnt(0)
    v_min3_u32 v200, v200, v201, v202
    v_min_u32 v200, v200, v203
    s_sub_u32 s69, s69, 1
    v_readfirstlane_b32 s8, v200
    s_nop 1
    s_cmp_lg_u32 s8, 0
    s_cbranch_scc1 a_xw_d
    s_sleep 1
    s_cmp_lg_u32 s69, 0
    s_cbranch_scc1 a_xw
a_xw_d:
    ds_read_b32 v2, v4 offset:108
    s_setprio 0
    ds_read_b128 v[184:187], v12 offset:0
    ds_read_b128 v[188:191], v13 offset:0
    ds_read_b128 v[192:195], v14 offset:0
    ds_read_b128 v[196:199], v15 offset:0
    ds_read_b128 v[200:203], v12 offset:4096
    ds_read_b128 v[204:207], v13 offset:4096
    ds_read_b128 v[208:211], v14 offset:4096
    ds_read_b128 v[212:215], v15 offset:4096
    s_waitcnt lgkmcnt(4)
    v_mfma_f32_32x32x16_bf16 v[168:183], v[184:187], v[16:19], 0
    v_mfma_f32_32x32x16_bf16 v[168:183], v[188:191], v[20:23], v[168:183]
    v_mfma_f32_32x32x16_bf16 v[168:183], v[192:195], v[24:27], v[168:183]
    v_mfma_f32_32x32x16_bf16 v[168:183], v[196:199], v[28:31], v[168:183]
    ds_read_b128 v[184:187], v12 offset:8192
    ds_read_b128 v[188:191], v13 offset:8192
    ds_read_b128 v[192:195], v14 offset:8192
    ds_read_b128 v[196:199], v15 offset:8192
    s_waitcnt lgkmcnt(4)
    v_mfma_f32_32x32x16_bf16 v[168:183], v[200:203], v[32:35], v[168:183]
    v_mfma_f32_32x32x16_bf16 v[168:183], v[204:207], v[36:39], v[168:183]
    v_mfma_f32_32x32x16_bf16 v[168:183], v[208:211], v[40:43], v[168:183]
    v_mfma_f32_32x32x16_bf16 v[168:183], v[212:215], v[44:47], v[168:183]
    s_mov_b64 exec, 1
    ds_add_u32 v4, v5 offset:0
    s_mov_b64 exec, -1
    ds_read_b128 v[200:203], v12 offset:12288
    ds_read_b128 v[204:207], v13 offset:12288
    ds_read_b128 v[208:211], v14 offset:12288
    ds_read_b128 v[212:215], v15 offset:12288
    s_waitcnt lgkmcnt(4)
    v_mfma_f32_32x32x16_bf16 v[168:183], v[184:187], v[48:51], v[168:183]
    v_mfma_f32_32x32x16_bf16 v[168:183], v[188:191], v[52:55], v[168:183]
    v_mfma_f32_32x32x16_bf16 v[168:183], v[192:195], v[56:59], v[168:183]
    v_mfma_f32_32x32x16_bf16 v[168:183], v[196:199], v[60:63], v[168:183]
    ds_read_b128 v[184:187], v12 offset:16384
    ds_read_b128 v[188:191], v13 offset:16384
    ds_read_b128 v[192:195], v14 offset:16384
    ds_read_b128 v[196:199], v15 offset:16384
    s_waitcnt lgkmcnt(4)
    v_mfma_f32_32x32x16_bf16 v[168:183], v[200:203], v[64:67], v[168:183]
    v_mfma_f32_32x32x16_bf16 v[168:183], v[204:207], v[68:71], v[168:183]
    v_mfma_f32_32x32x16_bf16 v[168:183], v[208:211], v[72:75], v[168:183]
    v_mfma_f32_32x32x16_bf16 v[168:183], v[212:215], v[76:79], v[168:183]
    ds_read_b128 v[200:203], v12 offset:20480
    ds_read_b128 v[204:207], v13 offset:20480
    ds_read_b128 v[208:211], v14 offset:20480
    ds_read_b128 v[212:215], v15 offset:20480
    s_waitcnt lgkmcnt(4)
    v_mfma_f32_32x32x16_bf16 v[168:183], v[184:187], v[80:83], v[168:183]
    v_mfma_f32_32x32x16_bf16 v[168:183], v[188:191], v[84:87], v[168:183]
    v_mfma_f32_32x32x16_bf16 v[168:183], v[192:195], v[88:91], v[168:183]
    v_mfma_f32_32x32x16_bf16 v[168:183], v[196:199], v[92:95], v[168:183]
    ds_read_b128 v[184:187], v12 offset:24576
    ds_read_b128 v[188:191], v13 offset:24576
    ds_read_b128 v[192:195], v14 offset:24576
    ds_read_b128 v[196:199], v15 offset:24576
    s_waitcnt lgkmcnt(4)
    v_mfma_f32_32x32x16_bf16 v[168:183], v[200:203], v[96:99], v[168:183]
    v_mfma_f32_32x32x16_bf16 v[168:183], v[204:207], v[100:103], v[168:183]
    v_mfma_f32_32x32x16_bf16 v[168:183], v[208:211], v[104:107], v[168:183]
    v_mfma_f32_32x32x16_bf16 v[168:183], v[212:215], v[108:111], v[168:183]
    s_waitcnt lgkmcnt(0)
    v_mfma_f32_32x32x16_bf16 v[168:183], v[184:187], v[112:115], v[168:183]
    v_mfma_f32_32x32x16_bf16 v[168:183], v[188:191], v[116:119], v[168:183]
    v_mfma_f32_32x32x16_bf16 v[168:183], v[192:195], v[120:123], v[168:183]
    v_mfma_f32_32x32x16_bf16 v[168:183], v[196:199], v[124:127], v[168:183]
    s_setprio 0
    s_lshl_b32 s8, s35, 11
    s_add_u32 s8, s8, 118784
    v_add_u32 v6, s8, v3
    v_mov_b32 v11, v6
    v_readfirstlane_b32 s34, v2
    s_mov_b32 s93, 0x00030003
    s_nop 1
    s_add_u32 s34, s34, 1
    s_bfe_i32 s92, s34, 0x10000
    s_xor_b32 s92, s92, 0x6a39e5c1
    s_mul_i32 s34, s34, 0x9E3779B1
    s_mov_b32 s69, 400000
wc_39:
    ds_read_b32 v6, v4 offset:0
    s_waitcnt lgkmcnt(0)
    v_readfirstlane_b32 s8, v6
    s_sub_u32 s69, s69, 1
    s_cmp_ge_u32 s8, 4
    s_cbranch_scc1 wc_39_d
    s_sleep 1
    s_cmp_lg_u32 s69, 0
    s_cbranch_scc1 wc_39
wc_39_d:
    v_mov_b32 v6, v11
    s_nop 3
    v_cvt_pk_bf16_f32 v200, v168, v169
    v_cvt_pk_bf16_f32 v201, v170, v171
    v_cvt_pk_bf16_f32 v202, v172, v173
    v_cvt_pk_bf16_f32 v203, v174, v175
    v_cvt_pk_bf16_f32 v204, v176, v177
    v_cvt_pk_bf16_f32 v205, v178, v179
    v_cvt_pk_bf16_f32 v206, v180, v181
    v_cvt_pk_bf16_f32 v207, v182, v183
    ds_write_b128 v6, v[200:203] offset:0
    ds_write_b128 v6, v[204:207] offset:1024
    v_mfma_f32_32x32x16_bf16 v[184:199], v[200:203], v[128:131], 0
    v_mfma_f32_32x32x16_bf16 v[184:199], v[204:207], v[132:135], v[184:199]
    s_waitcnt lgkmcnt(0)
    s_mov_b64 exec, 1
    ds_add_u32 v4, v5 offset:4
    s_mov_b64 exec, -1
    s_mov_b32 s69, 400000
wc_40:
    ds_read_b32 v6, v4 offset:4
    s_waitcnt lgkmcnt(0)
    v_readfirstlane_b32 s8, v6
    s_sub_u32 s69, s69, 1
    s_cmp_ge_u32 s8, 4
    s_cbranch_scc1 wc_40_d
    s_sleep 1
    s_cmp_lg_u32 s69, 0
    s_cbranch_scc1 wc_40
wc_40_d:
    s_setprio 3
    s_xor_b32 s8, s35, 1
    s_lshl_b32 s8, s8, 11
    s_add_u32 s8, s8, 118784
    v_add_u32 v6, s8, v3
    ds_read_b128 v[208:211], v6 offset:0
    ds_read_b128 v[212:215], v6 offset:1024
    s_waitcnt lgkmcnt(0)
    v_mfma_f32_32x32x16_bf16 v[184:199], v[208:211], v[136:139], v[184:199]
    v_mfma_f32_32x32x16_bf16 v[184:199], v[212:215], v[140:143], v[184:199]
    v_and_b32 v128, 3, v1
    v_lshlrev_b32 v128, 2, v128
    v_lshrrev_b32 v128, v128, s92
    s_lshl_b32 s8, s91, 6
    s_add_u32 s8, s8, s67
    s_lshl_b32 s8, s8, 12
    s_lshl_b32 s9, s68, 6
    s_add_u32 s8, s8, s9
    s_add_u32 s8, s8, 6291456
    s_add_u32 s9, s12, 126976
    v_lshlrev_b32 v6, 6, v8
    v_lshl_add_u32 v6, v9, 5, v6
    v_add_u32 v6, s9, v6
    v_add_u32 v7, s9, v3
    v_lshrrev_b32 v11, 2, v1
    v_lshlrev_b32 v11, 7, v11
    v_and_b32 v12, 3, v1
    v_lshl_add_u32 v11, v12, 4, v11
    v_cvt_pk_bf16_f32 v200, v184, v185
    v_cvt_pk_bf16_f32 v201, v186, v187
    v_cvt_pk_bf16_f32 v202, v188, v189
    v_cvt_pk_bf16_f32 v203, v190, v191
    v_cvt_pk_bf16_f32 v204, v192, v193
    v_cvt_pk_bf16_f32 v205, v194, v195
    v_cvt_pk_bf16_f32 v206, v196, v197
    v_cvt_pk_bf16_f32 v207, v198, v199
    ds_write_b128 v6, v[200:203] offset:0
    ds_write_b128 v6, v[204:207] offset:16
    ds_read_b128 v[208:211], v7 offset:0
    ds_read_b128 v[212:215], v7 offset:1024
    s_waitcnt lgkmcnt(0)
    v_bfi_b32 v208, s93, v128, v208
    v_bfi_b32 v212, s93, v128, v212
    s_mov_b32 s10, s8
    buffer_store_dwordx4 v[208:211], v11, s[44:47], s10 offen offset:0 sc1
    buffer_store_dwordx4 v[212:215], v11, s[44:47], s10 offen offset:2048 sc1
    v_lshrrev_b32 v6, 2, v1
    s_lshl_b32 s8, s35, 4
    v_add_u32 v6, s8, v6
    v_lshlrev_b32 v6, 5, v6
    v_add_u32 v6, s62, v6
    v_mul_u32_u24 v6, 450, v6
    v_and_b32 v7, 3, v1
    v_lshlrev_b32 v7, 4, v7
    s_mul_i32 s9, s89, 56
    v_add3_u32 v10, v6, v7, s9
    s_mov_b32 s56, s18
    s_mov_b32 s57, s19
    s_mov_b32 s58, 921602
    s_mov_b32 s59, 0x20000
    s_mov_b32 s52, s20
    s_mov_b32 s53, s21
    s_mov_b32 s54, 921602
    s_mov_b32 s55, 0x20000
    s_setprio 3
    v_and_b32 v14, 15, v1
    v_lshrrev_b32 v15, 4, v1
    s_lshl_b32 s6, s89, 18
    s_lshl_b32 s7, s62, 7
    s_add_u32 s6, s6, s7
    s_lshl_b32 s7, s35, 16
    s_add_u32 s6, s6, s7
    s_add_u32 s6, s6, 6291456
    v_bfe_u32 v6, v1, 1, 2
    v_bfe_u32 v7, v1, 4, 2
    v_xor_b32 v6, v6, v7
    v_and_b32 v7, 1, v1
    v_lshl_add_u32 v6, v6, 1, v7
    v_lshrrev_b32 v7, 3, v1
    v_lshlrev_b32 v7, 12, v7
    v_lshl_add_u32 v82, v6, 4, v7
    v_and_b32 v6, 3, v6
    v_lshlrev_b32 v6, 2, v6
    v_lshrrev_b32 v136, v6, s92
    v_lshrrev_b32 v6, 2, v1
    v_and_b32 v7, 3, v1
    v_lshlrev_b32 v7, 3, v7
    v_lshl_add_u32 v80, v6, 6, v7
    v_add_u32 v80, 118784, v80
    v_lshl_add_u32 v7, v6, 7, v7
    v_add_u32 v7, 135168, v7
    v_bfe_u32 v6, v1, 3, 2
    v_xor_b32 v11, 0, v6
    v_lshl_add_u32 v76, v11, 5, v7
    v_xor_b32 v11, 1, v6
    v_lshl_add_u32 v77, v11, 5, v7
    v_xor_b32 v11, 2, v6
    v_lshl_add_u32 v78, v11, 5, v7
    v_xor_b32 v11, 3, v6
    v_lshl_add_u32 v79, v11, 5, v7
    s_lshl_b32 s8, s35, 10
    s_add_u32 s8, s8, 118784
    v_lshlrev_b32 v6, 6, v14
    v_lshl_add_u32 v6, v15, 3, v6
    v_add_u32 v81, s8, v6
    s_add_u32 s8, s12, 147456
    v_add_u32 v6, s8, v6
    v_mov_b32 v12, v6
    s_lshl_b32 s10, s86, 7
    s_lshl_b32 s11, s4, 2
    s_add_u32 s10, s10, s11
    s_add_u32 s10, s10, s35
    s_lshl_b32 s10, s10, 11
    s_and_b32 s11, s61, 1
    s_mul_i32 s11, s11, 2097152
    s_add_u32 s10, s10, s11
    s_add_u32 s11, s10, 131072
    s_lshl_b32 s13, s35, 12
    s_add_u32 s13, s13, 16384
    v_add_u32 v13, s13, v3
    s_mov_b32 s9, 0x12492493
    s_mov_b32 s8, s90
    s_mul_i32 s8, s8, 224
    v_mul_hi_u32 v7, v1, s9
    v_mul_u32_u24 v6, 14, v7
    v_sub_u32 v6, v1, v6
    v_mul_u32_u24 v7, 896, v7
    v_lshl_add_u32 v7, v6, 4, v7
    v_add_u32 v140, s8, v7
    s_add_u32 s8, s12, 135168
    v_lshlrev_b32 v6, 7, v14
    v_lshl_add_u32 v6, v15, 3, v6
    v_add_u32 v83, s8, v6
    v_add_u32 v84, s8, v3
    s_lshl_b32 s9, s62, 5
    s_and_b32 s9, s9, 64
    v_and_b32 v11, 7, v1
    v_lshlrev_b32 v11, 4, v11
    v_xor_b32 v11, s9, v11
    v_lshrrev_b32 v6, 3, v1
    v_lshl_add_u32 v85, v6, 15, v11
    v_bfe_u32 v6, v1, 2, 2
    v_lshl_add_u32 v6, v9, 3, v6
    v_lshlrev_b32 v6, 7, v6
    v_bfe_u32 v7, v1, 3, 1
    v_xor_b32 v7, s68, v7
    v_lshl_add_u32 v14, v7, 6, v6
    v_xor_b32 v15, 64, v14
    v_bfe_u32 v6, v1, 4, 1
    v_lshlrev_b32 v6, 2, v6
    v_and_b32 v7, 1, v1
    v_lshl_add_u32 v6, v7, 1, v6
    v_bfe_u32 v7, v1, 1, 1
    v_add_u32 v11, v6, v7
    v_lshl_add_u32 v142, v11, 3, v14
    v_lshl_add_u32 v143, v11, 3, v15
    s_lshl_b32 s8, s35, 13
    v_add_u32 v137, s8, v3
    s_mov_b32 s8, 114688
    v_mul_lo_u32 v6, v8, s8
    v_lshlrev_b32 v7, 5, v9
    v_add_u32 v129, v6, v7
    v_sub_u32 v130, v6, v7
    v_add_u32 v130, 32, v130
    s_add_u32 s8, s12, 151552
    v_add_u32 v131, s8, v3
    v_xor_b32 v141, 2048, v131
    s_add_u32 s8, s12, 135168
    v_add_u32 v86, s8, v3
    v_mov_b32 v124, 0
    v_mov_b32 v125, 0
    v_mov_b32 v126, 0
    v_mov_b32 v127, 0
    s_mov_b32 s69, 400000
wc_41:
    ds_read_b32 v6, v4 offset:64
    s_waitcnt lgkmcnt(0)
    v_readfirstlane_b32 s8, v6
    s_sub_u32 s69, s69, 1
    s_cmp_ge_u32 s8, 4
    s_cbranch_scc1 wc_41_d
    s_sleep 1
    s_cmp_lg_u32 s69, 0
    s_cbranch_scc1 wc_41
wc_41_d:
    ds_read_b128 v[200:203], v13 offset:0
    ds_read_b128 v[204:207], v13 offset:1024
    ds_read_b128 v[208:211], v13 offset:2048
    ds_read_b128 v[212:215], v13 offset:3072
    s_mov_b32 s87, s10
    s_mov_b32 s88, s11
    s_waitcnt lgkmcnt(3)
    buffer_store_dwordx4 v[200:203], v3, s[44:47], s87 offen offset:0 sc1
    s_waitcnt lgkmcnt(2)
    buffer_store_dwordx4 v[204:207], v3, s[44:47], s87 offen offset:1024 sc1
    s_waitcnt lgkmcnt(1)
    s_mov_b32 s69, 400000
wc_43:
    ds_read_b32 v6, v4 offset:96
    s_waitcnt lgkmcnt(0)
    v_readfirstlane_b32 s8, v6
    s_sub_u32 s69, s69, 1
    s_cmp_ge_u32 s8, 4
    s_cbranch_scc1 wc_43_d
    s_sleep 2
    s_cmp_lg_u32 s69, 0
    s_cbranch_scc1 wc_43
wc_43_d:
agk_42:
    buffer_store_dwordx4 v[208:211], v3, s[44:47], s88 offen offset:0 sc1
    s_waitcnt lgkmcnt(0)
    buffer_store_dwordx4 v[212:215], v3, s[44:47], s88 offen offset:1024 sc1
    s_waitcnt lgkmcnt(0)
    s_mov_b32 s69, 400000
wc_44:
    ds_read_b32 v6, v4 offset:72
    s_waitcnt lgkmcnt(0)
    v_readfirstlane_b32 s8, v6
    s_sub_u32 s69, s69, 1
    s_cmp_ge_u32 s8, 4
    s_cbranch_scc1 wc_44_d
    s_sleep 2
    s_cmp_lg_u32 s69, 0
    s_cbranch_scc1 wc_44
wc_44_d:
    s_setprio 3
    s_add_u32 s8, s12, 135168
    s_add_u32 s9, s6, 32768
    s_mov_b32 s14, 20000
a_ypoll:
    s_mov_b32 m0, s8
    s_nop 0
    buffer_load_dwordx4 v82, s[44:47], s6 offen sc1 lds
    s_add_u32 m0, s8, 1024
    s_nop 0
    buffer_load_dwordx4 v82, s[44:47], s9 offen sc1 lds
    s_waitcnt vmcnt(0)
    ds_read_b32 v168, v86 offset:0
    ds_read_b32 v172, v86 offset:1024
    s_waitcnt lgkmcnt(0)
    v_bitop3_b32 v132, v168, v172, v136 bitop3:0x7e
    v_and_b32 v132, s93, v132
    v_cmp_ne_u32 vcc, 0, v132
    s_cbranch_vccz a_ypoll_d
    s_sleep 4
    s_sub_u32 s14, s14, 1
    s_cmp_lg_u32 s14, 0
    s_cbranch_scc1 a_ypoll
a_ypoll_d:
    s_mov_b64 exec, 1
    ds_add_u32 v4, v5 offset:12
    s_mov_b64 exec, -1
    s_add_u32 m0, s12, 147456
    s_nop 0
    buffer_load_dwordx4 v10, s[56:59], 0 offen lds
    s_add_u32 m0, s12, 148480
    s_nop 0
    buffer_load_dwordx4 v10, s[52:55], 0 offen lds
    s_mov_b32 s69, 400000
wc_45:
    ds_read_b32 v6, v4 offset:12
    s_waitcnt lgkmcnt(0)
    v_readfirstlane_b32 s8, v6
    s_sub_u32 s69, s69, 1
    s_cmp_ge_u32 s8, 4
    s_cbranch_scc1 wc_45_d
    s_sleep 1
    s_cmp_lg_u32 s69, 0
    s_cbranch_scc1 wc_45
wc_45_d:
    ds_read_b64_tr_b16 v[168:169], v76 offset:0
    ds_read_b64_tr_b16 v[170:171], v76 offset:2048
    ds_read_b64_tr_b16 v[176:177], v77 offset:0
    ds_read_b64_tr_b16 v[178:179], v77 offset:2048
    ds_read_b64_tr_b16 v[184:185], v78 offset:0
    ds_read_b64_tr_b16 v[186:187], v78 offset:2048
    s_waitcnt lgkmcnt(4)
    v_mfma_f32_16x16x32_bf16 v[200:203], v[168:171], v[216:219], 0
    v_mfma_f32_16x16x32_bf16 v[208:211], v[168:171], v[160:163], 0
    ds_read_b64_tr_b16 v[192:193], v79 offset:0
    ds_read_b64_tr_b16 v[194:195], v79 offset:2048
    s_waitcnt lgkmcnt(4)
    v_mfma_f32_16x16x32_bf16 v[204:207], v[176:179], v[216:219], 0
    v_mfma_f32_16x16x32_bf16 v[212:215], v[176:179], v[160:163], 0
    ds_read_b64_tr_b16 v[172:173], v76 offset:4096
    ds_read_b64_tr_b16 v[174:175], v76 offset:6144
    s_waitcnt lgkmcnt(4)
    v_mfma_f32_16x16x32_bf16 v[208:211], v[184:187], v[216:219], v[208:211]
    v_mfma_f32_16x16x32_bf16 v[200:203], v[184:187], v[224:227], v[200:203]
    ds_read_b64_tr_b16 v[180:181], v77 offset:4096
    ds_read_b64_tr_b16 v[182:183], v77 offset:6144
    s_waitcnt lgkmcnt(4)
    v_mfma_f32_16x16x32_bf16 v[212:215], v[192:195], v[216:219], v[212:215]
    v_mfma_f32_16x16x32_bf16 v[204:207], v[192:195], v[224:227], v[204:207]
    ds_read_b64_tr_b16 v[188:189], v78 offset:4096
    ds_read_b64_tr_b16 v[190:191], v78 offset:6144
    s_waitcnt lgkmcnt(4)
    v_mfma_f32_16x16x32_bf16 v[200:203], v[172:175], v[220:223], v[200:203]
    v_mfma_f32_16x16x32_bf16 v[208:211], v[172:175], v[164:167], v[208:211]
    ds_read_b64_tr_b16 v[196:197], v79 offset:4096
    ds_read_b64_tr_b16 v[198:199], v79 offset:6144
    s_waitcnt lgkmcnt(4)
    v_mfma_f32_16x16x32_bf16 v[204:207], v[180:183], v[220:223], v[204:207]
    v_mfma_f32_16x16x32_bf16 v[212:215], v[180:183], v[164:167], v[212:215]
    s_waitcnt lgkmcnt(2)
    v_mfma_f32_16x16x32_bf16 v[208:211], v[188:191], v[220:223], v[208:211]
    v_mfma_f32_16x16x32_bf16 v[200:203], v[188:191], v[228:231], v[200:203]
    s_waitcnt lgkmcnt(0)
    v_mfma_f32_16x16x32_bf16 v[212:215], v[196:199], v[220:223], v[212:215]
    v_mfma_f32_16x16x32_bf16 v[204:207], v[196:199], v[228:231], v[204:207]
    s_waitcnt vmcnt(0)
    ds_read_b64 v[232:233], v12 offset:0
    ds_read_b64 v[234:235], v12 offset:32
    ds_read_b64 v[236:237], v12 offset:1024
    ds_read_b64 v[238:239], v12 offset:1056
    s_waitcnt lgkmcnt(0)
    v_lshlrev_b32 v240, 16, v232
    v_and_b32 v241, 0xffff0000, v232
    v_lshlrev_b32 v242, 16, v233
    v_and_b32 v243, 0xffff0000, v233
    v_lshlrev_b32 v244, 16, v234
    v_and_b32 v245, 0xffff0000, v234
    v_lshlrev_b32 v246, 16, v235
    v_and_b32 v247, 0xffff0000, v235
    v_lshlrev_b32 v248, 16, v236
    v_and_b32 v249, 0xffff0000, v236
    v_lshlrev_b32 v250, 16, v237
    v_and_b32 v251, 0xffff0000, v237
    v_lshlrev_b32 v252, 16, v238
    v_and_b32 v253, 0xffff0000, v238
    v_lshlrev_b32 v254, 16, v239
    v_and_b32 v255, 0xffff0000, v239
    s_cmp_lg_u32 s89, 0
    s_cbranch_scc1 a_w1
    s_mov_b64 exec, 0xffff
    v_mul_f32 v240, 0.5, v240
    v_mul_f32 v248, 0.5, v248
    s_mov_b64 exec, -1
a_w1:
    s_cmp_lg_u32 s89, 7
    s_cbranch_scc1 a_w2
    s_mov_b32 exec_lo, 0
    s_mov_b32 exec_hi, 0xffff0000
    v_mul_f32 v244, 0.5, v244
    v_mul_f32 v252, 0.5, v252
    s_mov_b64 exec, -1
a_w2:
    v_pk_mul_f32 v[168:169], v[208:209], v[248:249]
    v_pk_mul_f32 v[170:171], v[200:201], v[248:249]
    v_pk_fma_f32 v[200:201], v[200:201], v[240:241], v[168:169] neg_lo:[0,0,1] neg_hi:[0,0,1]
    v_pk_fma_f32 v[208:209], v[208:209], v[240:241], v[170:171]
    v_pk_mul_f32 v[172:173], v[210:211], v[250:251]
    v_pk_mul_f32 v[174:175], v[202:203], v[250:251]
    v_pk_fma_f32 v[202:203], v[202:203], v[242:243], v[172:173] neg_lo:[0,0,1] neg_hi:[0,0,1]
    v_pk_fma_f32 v[210:211], v[210:211], v[242:243], v[174:175]
    v_pk_mul_f32 v[176:177], v[212:213], v[252:253]
    v_pk_mul_f32 v[178:179], v[204:205], v[252:253]
    v_pk_fma_f32 v[204:205], v[204:205], v[244:245], v[176:177] neg_lo:[0,0,1] neg_hi:[0,0,1]
    v_pk_fma_f32 v[212:213], v[212:213], v[244:245], v[178:179]
    v_pk_mul_f32 v[180:181], v[214:215], v[254:255]
    v_pk_mul_f32 v[182:183], v[206:207], v[254:255]
    v_pk_fma_f32 v[206:207], v[206:207], v[246:247], v[180:181] neg_lo:[0,0,1] neg_hi:[0,0,1]
    v_pk_fma_f32 v[214:215], v[214:215], v[246:247], v[182:183]
    v_cvt_pk_bf16_f32 v240, v200, v201
    v_cvt_pk_bf16_f32 v241, v202, v203
    v_cvt_pk_bf16_f32 v242, v204, v205
    v_cvt_pk_bf16_f32 v243, v206, v207
    v_cvt_pk_bf16_f32 v244, v208, v209
    v_cvt_pk_bf16_f32 v245, v210, v211
    v_cvt_pk_bf16_f32 v246, v212, v213
    v_cvt_pk_bf16_f32 v247, v214, v215
    ds_write_b64 v81, v[240:241] offset:0
    ds_write_b64 v81, v[242:243] offset:32
    ds_write_b64 v81, v[244:245] offset:4096
    ds_write_b64 v81, v[246:247] offset:4128
    s_waitcnt lgkmcnt(0)
    s_mov_b64 exec, 1
    ds_add_u32 v4, v5 offset:16
    s_mov_b64 exec, -1
    s_mov_b32 s69, 400000
wc_46:
    ds_read_b32 v6, v4 offset:16
    s_waitcnt lgkmcnt(0)
    v_readfirstlane_b32 s8, v6
    s_sub_u32 s69, s69, 1
    s_cmp_ge_u32 s8, 4
    s_cbranch_scc1 wc_46_d
    s_sleep 1
    s_cmp_lg_u32 s69, 0
    s_cbranch_scc1 wc_46
wc_46_d:
    ds_read_b64_tr_b16 v[168:169], v80 offset:0
    ds_read_b64_tr_b16 v[170:171], v80 offset:1024
    ds_read_b64_tr_b16 v[176:177], v80 offset:32
    ds_read_b64_tr_b16 v[178:179], v80 offset:1056
    ds_read_b64_tr_b16 v[184:185], v80 offset:4096
    ds_read_b64_tr_b16 v[186:187], v80 offset:5120
    s_waitcnt lgkmcnt(4)
    v_mfma_f32_16x16x32_bf16 v[200:203], v[168:171], v[216:219], 0
    v_mfma_f32_16x16x32_bf16 v[208:211], v[168:171], v[224:227], 0
    ds_read_b64_tr_b16 v[192:193], v80 offset:4128
    ds_read_b64_tr_b16 v[194:195], v80 offset:5152
    s_waitcnt lgkmcnt(4)
    v_mfma_f32_16x16x32_bf16 v[204:207], v[176:179], v[216:219], 0
    v_mfma_f32_16x16x32_bf16 v[212:215], v[176:179], v[224:227], 0
    ds_read_b64_tr_b16 v[172:173], v80 offset:2048
    ds_read_b64_tr_b16 v[174:175], v80 offset:3072
    s_waitcnt lgkmcnt(4)
    v_mfma_f32_16x16x32_bf16 v[208:211], v[184:187], v[216:219], v[208:211]
    v_mfma_f32_16x16x32_bf16 v[200:203], v[184:187], v[160:163], v[200:203]
    ds_read_b64_tr_b16 v[180:181], v80 offset:2080
    ds_read_b64_tr_b16 v[182:183], v80 offset:3104
    s_waitcnt lgkmcnt(4)
    v_mfma_f32_16x16x32_bf16 v[212:215], v[192:195], v[216:219], v[212:215]
    v_mfma_f32_16x16x32_bf16 v[204:207], v[192:195], v[160:163], v[204:207]
    ds_read_b64_tr_b16 v[188:189], v80 offset:6144
    ds_read_b64_tr_b16 v[190:191], v80 offset:7168
    s_waitcnt lgkmcnt(4)
    v_mfma_f32_16x16x32_bf16 v[200:203], v[172:175], v[220:223], v[200:203]
    v_mfma_f32_16x16x32_bf16 v[208:211], v[172:175], v[228:231], v[208:211]
    ds_read_b64_tr_b16 v[196:197], v80 offset:6176
    ds_read_b64_tr_b16 v[198:199], v80 offset:7200
    s_waitcnt lgkmcnt(4)
    v_mfma_f32_16x16x32_bf16 v[204:207], v[180:183], v[220:223], v[204:207]
    v_mfma_f32_16x16x32_bf16 v[212:215], v[180:183], v[228:231], v[212:215]
    s_waitcnt lgkmcnt(2)
    v_mfma_f32_16x16x32_bf16 v[208:211], v[188:191], v[220:223], v[208:211]
    v_mfma_f32_16x16x32_bf16 v[200:203], v[188:191], v[164:167], v[200:203]
    s_waitcnt lgkmcnt(0)
    v_mfma_f32_16x16x32_bf16 v[212:215], v[196:199], v[220:223], v[212:215]
    v_mfma_f32_16x16x32_bf16 v[204:207], v[196:199], v[164:167], v[204:207]
    s_nop 3
    s_lshl_b32 s6, s89, 12
    s_lshl_b32 s7, s62, 7
    s_add_u32 s6, s6, s7
    s_lshl_b32 s7, s35, 19
    s_add_u32 s6, s6, s7
    s_add_u32 s6, s6, 8388608
    s_add_u32 s7, s6, 262144
    v_cvt_pk_bf16_f32 v240, v200, v201
    v_cvt_pk_bf16_f32 v241, v202, v203
    v_cvt_pk_bf16_f32 v242, v204, v205
    v_cvt_pk_bf16_f32 v243, v206, v207
    v_cvt_pk_bf16_f32 v244, v208, v209
    v_cvt_pk_bf16_f32 v245, v210, v211
    v_cvt_pk_bf16_f32 v246, v212, v213
    v_cvt_pk_bf16_f32 v247, v214, v215
    ds_write_b64 v83, v[240:241] offset:0
    ds_write_b64 v83, v[242:243] offset:32
    ds_write_b64 v83, v[244:245] offset:64
    ds_write_b64 v83, v[246:247] offset:96
    ds_read_b128 v[248:251], v84 offset:0
    ds_read_b128 v[252:255], v84 offset:1024
    s_waitcnt lgkmcnt(0)
    v_bfi_b32 v248, s93, v128, v248
    v_bfi_b32 v252, s93, v128, v252
    buffer_store_dwordx4 v[248:251], v85, s[44:47], s6 offen sc1
    buffer_store_dwordx4 v[252:255], v85, s[44:47], s7 offen sc1
    s_mov_b64 exec, 1
    ds_add_u32 v4, v5 offset:20
    s_mov_b64 exec, -1
    s_lshl_b32 s6, s67, 15
    s_lshl_b32 s7, s35, 13
    s_add_u32 s6, s6, s7
    s_add_u32 s6, s6, 8388608
    s_add_u32 s7, s7, 0
    s_lshr_b32 s15, s61, 3
    s_lshl_b32 s15, s15, 11
    s_setprio 3
    s_mov_b32 s69, 400000
wc_47:
    ds_read_b32 v6, v4 offset:20
    s_waitcnt lgkmcnt(0)
    v_readfirstlane_b32 s8, v6
    s_sub_u32 s69, s69, 1
    s_cmp_ge_u32 s8, 4
    s_cbranch_scc1 wc_47_d
    s_sleep 1
    s_cmp_lg_u32 s69, 0
    s_cbranch_scc1 wc_47
wc_47_d:
    s_mov_b32 s69, 400000
wc_48:
    ds_read_b32 v6, v4 offset:60
    s_waitcnt lgkmcnt(0)
    v_readfirstlane_b32 s8, v6
    s_sub_u32 s69, s69, 1
    s_cmp_ge_u32 s8, 4
    s_cbranch_scc1 wc_48_d
    s_sleep 1
    s_cmp_lg_u32 s69, 0
    s_cbranch_scc1 wc_48
wc_48_d:
    s_mov_b32 s69, 400000
wc_49:
    ds_read_b32 v6, v4 offset:72
    s_waitcnt lgkmcnt(0)
    v_readfirstlane_b32 s8, v6
    s_sub_u32 s69, s69, 1
    s_cmp_ge_u32 s8, 4
    s_cbranch_scc1 wc_49_d
    s_sleep 1
    s_cmp_lg_u32 s69, 0
    s_cbranch_scc1 wc_49
wc_49_d:
    s_lshr_b32 s10, s61, 2
    s_mul_i32 s10, s10, 18
    s_lshr_b32 s10, s10, 3
    s_add_u32 s10, s10, 10
    s_lshl_b32 s10, s10, 2
    s_add_u32 s10, s10, s35
    s_mul_i32 s10, s10, 896
    s_add_u32 m0, s10, 0
    s_lshl_b32 s13, s10, 2
    buffer_load_dwordx4 v140, s[40:43], s13 offen lds
    s_add_u32 s10, s10, 3584
    s_sub_u32 s11, s10, 64512
    s_cmp_ge_u32 s10, 100352
    s_cselect_b32 s10, s11, s10
    s_add_u32 m0, s10, 0
    s_lshl_b32 s13, s10, 2
    buffer_load_dwordx4 v140, s[40:43], s13 offen lds
    s_add_u32 s10, s10, 3584
    s_sub_u32 s11, s10, 64512
    s_cmp_ge_u32 s10, 100352
    s_cselect_b32 s10, s11, s10
    s_add_u32 m0, s10, 0
    s_lshl_b32 s13, s10, 2
    buffer_load_dwordx4 v140, s[40:43], s13 offen lds
    s_add_u32 s10, s10, 3584
    s_sub_u32 s11, s10, 64512
    s_cmp_ge_u32 s10, 100352
    s_cselect_b32 s10, s11, s10
    s_add_u32 m0, s10, 0
    s_lshl_b32 s13, s10, 2
    buffer_load_dwordx4 v140, s[40:43], s13 offen lds
    s_add_u32 s10, s10, 3584
    s_sub_u32 s11, s10, 64512
    s_cmp_ge_u32 s10, 100352
    s_cselect_b32 s10, s11, s10
    s_add_u32 m0, s10, 0
    s_lshl_b32 s13, s10, 2
    s_waitcnt vmcnt(3)
    buffer_load_dwordx4 v140, s[40:43], s13 offen lds
    s_add_u32 s10, s10, 3584
    s_sub_u32 s11, s10, 64512
    s_cmp_ge_u32 s10, 100352
    s_cselect_b32 s10, s11, s10
    s_add_u32 m0, s10, 0
    s_lshl_b32 s13, s10, 2
    s_waitcnt vmcnt(3)
    buffer_load_dwordx4 v140, s[40:43], s13 offen lds
    s_add_u32 s10, s10, 3584
    s_sub_u32 s11, s10, 64512
    s_cmp_ge_u32 s10, 100352
    s_cselect_b32 s10, s11, s10
    s_add_u32 m0, s10, 0
    s_lshl_b32 s13, s10, 2
    s_waitcnt vmcnt(3)
    buffer_load_dwordx4 v140, s[40:43], s13 offen lds
    s_add_u32 s10, s10, 3584
    s_sub_u32 s11, s10, 64512
    s_cmp_ge_u32 s10, 100352
    s_cselect_b32 s10, s11, s10
    s_add_u32 m0, s10, 0
    s_lshl_b32 s13, s10, 2
    s_waitcnt vmcnt(3)
    buffer_load_dwordx4 v140, s[40:43], s13 offen lds
    s_add_u32 s10, s10, 3584
    s_sub_u32 s11, s10, 64512
    s_cmp_ge_u32 s10, 100352
    s_cselect_b32 s10, s11, s10
    s_add_u32 m0, s10, 0
    s_lshl_b32 s13, s10, 2
    s_waitcnt vmcnt(3)
    buffer_load_dwordx4 v140, s[40:43], s13 offen lds
    s_add_u32 s10, s10, 3584
    s_sub_u32 s11, s10, 64512
    s_cmp_ge_u32 s10, 100352
    s_cselect_b32 s10, s11, s10
    s_add_u32 m0, s10, 0
    s_lshl_b32 s13, s10, 2
    s_waitcnt vmcnt(3)
    buffer_load_dwordx4 v140, s[40:43], s13 offen lds
    s_add_u32 s10, s10, 3584
    s_sub_u32 s11, s10, 64512
    s_cmp_ge_u32 s10, 100352
    s_cselect_b32 s10, s11, s10
    s_add_u32 m0, s10, 0
    s_lshl_b32 s13, s10, 2
    s_waitcnt vmcnt(3)
    buffer_load_dwordx4 v140, s[40:43], s13 offen lds
    s_add_u32 s10, s10, 3584
    s_sub_u32 s11, s10, 64512
    s_cmp_ge_u32 s10, 100352
    s_cselect_b32 s10, s11, s10
    s_add_u32 m0, s10, 0
    s_lshl_b32 s13, s10, 2
    s_waitcnt vmcnt(3)
    buffer_load_dwordx4 v140, s[40:43], s13 offen lds
    s_add_u32 s10, s10, 3584
    s_sub_u32 s11, s10, 64512
    s_cmp_ge_u32 s10, 100352
    s_cselect_b32 s10, s11, s10
    s_add_u32 m0, s10, 0
    s_lshl_b32 s13, s10, 2
    s_waitcnt vmcnt(3)
    buffer_load_dwordx4 v140, s[40:43], s13 offen lds
    s_add_u32 s10, s10, 3584
    s_sub_u32 s11, s10, 64512
    s_cmp_ge_u32 s10, 100352
    s_cselect_b32 s10, s11, s10
    s_add_u32 m0, s10, 0
    s_lshl_b32 s13, s10, 2
    s_waitcnt vmcnt(3)
    buffer_load_dwordx4 v140, s[40:43], s13 offen lds
    s_add_u32 s10, s10, 3584
    s_sub_u32 s11, s10, 64512
    s_cmp_ge_u32 s10, 100352
    s_cselect_b32 s10, s11, s10
    s_add_u32 m0, s10, 0
    s_lshl_b32 s13, s10, 2
    s_waitcnt vmcnt(3)
    buffer_load_dwordx4 v140, s[40:43], s13 offen lds
    s_add_u32 s10, s10, 3584
    s_sub_u32 s11, s10, 64512
    s_cmp_ge_u32 s10, 100352
    s_cselect_b32 s10, s11, s10
    s_add_u32 m0, s10, 0
    s_lshl_b32 s13, s10, 2
    s_waitcnt vmcnt(3)
    buffer_load_dwordx4 v140, s[40:43], s13 offen lds
    s_add_u32 s10, s10, 3584
    s_sub_u32 s11, s10, 64512
    s_cmp_ge_u32 s10, 100352
    s_cselect_b32 s10, s11, s10
    s_add_u32 m0, s10, 0
    s_lshl_b32 s13, s10, 2
    s_waitcnt vmcnt(3)
    buffer_load_dwordx4 v140, s[40:43], s13 offen lds
    s_add_u32 s10, s10, 3584
    s_sub_u32 s11, s10, 64512
    s_cmp_ge_u32 s10, 100352
    s_cselect_b32 s10, s11, s10
    s_add_u32 m0, s10, 0
    s_lshl_b32 s13, s10, 2
    s_waitcnt vmcnt(3)
    buffer_load_dwordx4 v140, s[40:43], s13 offen lds
    s_mov_b32 m0, 100352
    s_mov_b32 s13, 401408
    buffer_load_dwordx4 v140, s[40:43], s13 offen lds
    s_mov_b64 exec, 1
    ds_add_u32 v4, v5 offset:68
    s_mov_b64 exec, -1
    s_add_u32 s8, s15, 0
    s_and_b32 s8, s8, 8191
    s_add_u32 m0, s7, s8
    s_add_u32 s8, s8, s6
    buffer_load_dwordx4 v3, s[44:47], s8 offen  lds
    s_add_u32 s8, s15, 1024
    s_and_b32 s8, s8, 8191
    s_add_u32 m0, s7, s8
    s_add_u32 s8, s8, s6
    buffer_load_dwordx4 v3, s[44:47], s8 offen  lds
    s_add_u32 s8, s15, 2048
    s_and_b32 s8, s8, 8191
    s_add_u32 m0, s7, s8
    s_add_u32 s8, s8, s6
    buffer_load_dwordx4 v3, s[44:47], s8 offen  lds
    s_add_u32 s8, s15, 3072
    s_and_b32 s8, s8, 8191
    s_add_u32 m0, s7, s8
    s_add_u32 s8, s8, s6
    buffer_load_dwordx4 v3, s[44:47], s8 offen  lds
    s_add_u32 s8, s15, 4096
    s_and_b32 s8, s8, 8191
    s_add_u32 m0, s7, s8
    s_add_u32 s8, s8, s6
    buffer_load_dwordx4 v3, s[44:47], s8 offen  lds
    s_add_u32 s8, s15, 5120
    s_and_b32 s8, s8, 8191
    s_add_u32 m0, s7, s8
    s_add_u32 s8, s8, s6
    buffer_load_dwordx4 v3, s[44:47], s8 offen  lds
    s_add_u32 s8, s15, 6144
    s_and_b32 s8, s8, 8191
    s_add_u32 m0, s7, s8
    s_add_u32 s8, s8, s6
    buffer_load_dwordx4 v3, s[44:47], s8 offen  lds
    s_add_u32 s8, s15, 7168
    s_and_b32 s8, s8, 8191
    s_add_u32 m0, s7, s8
    s_add_u32 s8, s8, s6
    buffer_load_dwordx4 v3, s[44:47], s8 offen  lds
    s_mov_b32 s14, 20000
    s_waitcnt vmcnt(0)
a_tchk0:
    ds_read_b32 v160, v137 offset:0
    ds_read_b32 v164, v137 offset:1024
    ds_read_b32 v168, v137 offset:2048
    ds_read_b32 v172, v137 offset:3072
    ds_read_b32 v176, v137 offset:4096
    ds_read_b32 v180, v137 offset:5120
    ds_read_b32 v184, v137 offset:6144
    ds_read_b32 v188, v137 offset:7168
    s_waitcnt lgkmcnt(0)
    v_bitop3_b32 v132, v160, v164, v128 bitop3:0x7e
    v_bitop3_b32 v133, v168, v172, v128 bitop3:0x7e
    v_bitop3_b32 v134, v176, v180, v128 bitop3:0x7e
    v_bitop3_b32 v135, v184, v188, v128 bitop3:0x7e
    v_or3_b32 v132, v132, v133, v134
    v_bitop3_b32 v132, v132, s93, v135 bitop3:0xc8
    v_cmp_ne_u32 vcc, 0, v132
    s_cbranch_vccnz a_tchk0_r
a_tchk0_d:
    s_mov_b64 exec, 1
    ds_add_u32 v4, v5 offset:8
    s_mov_b64 exec, -1
    s_mov_b32 s69, 400000
wc_50:
    ds_read_b32 v6, v4 offset:8
    s_waitcnt lgkmcnt(0)
    v_readfirstlane_b32 s8, v6
    s_sub_u32 s69, s69, 1
    s_cmp_ge_u32 s8, 4
    s_cbranch_scc1 wc_50_d
    s_sleep 1
    s_cmp_lg_u32 s69, 0
    s_cbranch_scc1 wc_50
wc_50_d:
    s_mov_b32 s10, 4040
    s_mov_b32 s11, 4040
    s_setprio 0
    ds_read_b64_tr_b16 v[240:241], v14 offset:28728
    ds_read_b64_tr_b16 v[242:243], v14 offset:29240
    ds_read_b64_tr_b16 v[244:245], v14 offset:30776
    ds_read_b64_tr_b16 v[246:247], v14 offset:31288
    ds_read_b64_tr_b16 v[248:249], v15 offset:28728
    ds_read_b64_tr_b16 v[250:251], v15 offset:29240
    ds_read_b64_tr_b16 v[252:253], v15 offset:30776
    ds_read_b64_tr_b16 v[254:255], v15 offset:31288
    s_setprio 3
    s_mov_b32 exec_lo, 0x88880000
    s_mov_b32 exec_hi, 0x88880000
    v_lshl_add_u64 v[142:143], v[142:143], 0, s[10:11]
    s_mov_b64 exec, -1
    s_setprio 0
    ds_read_b64_tr_b16 v[76:77], v142 offset:0
    ds_read_b64_tr_b16 v[78:79], v142 offset:512
    ds_read_b64_tr_b16 v[80:81], v142 offset:2048
    ds_read_b64_tr_b16 v[82:83], v142 offset:2560
    ds_read_b64_tr_b16 v[84:85], v143 offset:0
    ds_read_b64_tr_b16 v[86:87], v143 offset:512
    ds_read_b64_tr_b16 v[88:89], v143 offset:2048
    ds_read_b64_tr_b16 v[90:91], v143 offset:2560
    s_setprio 3
    s_waitcnt lgkmcnt(8)
    v_mfma_f32_32x32x16_bf16 v[224:239], v[240:243], v[144:147], 0
    v_mfma_f32_32x32x16_bf16 v[224:239], v[244:247], v[148:151], v[224:239]
    v_mfma_f32_32x32x16_bf16 v[224:239], v[248:251], v[152:155], v[224:239]
    v_mfma_f32_32x32x16_bf16 v[224:239], v[252:255], v[156:159], v[224:239]
    s_mov_b32 exec_lo, 0x22220000
    s_mov_b32 exec_hi, 0x22220000
    v_lshl_add_u64 v[142:143], v[142:143], 0, s[10:11]
    s_mov_b64 exec, -1
    s_setprio 0
    ds_read_b64_tr_b16 v[92:93], v142 offset:4104
    ds_read_b64_tr_b16 v[94:95], v142 offset:4616
    ds_read_b64_tr_b16 v[96:97], v142 offset:6152
    ds_read_b64_tr_b16 v[98:99], v142 offset:6664
    ds_read_b64_tr_b16 v[100:101], v143 offset:4104
    ds_read_b64_tr_b16 v[102:103], v143 offset:4616
    ds_read_b64_tr_b16 v[104:105], v143 offset:6152
    ds_read_b64_tr_b16 v[106:107], v143 offset:6664
    s_setprio 3
    s_mov_b32 exec_lo, 0x44440000
    s_mov_b32 exec_hi, 0x44440000
    v_lshl_add_u64 v[142:143], v[142:143], 0, s[10:11]
    s_mov_b64 exec, -1
    s_setprio 0
    ds_read_b64_tr_b16 v[108:109], v142 offset:8208
    ds_read_b64_tr_b16 v[110:111], v142 offset:8720
    ds_read_b64_tr_b16 v[112:113], v142 offset:10256
    ds_read_b64_tr_b16 v[114:115], v142 offset:10768
    ds_read_b64_tr_b16 v[116:117], v143 offset:8208
    ds_read_b64_tr_b16 v[118:119], v143 offset:8720
    ds_read_b64_tr_b16 v[120:121], v143 offset:10256
    ds_read_b64_tr_b16 v[122:123], v143 offset:10768
    s_setprio 3
    s_mov_b32 exec_lo, 0x11110000
    s_mov_b32 exec_hi, 0x11110000
    v_lshl_add_u64 v[142:143], v[142:143], 0, s[10:11]
    s_mov_b64 exec, -1
    s_setprio 0
    ds_read_b64_tr_b16 v[160:161], v142 offset:12312
    ds_read_b64_tr_b16 v[162:163], v142 offset:12824
    ds_read_b64_tr_b16 v[164:165], v142 offset:14360
    ds_read_b64_tr_b16 v[166:167], v142 offset:14872
    ds_read_b64_tr_b16 v[168:169], v143 offset:12312
    ds_read_b64_tr_b16 v[170:171], v143 offset:12824
    ds_read_b64_tr_b16 v[172:173], v143 offset:14360
    ds_read_b64_tr_b16 v[174:175], v143 offset:14872
    s_setprio 3
    s_mov_b32 exec_lo, 0x8888
    s_mov_b32 exec_hi, 0x8888
    v_lshl_add_u64 v[142:143], v[142:143], 0, s[10:11]
    s_mov_b64 exec, -1
    s_setprio 0
    ds_read_b64_tr_b16 v[176:177], v142 offset:16416
    ds_read_b64_tr_b16 v[178:179], v142 offset:16928
    ds_read_b64_tr_b16 v[180:181], v142 offset:18464
    ds_read_b64_tr_b16 v[182:183], v142 offset:18976
    ds_read_b64_tr_b16 v[184:185], v143 offset:16416
    ds_read_b64_tr_b16 v[186:187], v143 offset:16928
    ds_read_b64_tr_b16 v[188:189], v143 offset:18464
    ds_read_b64_tr_b16 v[190:191], v143 offset:18976
    s_setprio 3
    s_mov_b32 exec_lo, 0x2222
    s_mov_b32 exec_hi, 0x2222
    v_lshl_add_u64 v[142:143], v[142:143], 0, s[10:11]
    s_mov_b64 exec, -1
    s_setprio 0
    ds_read_b64_tr_b16 v[192:193], v142 offset:20520
    ds_read_b64_tr_b16 v[194:195], v142 offset:21032
    ds_read_b64_tr_b16 v[196:197], v142 offset:22568
    ds_read_b64_tr_b16 v[198:199], v142 offset:23080
    ds_read_b64_tr_b16 v[200:201], v143 offset:20520
    ds_read_b64_tr_b16 v[202:203], v143 offset:21032
    ds_read_b64_tr_b16 v[204:205], v143 offset:22568
    ds_read_b64_tr_b16 v[206:207], v143 offset:23080
    s_setprio 3
    s_mov_b32 exec_lo, 0x4444
    s_mov_b32 exec_hi, 0x4444
    v_lshl_add_u64 v[142:143], v[142:143], 0, s[10:11]
    s_mov_b64 exec, -1
    s_setprio 0
    ds_read_b64_tr_b16 v[208:209], v142 offset:24624
    ds_read_b64_tr_b16 v[210:211], v142 offset:25136
    ds_read_b64_tr_b16 v[212:213], v142 offset:26672
    ds_read_b64_tr_b16 v[214:215], v142 offset:27184
    ds_read_b64_tr_b16 v[216:217], v143 offset:24624
    ds_read_b64_tr_b16 v[218:219], v143 offset:25136
    ds_read_b64_tr_b16 v[220:221], v143 offset:26672
    ds_read_b64_tr_b16 v[222:223], v143 offset:27184
    s_setprio 3
    s_mov_b32 exec_hi, 0
    v_cvt_pk_bf16_f32 v124, v224, 0
    s_mov_b64 exec, -1
    s_waitcnt lgkmcnt(0)
    s_mov_b64 exec, 1
    ds_add_u32 v4, v5 offset:32
    s_mov_b64 exec, -1
    v_mfma_f32_32x32x16_bf16 v[240:255], v[72:75], v[124:127], 0
    s_mov_b32 s69, 400000
wc_51:
    ds_read_b32 v6, v4 offset:32
    s_waitcnt lgkmcnt(0)
    v_readfirstlane_b32 s8, v6
    s_sub_u32 s69, s69, 1
    s_cmp_ge_u32 s8, 4
    s_cbranch_scc1 wc_51_d
    s_sleep 1
    s_cmp_lg_u32 s69, 0
    s_cbranch_scc1 wc_51
wc_51_d:
    s_lshr_b32 s10, s61, 2
    s_mul_i32 s10, s10, 10
    s_lshr_b32 s10, s10, 3
    s_add_u32 s10, s10, 0
    s_lshl_b32 s10, s10, 2
    s_add_u32 s10, s10, s35
    s_mul_i32 s10, s10, 896
    s_add_u32 m0, s10, 0
    s_lshl_b32 s13, s10, 2
    buffer_load_dwordx4 v140, s[40:43], s13 offen lds
    s_add_u32 s10, s10, 3584
    s_sub_u32 s11, s10, 35840
    s_cmp_ge_u32 s10, 35840
    s_cselect_b32 s10, s11, s10
    s_add_u32 m0, s10, 0
    s_lshl_b32 s13, s10, 2
    buffer_load_dwordx4 v140, s[40:43], s13 offen lds
    s_add_u32 s10, s10, 3584
    s_sub_u32 s11, s10, 35840
    s_cmp_ge_u32 s10, 35840
    s_cselect_b32 s10, s11, s10
    s_add_u32 m0, s10, 0
    s_lshl_b32 s13, s10, 2
    buffer_load_dwordx4 v140, s[40:43], s13 offen lds
    s_add_u32 s10, s10, 3584
    s_sub_u32 s11, s10, 35840
    s_cmp_ge_u32 s10, 35840
    s_cselect_b32 s10, s11, s10
    s_add_u32 m0, s10, 0
    s_lshl_b32 s13, s10, 2
    buffer_load_dwordx4 v140, s[40:43], s13 offen lds
    s_add_u32 s10, s10, 3584
    s_sub_u32 s11, s10, 35840
    s_cmp_ge_u32 s10, 35840
    s_cselect_b32 s10, s11, s10
    s_add_u32 m0, s10, 0
    s_lshl_b32 s13, s10, 2
    buffer_load_dwordx4 v140, s[40:43], s13 offen lds
    s_add_u32 s10, s10, 3584
    s_sub_u32 s11, s10, 35840
    s_cmp_ge_u32 s10, 35840
    s_cselect_b32 s10, s11, s10
    s_add_u32 m0, s10, 0
    s_lshl_b32 s13, s10, 2
    buffer_load_dwordx4 v140, s[40:43], s13 offen lds
    s_add_u32 s10, s10, 3584
    s_sub_u32 s11, s10, 35840
    s_cmp_ge_u32 s10, 35840
    s_cselect_b32 s10, s11, s10
    s_add_u32 m0, s10, 0
    s_lshl_b32 s13, s10, 2
    buffer_load_dwordx4 v140, s[40:43], s13 offen lds
    s_add_u32 s10, s10, 3584
    s_sub_u32 s11, s10, 35840
    s_cmp_ge_u32 s10, 35840
    s_cselect_b32 s10, s11, s10
    s_add_u32 m0, s10, 0
    s_lshl_b32 s13, s10, 2
    buffer_load_dwordx4 v140, s[40:43], s13 offen lds
    s_add_u32 s10, s10, 3584
    s_sub_u32 s11, s10, 35840
    s_cmp_ge_u32 s10, 35840
    s_cselect_b32 s10, s11, s10
    s_add_u32 m0, s10, 0
    s_lshl_b32 s13, s10, 2
    buffer_load_dwordx4 v140, s[40:43], s13 offen lds
    s_add_u32 s10, s10, 3584
    s_sub_u32 s11, s10, 35840
    s_cmp_ge_u32 s10, 35840
    s_cselect_b32 s10, s11, s10
    s_add_u32 m0, s10, 0
    s_lshl_b32 s13, s10, 2
    buffer_load_dwordx4 v140, s[40:43], s13 offen lds
    s_waitcnt vmcnt(0)
    s_mov_b64 exec, 1
    ds_add_u32 v4, v5 offset:48
    s_mov_b64 exec, -1
    s_mul_i32 s7, s67, 1792
    s_mul_i32 s8, s91, 56
    s_lshl_b32 s9, s68, 4
    s_add_u32 s8, s8, s9
    s_add_u32 s6, s7, s8
    s_sub_u32 s7, s7, s8
    s_add_u32 s7, s7, 882
    s_sub_u32 s7, s7, 32
    s_mov_b32 s69, 400000
wc_52:
    ds_read_b32 v6, v4 offset:40
    s_waitcnt lgkmcnt(0)
    v_readfirstlane_b32 s8, v6
    s_sub_u32 s69, s69, 1
    s_cmp_ge_u32 s8, 4
    s_cbranch_scc1 wc_52_d
    s_sleep 4
    s_cmp_lg_u32 s69, 0
    s_cbranch_scc1 wc_52
wc_52_d:
    s_setprio 1
    v_mfma_f32_32x32x16_bf16 v[224:239], v[76:79], v[144:147], 0
    v_mfma_f32_32x32x16_bf16 v[224:239], v[80:83], v[148:151], v[224:239]
    v_mfma_f32_32x32x16_bf16 v[224:239], v[84:87], v[152:155], v[224:239]
    v_mfma_f32_32x32x16_bf16 v[224:239], v[88:91], v[156:159], v[224:239]
    v_mfma_f32_32x32x16_bf16 v[76:91], v[92:95], v[144:147], 0
    v_mfma_f32_32x32x16_bf16 v[76:91], v[96:99], v[148:151], v[76:91]
    v_mfma_f32_32x32x16_bf16 v[76:91], v[100:103], v[152:155], v[76:91]
    v_mfma_f32_32x32x16_bf16 v[76:91], v[104:107], v[156:159], v[76:91]
    v_cvt_pk_bf16_f32 v132, v224, v225
    v_cvt_pk_bf16_f32 v133, v226, v227
    v_cvt_pk_bf16_f32 v134, v228, v229
    v_cvt_pk_bf16_f32 v135, v230, v231
    v_cvt_pk_bf16_f32 v136, v232, v233
    v_cvt_pk_bf16_f32 v137, v234, v235
    v_cvt_pk_bf16_f32 v138, v236, v237
    v_cvt_pk_bf16_f32 v139, v238, v239
    s_nop 0
    v_mfma_f32_32x32x16_bf16 v[240:255], v[16:19], v[132:135], v[240:255]
    v_mfma_f32_32x32x16_bf16 v[240:255], v[20:23], v[136:139], v[240:255]
    v_mfma_f32_32x32x16_bf16 v[224:239], v[108:111], v[144:147], 0
    v_mfma_f32_32x32x16_bf16 v[224:239], v[112:115], v[148:151], v[224:239]
    v_mfma_f32_32x32x16_bf16 v[224:239], v[116:119], v[152:155], v[224:239]
    v_mfma_f32_32x32x16_bf16 v[224:239], v[120:123], v[156:159], v[224:239]
    v_cvt_pk_bf16_f32 v92, v76, v77
    v_cvt_pk_bf16_f32 v93, v78, v79
    v_cvt_pk_bf16_f32 v94, v80, v81
    v_cvt_pk_bf16_f32 v95, v82, v83
    v_cvt_pk_bf16_f32 v96, v84, v85
    v_cvt_pk_bf16_f32 v97, v86, v87
    v_cvt_pk_bf16_f32 v98, v88, v89
    v_cvt_pk_bf16_f32 v99, v90, v91
    s_nop 0
    v_mfma_f32_32x32x16_bf16 v[240:255], v[24:27], v[92:95], v[240:255]
    v_mfma_f32_32x32x16_bf16 v[240:255], v[28:31], v[96:99], v[240:255]
    v_mfma_f32_32x32x16_bf16 v[76:91], v[160:163], v[144:147], 0
    v_mfma_f32_32x32x16_bf16 v[76:91], v[164:167], v[148:151], v[76:91]
    v_mfma_f32_32x32x16_bf16 v[76:91], v[168:171], v[152:155], v[76:91]
    v_mfma_f32_32x32x16_bf16 v[76:91], v[172:175], v[156:159], v[76:91]
    v_cvt_pk_bf16_f32 v132, v224, v225
    v_cvt_pk_bf16_f32 v133, v226, v227
    v_cvt_pk_bf16_f32 v134, v228, v229
    v_cvt_pk_bf16_f32 v135, v230, v231
    v_cvt_pk_bf16_f32 v136, v232, v233
    v_cvt_pk_bf16_f32 v137, v234, v235
    v_cvt_pk_bf16_f32 v138, v236, v237
    v_cvt_pk_bf16_f32 v139, v238, v239
    s_nop 0
    v_mfma_f32_32x32x16_bf16 v[240:255], v[32:35], v[132:135], v[240:255]
    v_mfma_f32_32x32x16_bf16 v[240:255], v[36:39], v[136:139], v[240:255]
    v_mfma_f32_32x32x16_bf16 v[224:239], v[176:179], v[144:147], 0
    v_mfma_f32_32x32x16_bf16 v[224:239], v[180:183], v[148:151], v[224:239]
    v_mfma_f32_32x32x16_bf16 v[224:239], v[184:187], v[152:155], v[224:239]
    v_mfma_f32_32x32x16_bf16 v[224:239], v[188:191], v[156:159], v[224:239]
    v_cvt_pk_bf16_f32 v92, v76, v77
    v_cvt_pk_bf16_f32 v93, v78, v79
    v_cvt_pk_bf16_f32 v94, v80, v81
    v_cvt_pk_bf16_f32 v95, v82, v83
    v_cvt_pk_bf16_f32 v96, v84, v85
    v_cvt_pk_bf16_f32 v97, v86, v87
    v_cvt_pk_bf16_f32 v98, v88, v89
    v_cvt_pk_bf16_f32 v99, v90, v91
    s_nop 0
    v_mfma_f32_32x32x16_bf16 v[240:255], v[40:43], v[92:95], v[240:255]
    v_mfma_f32_32x32x16_bf16 v[240:255], v[44:47], v[96:99], v[240:255]
    v_mfma_f32_32x32x16_bf16 v[76:91], v[192:195], v[144:147], 0
    v_mfma_f32_32x32x16_bf16 v[76:91], v[196:199], v[148:151], v[76:91]
    v_mfma_f32_32x32x16_bf16 v[76:91], v[200:203], v[152:155], v[76:91]
    v_mfma_f32_32x32x16_bf16 v[76:91], v[204:207], v[156:159], v[76:91]
    v_cvt_pk_bf16_f32 v132, v224, v225
    v_cvt_pk_bf16_f32 v133, v226, v227
    v_cvt_pk_bf16_f32 v134, v228, v229
    v_cvt_pk_bf16_f32 v135, v230, v231
    v_cvt_pk_bf16_f32 v136, v232, v233
    v_cvt_pk_bf16_f32 v137, v234, v235
    v_cvt_pk_bf16_f32 v138, v236, v237
    v_cvt_pk_bf16_f32 v139, v238, v239
    s_nop 0
    v_mfma_f32_32x32x16_bf16 v[240:255], v[48:51], v[132:135], v[240:255]
    v_mfma_f32_32x32x16_bf16 v[240:255], v[52:55], v[136:139], v[240:255]
    v_mfma_f32_32x32x16_bf16 v[224:239], v[208:211], v[144:147], 0
    v_mfma_f32_32x32x16_bf16 v[224:239], v[212:215], v[148:151], v[224:239]
    v_mfma_f32_32x32x16_bf16 v[224:239], v[216:219], v[152:155], v[224:239]
    v_mfma_f32_32x32x16_bf16 v[224:239], v[220:223], v[156:159], v[224:239]
    v_cvt_pk_bf16_f32 v92, v76, v77
    v_cvt_pk_bf16_f32 v93, v78, v79
    v_cvt_pk_bf16_f32 v94, v80, v81
    v_cvt_pk_bf16_f32 v95, v82, v83
    v_cvt_pk_bf16_f32 v96, v84, v85
    v_cvt_pk_bf16_f32 v97, v86, v87
    v_cvt_pk_bf16_f32 v98, v88, v89
    v_cvt_pk_bf16_f32 v99, v90, v91
    s_nop 0
    v_mfma_f32_32x32x16_bf16 v[240:255], v[56:59], v[92:95], v[240:255]
    v_mfma_f32_32x32x16_bf16 v[240:255], v[60:63], v[96:99], v[240:255]
    s_nop 9
    v_cvt_pk_bf16_f32 v132, v224, v225
    v_cvt_pk_bf16_f32 v133, v226, v227
    v_cvt_pk_bf16_f32 v134, v228, v229
    v_cvt_pk_bf16_f32 v135, v230, v231
    v_cvt_pk_bf16_f32 v136, v232, v233
    v_cvt_pk_bf16_f32 v137, v234, v235
    v_cvt_pk_bf16_f32 v138, v236, v237
    v_cvt_pk_bf16_f32 v139, v238, v239
    s_nop 0
    v_mfma_f32_32x32x16_bf16 v[240:255], v[64:67], v[132:135], v[240:255]
    v_mfma_f32_32x32x16_bf16 v[240:255], v[68:71], v[136:139], v[240:255]
    s_nop 2
    s_nop 13
    s_cmp_lg_u32 s68, 0
    s_cbranch_scc1 a_x1
    ds_write_b128 v131, v[248:251] offset:0
    ds_write_b128 v131, v[252:255] offset:1024
    s_waitcnt lgkmcnt(0)
    s_mov_b64 exec, 1
    ds_add_u32 v4, v5 offset:28
    s_mov_b64 exec, -1
    v_mov_b32 v176, v7
    s_mov_b32 s69, 400000
wc_53:
    ds_read_b32 v6, v4 offset:28
    s_waitcnt lgkmcnt(0)
    v_readfirstlane_b32 s8, v6
    s_sub_u32 s69, s69, 1
    s_cmp_ge_u32 s8, 4
    s_cbranch_scc1 wc_53_d
    s_sleep 1
    s_cmp_lg_u32 s69, 0
    s_cbranch_scc1 wc_53
wc_53_d:
    ds_read_b128 v[168:171], v141 offset:0
    ds_read_b128 v[172:175], v141 offset:1024
    s_waitcnt lgkmcnt(0)
    v_add_f32 v176, v240, v168
    v_sub_f32 v184, v240, v168
    v_add_f32 v177, v241, v169
    v_sub_f32 v185, v241, v169
    v_add_f32 v178, v242, v170
    v_sub_f32 v186, v242, v170
    v_add_f32 v179, v243, v171
    v_sub_f32 v187, v243, v171
    v_add_f32 v180, v244, v172
    v_sub_f32 v188, v244, v172
    v_add_f32 v181, v245, v173
    v_sub_f32 v189, v245, v173
    v_add_f32 v182, v246, v174
    v_sub_f32 v190, v246, v174
    v_add_f32 v183, v247, v175
    v_sub_f32 v191, v247, v175
    v_cvt_pk_bf16_f32 v168, v176, v177
    v_cvt_pk_bf16_f32 v169, v178, v179
    v_cvt_pk_bf16_f32 v170, v180, v181
    v_cvt_pk_bf16_f32 v171, v182, v183
    v_cvt_pk_bf16_f32 v172, v191, v190
    v_cvt_pk_bf16_f32 v173, v189, v188
    v_cvt_pk_bf16_f32 v174, v187, v186
    v_cvt_pk_bf16_f32 v175, v185, v184
    buffer_store_dwordx4 v[168:171], v129, s[48:51], s6 offen
    s_cmp_lg_u32 s91, 0
    s_cbranch_scc1 a_o1
    s_mov_b32 exec_hi, 0
    buffer_store_dwordx3 v[172:174], v130, s[48:51], s7 offen
    buffer_store_short v175, v130, s[48:51], s7 offen offset:12
    s_mov_b32 exec_lo, 0
    s_mov_b32 exec_hi, -1
a_o1:
    buffer_store_dwordx4 v[172:175], v130, s[48:51], s7 offen
    s_mov_b64 exec, -1
    s_branch a_x2
a_x1:
    ds_write_b128 v131, v[240:243] offset:0
    ds_write_b128 v131, v[244:247] offset:1024
    s_waitcnt lgkmcnt(0)
    s_mov_b64 exec, 1
    ds_add_u32 v4, v5 offset:28
    s_mov_b64 exec, -1
    v_mov_b32 v176, v7
    s_mov_b32 s69, 400000
wc_54:
    ds_read_b32 v6, v4 offset:28
    s_waitcnt lgkmcnt(0)
    v_readfirstlane_b32 s8, v6
    s_sub_u32 s69, s69, 1
    s_cmp_ge_u32 s8, 4
    s_cbranch_scc1 wc_54_d
    s_sleep 1
    s_cmp_lg_u32 s69, 0
    s_cbranch_scc1 wc_54
wc_54_d:
    ds_read_b128 v[168:171], v141 offset:0
    ds_read_b128 v[172:175], v141 offset:1024
    s_waitcnt lgkmcnt(0)
    v_add_f32 v176, v168, v248
    v_sub_f32 v184, v168, v248
    v_add_f32 v177, v169, v249
    v_sub_f32 v185, v169, v249
    v_add_f32 v178, v170, v250
    v_sub_f32 v186, v170, v250
    v_add_f32 v179, v171, v251
    v_sub_f32 v187, v171, v251
    v_add_f32 v180, v172, v252
    v_sub_f32 v188, v172, v252
    v_add_f32 v181, v173, v253
    v_sub_f32 v189, v173, v253
    v_add_f32 v182, v174, v254
    v_sub_f32 v190, v174, v254
    v_add_f32 v183, v175, v255
    v_sub_f32 v191, v175, v255
    v_cvt_pk_bf16_f32 v168, v176, v177
    v_cvt_pk_bf16_f32 v169, v178, v179
    v_cvt_pk_bf16_f32 v170, v180, v181
    v_cvt_pk_bf16_f32 v171, v182, v183
    v_cvt_pk_bf16_f32 v172, v191, v190
    v_cvt_pk_bf16_f32 v173, v189, v188
    v_cvt_pk_bf16_f32 v174, v187, v186
    v_cvt_pk_bf16_f32 v175, v185, v184
    s_mov_b32 exec_hi, 0
    buffer_store_dwordx4 v[168:171], v129, s[48:51], s6 offen
    buffer_store_dwordx4 v[172:175], v130, s[48:51], s7 offen
    s_mov_b32 exec_lo, 0
    s_mov_b32 exec_hi, -1
    buffer_store_dwordx2 v[168:169], v129, s[48:51], s6 offen
    buffer_store_dwordx2 v[174:175], v130, s[48:51], s7 offen offset:8
    s_cmp_lg_u32 s91, 7
    s_cbranch_scc1 a_o2
    buffer_store_short v170, v129, s[48:51], s6 offen offset:8
a_o2:
    s_mov_b64 exec, -1
a_x2:
    s_branch a_fin
a_tchk0_r:
    s_sub_u32 s14, s14, 1
    s_cmp_le_i32 s14, 0
    s_cbranch_scc1 a_tchk0_d
    s_sleep 4
    s_add_u32 m0, s7, 0
    s_add_u32 s8, s6, 0
    buffer_load_dwordx4 v3, s[44:47], s8 offen sc1 lds
    s_add_u32 m0, s7, 1024
    s_add_u32 s8, s6, 1024
    buffer_load_dwordx4 v3, s[44:47], s8 offen sc1 lds
    s_add_u32 m0, s7, 2048
    s_add_u32 s8, s6, 2048
    buffer_load_dwordx4 v3, s[44:47], s8 offen sc1 lds
    s_add_u32 m0, s7, 3072
    s_add_u32 s8, s6, 3072
    buffer_load_dwordx4 v3, s[44:47], s8 offen sc1 lds
    s_add_u32 m0, s7, 4096
    s_add_u32 s8, s6, 4096
    buffer_load_dwordx4 v3, s[44:47], s8 offen sc1 lds
    s_add_u32 m0, s7, 5120
    s_add_u32 s8, s6, 5120
    buffer_load_dwordx4 v3, s[44:47], s8 offen sc1 lds
    s_add_u32 m0, s7, 6144
    s_add_u32 s8, s6, 6144
    buffer_load_dwordx4 v3, s[44:47], s8 offen sc1 lds
    s_add_u32 m0, s7, 7168
    s_add_u32 s8, s6, 7168
    buffer_load_dwordx4 v3, s[44:47], s8 offen sc1 lds
    s_waitcnt vmcnt(0)
    s_branch a_tchk0
a_fin:
k_end:
    s_endpgm
.section .rodata,"a"
.p2align 6
.amdhsa_kernel concat_heads__spectral_gfnet__mha_block__prompt_kernel
  .amdhsa_next_free_vgpr 256
  .amdhsa_next_free_sgpr 96
  .amdhsa_accum_offset 256
  .amdhsa_group_segment_fixed_size 0
  .amdhsa_kernarg_size 72
  .amdhsa_user_sgpr_count 2
  .amdhsa_user_sgpr_kernarg_segment_ptr 1
  .amdhsa_system_sgpr_workgroup_id_x 1
.end_amdhsa_kernel
```
